```python
import torch

def _softmax(x, axis=-1):
    return torch.softmax(x, dim=axis)
def _gelu(x):
    return torch.nn.functional.gelu(x, approximate="tanh")
def _silu(x):
    return torch.nn.functional.silu(x)
def _sigmoid(x):
    return torch.sigmoid(x)
def _layernorm(x, axis=-1, eps=1e-5):
    m = x.mean(dim=axis, keepdim=True)
    v = x.var(dim=axis, keepdim=True, unbiased=False)
    return (x - m) / torch.sqrt(v + eps)
def _scatter_add(tgt, idx, src, axis=0):
    return tgt.clone().index_add_(axis, idx, src)
def _segment_sum(src, seg, n):
    out = torch.zeros((n,) + src.shape[1:], dtype=src.dtype)
    return out.index_add_(0, seg, src)
def _pad(x, pw):
    flat = tuple(v for pair in reversed(pw) for v in pair)
    return torch.nn.functional.pad(x, flat)

kernel_name = 'concat_heads__linear_kernel_hedgehog__linear_kernel_hedgehog__prompt'

def setup_inputs():

    _w = (lambda a: (lambda t: t.to(torch.bfloat16) if t.is_floating_point() else t)(torch.as_tensor(a)))
    def _A_setup():
        B, S, D, H = 1, 2048, 1024, 32
        Dh = D // H
        return {
            "x": _w((lambda *s: torch.randn(*s, dtype=torch.bfloat16) * 0.4)(B, S, D)),
            "wqkv": _w((lambda *s: torch.randn(*s, dtype=torch.bfloat16) * 0.4)(D, 3 * D)),
            "w_phi": _w((lambda *s: torch.randn(*s, dtype=torch.bfloat16) * 0.4)(H, Dh, Dh) * (Dh ** -0.5)),
            "wo": _w((lambda *s: torch.randn(*s, dtype=torch.bfloat16) * 0.05)(D, D)),
        }
    _A_in = _A_setup()

    def _B_setup():
        B, S, D, H = 1, 2048, 1024, 32
        Dh = D // H
        return {
            "x": _w((lambda *s: torch.randn(*s, dtype=torch.bfloat16) * 0.4)(B, S, D)),
            "wqkv": _w((lambda *s: torch.randn(*s, dtype=torch.bfloat16) * 0.4)(D, 3 * D)),
            "w_phi": _w((lambda *s: torch.randn(*s, dtype=torch.bfloat16) * 0.4)(H, Dh, Dh) * (Dh ** -0.5)),
            "wo": _w((lambda *s: torch.randn(*s, dtype=torch.bfloat16) * 0.05)(D, D)),
        }
    _B_in = _B_setup()

    return {
        "A_x": _A_in["x"],
        "A_wqkv": _A_in["wqkv"],
        "A_w_phi": _A_in["w_phi"],
        "A_wo": _A_in["wo"],
        "B_x": _B_in["x"],
        "B_wqkv": _B_in["wqkv"],
        "B_w_phi": _B_in["w_phi"],
        "B_wo": _B_in["wo"],
    }

def reference(A_x, A_wqkv, A_w_phi, A_wo, B_x, B_wqkv, B_w_phi, B_wo):
    def _A_ref(x, wqkv, w_phi, wo):
        B, S, D = x.shape
        H = 32; Dh = D // H
        qkv = (lambda x, *d: x.permute(*d))((x @ wqkv).reshape(B, S, 3, H, Dh), 2, 0, 3, 1, 4)
        q, k, v = qkv[0], qkv[1], qkv[2]
        pq = torch.einsum("bhsd,hdf->bhsf", q, w_phi)
        pk = torch.einsum("bhsd,hdf->bhsf", k, w_phi)
        phi_q = torch.concatenate([_softmax(pq, axis=-1), _softmax(-pq, axis=-1)], axis=-1)
        phi_k = torch.concatenate([_softmax(pk, axis=-1), _softmax(-pk, axis=-1)], axis=-1)
        kv = torch.einsum("bhsf,bhsd->bhfd", phi_k, v)
        z  = torch.einsum("bhsf->bhf", phi_k)
        num = torch.einsum("bhqf,bhfd->bhqd", phi_q, kv)
        den = torch.einsum("bhqf,bhf->bhq", phi_q, z)[..., None] + 1e-6
        o = num / den
        return (lambda x, *d: x.permute(*d))(o, 0, 2, 1, 3).reshape(B, S, D) @ wo

    def _B_ref(x, wqkv, w_phi, wo):
        B, S, D = x.shape
        H = 32; Dh = D // H
        qkv = (lambda x, *d: x.permute(*d))((x @ wqkv).reshape(B, S, 3, H, Dh), 2, 0, 3, 1, 4)
        q, k, v = qkv[0], qkv[1], qkv[2]
        pq = torch.einsum("bhsd,hdf->bhsf", q, w_phi)
        pk = torch.einsum("bhsd,hdf->bhsf", k, w_phi)
        phi_q = torch.concatenate([_softmax(pq, axis=-1), _softmax(-pq, axis=-1)], axis=-1)
        phi_k = torch.concatenate([_softmax(pk, axis=-1), _softmax(-pk, axis=-1)], axis=-1)
        kv = torch.einsum("bhsf,bhsd->bhfd", phi_k, v)
        z  = torch.einsum("bhsf->bhf", phi_k)
        num = torch.einsum("bhqf,bhfd->bhqd", phi_q, kv)
        den = torch.einsum("bhqf,bhf->bhq", phi_q, z)[..., None] + 1e-6
        o = num / den
        return (lambda x, *d: x.permute(*d))(o, 0, 2, 1, 3).reshape(B, S, D) @ wo

    a = _A_ref(A_x, A_wqkv, A_w_phi, A_wo)
    b = _B_ref(B_x, B_wqkv, B_w_phi, B_wo)
    return torch.concatenate([a, b], axis=-1)
```

```asm
; @launch grid=(256,1,1) block=(256,1,1) lds=163840
.amdgcn_target "amdgcn-amd-amdhsa--gfx950"
.text
.globl concat_heads__linear_kernel_hedgehog__linear_kernel_hedgehog__prompt_kernel
.p2align 8
.type concat_heads__linear_kernel_hedgehog__linear_kernel_hedgehog__prompt_kernel,@function
concat_heads__linear_kernel_hedgehog__linear_kernel_hedgehog__prompt_kernel:
    s_cmp_ge_u32 s2, 256
    s_cbranch_scc1 L_end
    s_load_dwordx16 s[64:79], s[0:1], 0
    s_load_dwordx4 s[4:7], s[0:1], 64
    s_load_dwordx2 s[96:97], s[0:1], 80
    v_lshrrev_b32 v1, 6, v0
    v_and_b32 v209, 63, v0
    v_readfirstlane_b32 s24, v1
    s_getpc_b64 s[22:23]
    s_lshr_b32 s3, s2, 3
    s_lshl_b32 s3, s3, 2
    v_add_u32 v2, s3, v1
    v_mul_u32_u24 v2, 3, v2
    v_min_u32 v3, 2, v209
    v_add_lshl_u32 v2, v2, v3, 7
    v_min_u32 v2, 48256, v2
    global_load_dword v206, v2, s[22:23]
    v_mov_b32_e64 v0, v209
    s_and_b32 s3, s2, 7
    s_lshr_b32 s29, s3, 2
    s_and_b32 s30, s3, 2
    s_lshl_b32 s30, s30, 2
    s_lshr_b32 s31, s2, 5
    s_add_u32 s30, s30, s31
    s_and_b32 s3, s3, 1
    s_lshl_b32 s3, s3, 2
    s_bfe_u32 s31, s2, 0x20003
    s_add_u32 s31, s31, s3
    v_lshrrev_b32 v1, 3, v0
    v_and_b32 v2, 7, v0
    v_lshrrev_b32 v3, 1, v1
    s_lshr_b32 s33, s24, 1
    s_and_b32 s34, s24, 1
    s_lshl_b32 s3, s33, 7
    s_lshl_b32 s32, s34, 5
    s_add_u32 s3, s3, s32
    v_add_u32 v4, s3, v1
    v_lshlrev_b32 v4, 11, v4
    v_xor_b32 v5, v2, v3
    v_lshl_add_u32 v192, v5, 4, v4
    v_xor_b32_e64 v5, 4, v5
    v_lshl_add_u32 v193, v5, 4, v4
    v_add_u32 v193, 15360, v193
    v_add_u32 v194, 30720, v192
    v_add_u32 v195, 30720, v193
    s_lshl_b32 s3, s24, 4
    v_add_u32 v4, s3, v1
    v_mul_u32_u24 v4, 6144, v4
    v_and_b32 v3, 1, v3
    v_lshlrev_b32 v3, 1, v3
    v_xor_b32_e64 v5, v2, v3
    v_lshl_add_u32 v196, v5, 4, v4
    v_xor_b32_e64 v5, 4, v5
    v_lshl_add_u32 v197, v5, 4, v4
    v_add_u32 v197, 48128, v197
    s_lshl_b32 s25, s24, 12
    s_lshl_b32 s26, s24, 11
    s_add_u32 s94, s25, 65536
    s_add_u32 s26, s26, 98304
    v_and_b32 v1, 7, v0
    v_lshrrev_b32 v2, 3, v0
    s_and_b32 s3, s30, 7
    s_lshl_b32 s3, s3, 2
    s_add_u32 s3, s3, s24
    s_lshl_b32 s3, s3, 3
    v_add_u32 v4, s3, v1
    v_lshlrev_b32 v4, 11, v4
    v_lshl_add_u32 v204, v2, 7, v4
    v_lshrrev_b32_e64 v4, 4, v0
    v_bfe_u32 v3, v0, 2, 2
    v_lshl_add_u32 v4, v4, 6, v3
    s_and_b32 s3, s31, 3
    s_lshl_b32 s3, s3, 2
    s_add_u32 s3, s3, s24
    s_lshl_b32 s3, s3, 2
    v_add_u32_e64 v4, s3, v4
    v_mul_u32_u24 v4, 6144, v4
    v_and_b32 v3, 3, v0
    v_min_u32 v3, 2, v3
    v_lshl_add_u32 v205, v3, 11, v4
    s_lshl_b32 s32, s29, 4
    s_add_u32 s32, s32, s30
    s_waitcnt lgkmcnt(0)
    s_cmp_eq_u32 s29, 0
    s_cselect_b32 s8, s64, s72
    s_cselect_b32 s9, s65, s73
    s_cselect_b32 s12, s66, s74
    s_cselect_b32 s13, s67, s75
    s_cselect_b32 s20, s68, s76
    s_cselect_b32 s21, s69, s77
    s_cselect_b32 s80, s70, s78
    s_cselect_b32 s81, s71, s79
    s_lshl_b32 s3, s31, 19
    s_add_u32 s8, s8, s3
    s_addc_u32 s9, s9, 0
    s_mov_b32 s10, 0x80000
    s_mov_b32 s11, 0x20000
    s_and_b32 s3, s30, 15
    s_lshl_b32 s3, s3, 7
    s_add_u32 s12, s12, s3
    s_addc_u32 s13, s13, 0
    s_sub_u32 s14, 0x600000, s3
    s_mov_b32 s15, 0x20000
    s_mov_b32 exec_lo, 0xffff
    s_mov_b32 exec_hi, 0x0
    s_mov_b32 s35, 0
    buffer_load_dword v206, v205, s[12:15], s35 offen
    s_mov_b64 exec, -1
    s_mov_b32 exec_lo, 0xff
    s_mov_b32 exec_hi, 0x0
    s_mov_b32 s35, 0
    buffer_load_dword v206, v204, s[8:11], s35 offen
    s_mov_b64 exec, -1
    s_add_u32 m0, s26, 0
    s_mov_b32 s28, 0
    buffer_load_dwordx4 v196, s[12:15], s28 offen offset:0  lds
    buffer_load_dwordx4 v197, s[12:15], s28 offen offset:1024  lds
    s_add_u32 m0, s25, 0
    s_mov_b32 s27, 0
    buffer_load_dwordx4 v192, s[8:11], s27 offen offset:0  lds
    buffer_load_dwordx4 v193, s[8:11], s27 offen offset:1024  lds
    buffer_load_dwordx4 v194, s[8:11], s27 offen offset:2048  lds
    buffer_load_dwordx4 v195, s[8:11], s27 offen offset:3072  lds
    s_add_u32 m0, s26, 8192
    s_mov_b32 s28, 2048
    buffer_load_dwordx4 v196, s[12:15], s28 offen offset:0  lds
    buffer_load_dwordx4 v197, s[12:15], s28 offen offset:1024  lds
    s_add_u32 m0, s25, 16384
    s_mov_b32 s27, 131072
    buffer_load_dwordx4 v192, s[8:11], s27 offen offset:0  lds
    buffer_load_dwordx4 v193, s[8:11], s27 offen offset:1024  lds
    buffer_load_dwordx4 v194, s[8:11], s27 offen offset:2048  lds
    buffer_load_dwordx4 v195, s[8:11], s27 offen offset:3072  lds
    s_add_u32 m0, s26, 16384
    s_mov_b32 s28, 4096
    buffer_load_dwordx4 v196, s[12:15], s28 offen offset:0  lds
    buffer_load_dwordx4 v197, s[12:15], s28 offen offset:1024  lds
    s_mov_b32 exec_lo, 0xffffffff
    s_mov_b32 exec_hi, 0xffff
    s_mov_b32 s35, 393216
    buffer_load_dword v206, v205, s[12:15], s35 offen
    s_mov_b64 exec, -1
    s_mov_b32 exec_lo, 0xffffff
    s_mov_b32 exec_hi, 0x0
    s_mov_b32 s35, 128
    buffer_load_dword v206, v204, s[8:11], s35 offen
    s_mov_b64 exec, -1
    s_mov_b32 s16, s96
    s_mov_b32 s17, s97
    s_mov_b32 s18, 0x10000000
    s_mov_b32 s19, 0x20000
    s_lshl_b32 s3, s32, 2
    s_add_u32 s3, s3, s24
    s_lshl_b32 s3, s3, 10
    s_add_u32 s40, s3, 1048576
    s_lshl_b32 s3, s31, 7
    s_add_u32 s71, s40, s3
    v_mov_b32 v242, 0
    s_lshl_b32 s3, s29, 3
    s_add_u32 s3, s3, s31
    s_lshl_b32 s3, s3, 13
    s_add_u32 s92, s3, 1179648
    s_lshl_b32 s3, s30, 1
    s_add_u32 s3, s3, s34
    s_lshl_b32 s3, s3, 7
    s_lshl_b32 s93, s33, 12
    s_add_u32 s3, s3, s93
    v_mov_b32 v235, s3
    v_and_b32 v1, 15, v0
    v_lshrrev_b32 v2, 4, v0
    v_lshrrev_b32 v3, 1, v1
    v_xor_b32 v3, v3, v2
    v_lshlrev_b32 v4, 7, v1
    s_lshl_b32 s3, s33, 13
    v_add_u32_e64 v4, s3, v4
    v_lshl_add_u32 v198, v3, 4, v4
    v_xor_b32_e64 v199, 64, v198
    v_add_u32 v200, 0x10000, v198
    v_add_u32 v201, 0x10000, v199
    s_lshl_b32 s3, s30, 1
    s_add_u32 s3, s3, s34
    s_lshl_b32 s3, s3, 11
    v_lshlrev_b32 v4, 8, v2
    v_lshl_add_u32 v4, v1, 1, v4
    v_add_u32_e64 v210, s3, v4
    s_mov_b32 s36, s6
    s_mov_b32 s37, s7
    s_mov_b32 s38, 256
    s_mov_b32 s39, 0x20000
    v_mov_b32 v4, 0x7f000000
    v_cmp_gt_u32 vcc, 16, v0
    s_nop 1
    v_cndmask_b32 v207, v4, v204, vcc
    v_cmp_gt_u32 vcc, 32, v0
    s_nop 1
    v_cndmask_b32 v208, v4, v205, vcc
    v_bfe_u32 v1, v0, 2, 2
    v_and_b32_e64 v3, 3, v0
    v_lshl_add_u32 v4, v2, 3, v1
    v_lshlrev_b32_e64 v4, 7, v4
    v_lshl_add_u32 v4, v3, 3, v4
    v_lshrrev_b32 v1, 1, v1
    v_and_b32 v5, 1, v2
    v_lshl_add_u32 v1, v5, 1, v1
    s_lshl_b32 s3, s34, 1
    v_xor_b32 v1, s3, v1
    v_lshl_add_u32 v4, v1, 5, v4
    v_add_u32 v202, 98304, v4
    v_xor_b32 v203, 32, v202
    v_lshlrev_b32 v233, 4, v0
    v_and_b32 v239, 15, v0
    v_lshlrev_b32_e64 v239, 2, v239
    s_lshl_b32 s3, s32, 5
    s_add_u32 s3, s3, s24
    s_lshl_b32 s41, s3, 11
    s_add_u32 s41, s41, 2097152
    s_lshl_b32 s3, s31, 13
    s_add_u32 s42, s41, s3
    s_lshl_b32 s3, s32, 2
    s_add_u32 s3, s3, s24
    s_lshl_b32 s3, s3, 9
    s_add_u32 s43, s3, 1310720
    s_lshl_b32 s3, s31, 6
    s_add_u32 s22, s43, s3
    s_lshl_b32 s3, s29, 4
    s_lshl_b32 s23, s31, 1
    s_add_u32 s3, s3, s23
    s_add_u32 s3, s3, s33
    s_lshl_b32 s3, s3, 5
    s_lshl_b32 s23, s30, 1
    s_add_u32 s3, s3, s23
    s_add_u32 s3, s3, s34
    s_lshl_b32 s3, s3, 13
    s_add_u32 s23, s3, 8388608
    v_mov_b32 v243, 1
    s_lshr_b32 s3, s2, 3
    s_and_b32 s3, s3, 7
    s_add_u32 s3, s3, 5
    s_min_u32 s3, s3, 11
    s_mov_b32 s75, 0
    s_lshl_b32 s75, s75, 7
    s_cmp_eq_u32 s24, 0
    s_cselect_b32 s68, s3, 99
    v_mov_b32 v244, -1
    v_mov_b32 v245, -1
    v_mov_b32 v246, -1
    v_mov_b32_e64 v247, -1
    s_lshr_b32 s93, s30, 3
    s_and_b32 s3, s30, 7
    s_lshl_b32 s3, s3, 8
    s_add_u32 s80, s80, s3
    s_addc_u32 s81, s81, 0
    s_sub_u32 s80, s80, 2048
    s_subb_u32 s81, s81, 0
    s_sub_u32 s82, 0x200800, s3
    s_mov_b32 s83, 0x20000
    s_mov_b32 s84, s4
    s_mov_b32 s85, s5
    s_mov_b32 s86, 0x800000
    s_mov_b32 s87, 0x20000
    s_lshl_b32 s4, s29, 11
    s_add_u32 s3, s3, s4
    s_lshl_b32 s4, s34, 7
    s_add_u32 s3, s3, s4
    s_lshl_b32 s4, s31, 1
    s_add_u32 s4, s4, s93
    s_lshl_b32 s5, s4, 1
    s_add_u32 s5, s5, s33
    s_lshl_b32 s5, s5, 18
    s_add_u32 s95, s3, s5
    s_lshl_b32 s5, s29, 4
    s_add_u32 s4, s4, s5
    s_lshl_b32 s4, s4, 18
    s_add_u32 s4, s4, 8388608
    s_add_u32 s88, s96, s4
    s_addc_u32 s89, s97, 0
    s_mov_b32 s90, 0x40000
    s_mov_b32 s91, 0x20000
    s_mov_b64 exec, 0
    s_cmp_eq_u32 s24, 0
    s_cbranch_scc1 L_pg0
    s_cmp_eq_u32 s24, 1
    s_cbranch_scc1 L_pg2
    s_cmp_eq_u32 s24, 2
    s_cbranch_scc1 L_pg4
    s_cmp_eq_u32 s24, 3
    s_cbranch_scc1 L_pg6
    s_branch L_body
    .p2align 12
L_body:
    s_mov_b64 exec, -1
    s_nop 3
    s_waitcnt vmcnt(2)
    s_barrier
    ds_read_b64_tr_b16 a[64:65], v202 offset:0
    ds_read_b64_tr_b16 a[66:67], v202 offset:512
    ds_read_b64_tr_b16 a[68:69], v202 offset:4096
    ds_read_b64_tr_b16 a[70:71], v202 offset:4608
    ds_read_b64_tr_b16 a[72:73], v203 offset:0
    ds_read_b64_tr_b16 a[74:75], v203 offset:512
    ds_read_b64_tr_b16 a[76:77], v203 offset:4096
    ds_read_b64_tr_b16 a[78:79], v203 offset:4608
    ds_read_b128 a[0:3], v198 offset:0
    ds_read_b128 a[4:7], v199 offset:0
    ds_read_b128 a[8:11], v198 offset:2048
    ds_read_b128 a[12:15], v199 offset:2048
    ds_read_b128 a[16:19], v198 offset:4096
    ds_read_b128 a[20:23], v199 offset:4096
    ds_read_b128 a[24:27], v198 offset:6144
    ds_read_b128 a[28:31], v199 offset:6144
    ds_read_b64_tr_b16 a[80:81], v202 offset:8192
    ds_read_b64_tr_b16 a[82:83], v202 offset:8704
    ds_read_b64_tr_b16 a[84:85], v202 offset:12288
    ds_read_b64_tr_b16 a[86:87], v202 offset:12800
    ds_read_b64_tr_b16 a[88:89], v203 offset:8192
    ds_read_b64_tr_b16 a[90:91], v203 offset:8704
    ds_read_b64_tr_b16 a[92:93], v203 offset:12288
    ds_read_b64_tr_b16 a[94:95], v203 offset:12800
    ds_read_b128 a[32:35], v198 offset:16384
    ds_read_b128 a[36:39], v199 offset:16384
    ds_read_b128 a[40:43], v198 offset:18432
    ds_read_b128 a[44:47], v199 offset:18432
    ds_read_b128 a[48:51], v198 offset:20480
    ds_read_b128 a[52:55], v199 offset:20480
    ds_read_b128 a[56:59], v198 offset:22528
    ds_read_b128 a[60:63], v199 offset:22528
    ds_read_b64_tr_b16 a[96:97], v202 offset:16384
    ds_read_b64_tr_b16 a[98:99], v202 offset:16896
    ds_read_b64_tr_b16 a[100:101], v202 offset:20480
    ds_read_b64_tr_b16 a[102:103], v202 offset:20992
    ds_read_b64_tr_b16 a[104:105], v203 offset:16384
    ds_read_b64_tr_b16 a[106:107], v203 offset:16896
    ds_read_b64_tr_b16 a[108:109], v203 offset:20480
    ds_read_b64_tr_b16 a[110:111], v203 offset:20992
    s_waitcnt lgkmcnt(0)
    s_barrier
    v_mfma_f32_16x16x32_bf16 v[0:3], a[64:67], a[0:3], 0
    s_add_u32 m0, s26, 24576
    s_mov_b32 s28, 393216
    v_mfma_f32_16x16x32_bf16 v[0:3], a[68:71], a[4:7], v[0:3]
    buffer_load_dwordx4 v196, s[12:15], s28 offen offset:0  lds
    v_mfma_f32_16x16x32_bf16 v[8:11], a[64:67], a[8:11], 0
    v_mfma_f32_16x16x32_bf16 v[8:11], a[68:71], a[12:15], v[8:11]
    v_mfma_f32_16x16x32_bf16 v[16:19], a[64:67], a[16:19], 0
    v_mfma_f32_16x16x32_bf16 v[16:19], a[68:71], a[20:23], v[16:19]
    buffer_load_dwordx4 v197, s[12:15], s28 offen offset:1024  lds
    v_mfma_f32_16x16x32_bf16 v[24:27], a[64:67], a[24:27], 0
    v_mfma_f32_16x16x32_bf16 v[24:27], a[68:71], a[28:31], v[24:27]
    v_mfma_f32_16x16x32_bf16 v[32:35], a[64:67], a[32:35], 0
    s_add_u32 m0, s25, 32768
    s_mov_b32 s27, 128
    v_mfma_f32_16x16x32_bf16 v[32:35], a[68:71], a[36:39], v[32:35]
    buffer_load_dwordx4 v192, s[8:11], s27 offen offset:0  lds
    v_mfma_f32_16x16x32_bf16 v[40:43], a[64:67], a[40:43], 0
    v_mfma_f32_16x16x32_bf16 v[40:43], a[68:71], a[44:47], v[40:43]
    v_mfma_f32_16x16x32_bf16 v[48:51], a[64:67], a[48:51], 0
    v_mfma_f32_16x16x32_bf16 v[48:51], a[68:71], a[52:55], v[48:51]
    buffer_load_dwordx4 v193, s[8:11], s27 offen offset:1024  lds
    v_mfma_f32_16x16x32_bf16 v[56:59], a[64:67], a[56:59], 0
    v_mfma_f32_16x16x32_bf16 v[56:59], a[68:71], a[60:63], v[56:59]
    v_mfma_f32_16x16x32_bf16 v[60:63], a[72:75], a[56:59], 0
    v_mfma_f32_16x16x32_bf16 v[60:63], a[76:79], a[60:63], v[60:63]
    buffer_load_dwordx4 v194, s[8:11], s27 offen offset:2048  lds
    v_mfma_f32_16x16x32_bf16 v[52:55], a[72:75], a[48:51], 0
    v_mfma_f32_16x16x32_bf16 v[52:55], a[76:79], a[52:55], v[52:55]
    v_mfma_f32_16x16x32_bf16 v[44:47], a[72:75], a[40:43], 0
    v_mfma_f32_16x16x32_bf16 v[44:47], a[76:79], a[44:47], v[44:47]
    buffer_load_dwordx4 v195, s[8:11], s27 offen offset:3072  lds
    v_mfma_f32_16x16x32_bf16 v[36:39], a[72:75], a[32:35], 0
    v_mfma_f32_16x16x32_bf16 v[36:39], a[76:79], a[36:39], v[36:39]
    v_mfma_f32_16x16x32_bf16 v[28:31], a[72:75], a[24:27], 0
    s_add_u32 m0, s26, 32768
    s_mov_b32 s28, 395264
    v_mfma_f32_16x16x32_bf16 v[28:31], a[76:79], a[28:31], v[28:31]
    buffer_load_dwordx4 v196, s[12:15], s28 offen offset:0  lds
    v_mfma_f32_16x16x32_bf16 v[20:23], a[72:75], a[16:19], 0
    v_mfma_f32_16x16x32_bf16 v[20:23], a[76:79], a[20:23], v[20:23]
    v_mfma_f32_16x16x32_bf16 v[12:15], a[72:75], a[8:11], 0
    v_mfma_f32_16x16x32_bf16 v[12:15], a[76:79], a[12:15], v[12:15]
    buffer_load_dwordx4 v197, s[12:15], s28 offen offset:1024  lds
    v_mfma_f32_16x16x32_bf16 v[4:7], a[72:75], a[0:3], 0
    v_mfma_f32_16x16x32_bf16 v[4:7], a[76:79], a[4:7], v[4:7]
    v_mfma_f32_16x16x32_bf16 v[64:67], a[80:83], a[0:3], 0
    s_add_u32 m0, s25, 49152
    s_mov_b32 s27, 131200
    v_mfma_f32_16x16x32_bf16 v[64:67], a[84:87], a[4:7], v[64:67]
    buffer_load_dwordx4 v192, s[8:11], s27 offen offset:0  lds
    v_mfma_f32_16x16x32_bf16 v[72:75], a[80:83], a[8:11], 0
    v_mfma_f32_16x16x32_bf16 v[72:75], a[84:87], a[12:15], v[72:75]
    v_mfma_f32_16x16x32_bf16 v[80:83], a[80:83], a[16:19], 0
    v_mfma_f32_16x16x32_bf16 v[80:83], a[84:87], a[20:23], v[80:83]
    buffer_load_dwordx4 v193, s[8:11], s27 offen offset:1024  lds
    v_mfma_f32_16x16x32_bf16 v[88:91], a[80:83], a[24:27], 0
    v_mfma_f32_16x16x32_bf16 v[88:91], a[84:87], a[28:31], v[88:91]
    v_mfma_f32_16x16x32_bf16 v[96:99], a[80:83], a[32:35], 0
    v_mfma_f32_16x16x32_bf16 v[96:99], a[84:87], a[36:39], v[96:99]
    buffer_load_dwordx4 v194, s[8:11], s27 offen offset:2048  lds
    v_mfma_f32_16x16x32_bf16 v[104:107], a[80:83], a[40:43], 0
    v_mfma_f32_16x16x32_bf16 v[104:107], a[84:87], a[44:47], v[104:107]
    v_mfma_f32_16x16x32_bf16 v[112:115], a[80:83], a[48:51], 0
    v_mfma_f32_16x16x32_bf16 v[112:115], a[84:87], a[52:55], v[112:115]
    buffer_load_dwordx4 v195, s[8:11], s27 offen offset:3072  lds
    v_mfma_f32_16x16x32_bf16 v[120:123], a[80:83], a[56:59], 0
    v_mfma_f32_16x16x32_bf16 v[120:123], a[84:87], a[60:63], v[120:123]
    v_mfma_f32_16x16x32_bf16 v[124:127], a[88:91], a[56:59], 0
    s_add_u32 m0, s26, 40960
    s_mov_b32 s28, 397312
    v_mfma_f32_16x16x32_bf16 v[124:127], a[92:95], a[60:63], v[124:127]
    buffer_load_dwordx4 v196, s[12:15], s28 offen offset:0  lds
    v_mfma_f32_16x16x32_bf16 v[116:119], a[88:91], a[48:51], 0
    v_mfma_f32_16x16x32_bf16 v[116:119], a[92:95], a[52:55], v[116:119]
    v_mfma_f32_16x16x32_bf16 v[108:111], a[88:91], a[40:43], 0
    v_mfma_f32_16x16x32_bf16 v[108:111], a[92:95], a[44:47], v[108:111]
    buffer_load_dwordx4 v197, s[12:15], s28 offen offset:1024  lds
    v_mfma_f32_16x16x32_bf16 v[100:103], a[88:91], a[32:35], 0
    v_mfma_f32_16x16x32_bf16 v[100:103], a[92:95], a[36:39], v[100:103]
    v_mfma_f32_16x16x32_bf16 v[92:95], a[88:91], a[24:27], 0
    s_add_u32 m0, s26, 49152
    s_mov_b32 s28, 786432
    v_mfma_f32_16x16x32_bf16 v[92:95], a[92:95], a[28:31], v[92:95]
    buffer_load_dwordx4 v196, s[12:15], s28 offen offset:0  lds
    v_mfma_f32_16x16x32_bf16 v[84:87], a[88:91], a[16:19], 0
    v_mfma_f32_16x16x32_bf16 v[84:87], a[92:95], a[20:23], v[84:87]
    v_mfma_f32_16x16x32_bf16 v[76:79], a[88:91], a[8:11], 0
    s_waitcnt vmcnt(1)
    s_barrier
    v_mfma_f32_16x16x32_bf16 v[76:79], a[92:95], a[12:15], v[76:79]
    buffer_load_dwordx4 v197, s[12:15], s28 offen offset:1024  lds
    ds_read_b64_tr_b16 a[176:177], v202 offset:24576
    ds_read_b64_tr_b16 a[178:179], v202 offset:25088
    v_mfma_f32_16x16x32_bf16 v[68:71], a[88:91], a[0:3], 0
    ds_read_b64_tr_b16 a[180:181], v202 offset:28672
    v_mfma_f32_16x16x32_bf16 v[68:71], a[92:95], a[4:7], v[68:71]
    ds_read_b64_tr_b16 a[182:183], v202 offset:29184
    ds_read_b64_tr_b16 a[184:185], v203 offset:24576
    v_mfma_f32_16x16x32_bf16 v[128:131], a[0:3], a[96:99], 0
    s_add_u32 m0, s25, 65536
    s_mov_b32 s27, 256
    ds_read_b64_tr_b16 a[186:187], v203 offset:25088
    v_mfma_f32_16x16x32_bf16 v[128:131], a[4:7], a[100:103], v[128:131]
    buffer_load_dwordx4 v192, s[8:11], s27 offen offset:0  lds
    ds_read_b64_tr_b16 a[188:189], v203 offset:28672
    v_mfma_f32_16x16x32_bf16 v[132:135], a[8:11], a[96:99], 0
    ds_read_b64_tr_b16 a[190:191], v203 offset:29184
    ds_read_b128 a[112:115], v198 offset:32768
    v_mfma_f32_16x16x32_bf16 v[132:135], a[12:15], a[100:103], v[132:135]
    ds_read_b128 a[116:119], v199 offset:32768
    v_mfma_f32_16x16x32_bf16 v[144:147], a[16:19], a[96:99], 0
    ds_read_b128 a[120:123], v198 offset:34816
    ds_read_b128 a[124:127], v199 offset:34816
    v_mfma_f32_16x16x32_bf16 v[144:147], a[20:23], a[100:103], v[144:147]
    buffer_load_dwordx4 v193, s[8:11], s27 offen offset:1024  lds
    ds_read_b128 a[128:131], v198 offset:36864
    v_mfma_f32_16x16x32_bf16 v[148:151], a[24:27], a[96:99], 0
    ds_read_b128 a[132:135], v199 offset:36864
    v_mfma_f32_16x16x32_bf16 v[148:151], a[28:31], a[100:103], v[148:151]
    ds_read_b128 a[136:139], v198 offset:38912
    ds_read_b128 a[140:143], v199 offset:38912
    v_mfma_f32_16x16x32_bf16 v[160:163], a[32:35], a[96:99], 0
    ds_read_b64_tr_b16 a[192:193], v202 offset:32768
    v_mfma_f32_16x16x32_bf16 v[160:163], a[36:39], a[100:103], v[160:163]
    buffer_load_dwordx4 v194, s[8:11], s27 offen offset:2048  lds
    ds_read_b64_tr_b16 a[194:195], v202 offset:33280
    v_mfma_f32_16x16x32_bf16 v[164:167], a[40:43], a[96:99], 0
    ds_read_b64_tr_b16 a[196:197], v202 offset:36864
    ds_read_b64_tr_b16 a[198:199], v202 offset:37376
    v_mfma_f32_16x16x32_bf16 v[164:167], a[44:47], a[100:103], v[164:167]
    ds_read_b64_tr_b16 a[200:201], v203 offset:32768
    v_mfma_f32_16x16x32_bf16 v[176:179], a[48:51], a[96:99], 0
    ds_read_b64_tr_b16 a[202:203], v203 offset:33280
    ds_read_b64_tr_b16 a[204:205], v203 offset:36864
    v_mfma_f32_16x16x32_bf16 v[176:179], a[52:55], a[100:103], v[176:179]
    buffer_load_dwordx4 v195, s[8:11], s27 offen offset:3072  lds
    ds_read_b64_tr_b16 a[206:207], v203 offset:37376
    v_mfma_f32_16x16x32_bf16 v[180:183], a[56:59], a[96:99], 0
    ds_read_b128 a[144:147], v198 offset:49152
    v_mfma_f32_16x16x32_bf16 v[180:183], a[60:63], a[100:103], v[180:183]
    ds_read_b128 a[148:151], v199 offset:49152
    ds_read_b128 a[152:155], v198 offset:51200
    v_mfma_f32_16x16x32_bf16 v[188:191], a[56:59], a[104:107], 0
    ds_read_b128 a[156:159], v199 offset:51200
    v_mfma_f32_16x16x32_bf16 v[188:191], a[60:63], a[108:111], v[188:191]
    ds_read_b128 a[160:163], v198 offset:53248
    v_mfma_f32_16x16x32_bf16 v[184:187], a[48:51], a[104:107], 0
    ds_read_b128 a[164:167], v199 offset:53248
    ds_read_b128 a[168:171], v198 offset:55296
    v_mfma_f32_16x16x32_bf16 v[184:187], a[52:55], a[108:111], v[184:187]
    ds_read_b128 a[172:175], v199 offset:55296
    v_mfma_f32_16x16x32_bf16 v[172:175], a[40:43], a[104:107], 0
    ds_read_b64_tr_b16 a[208:209], v202 offset:40960
    ds_read_b64_tr_b16 a[210:211], v202 offset:41472
    v_mfma_f32_16x16x32_bf16 v[172:175], a[44:47], a[108:111], v[172:175]
    ds_read_b64_tr_b16 a[212:213], v202 offset:45056
    v_mfma_f32_16x16x32_bf16 v[168:171], a[32:35], a[104:107], 0
    ds_read_b64_tr_b16 a[214:215], v202 offset:45568
    v_mfma_f32_16x16x32_bf16 v[168:171], a[36:39], a[108:111], v[168:171]
    ds_read_b64_tr_b16 a[216:217], v203 offset:40960
    ds_read_b64_tr_b16 a[218:219], v203 offset:41472
    v_mfma_f32_16x16x32_bf16 v[156:159], a[24:27], a[104:107], 0
    ds_read_b64_tr_b16 a[220:221], v203 offset:45056
    v_mfma_f32_16x16x32_bf16 v[156:159], a[28:31], a[108:111], v[156:159]
    ds_read_b64_tr_b16 a[222:223], v203 offset:45568
    v_mfma_f32_16x16x32_bf16 v[152:155], a[16:19], a[104:107], 0
    v_mfma_f32_16x16x32_bf16 v[152:155], a[20:23], a[108:111], v[152:155]
    v_mfma_f32_16x16x32_bf16 v[140:143], a[8:11], a[104:107], 0
    v_mfma_f32_16x16x32_bf16 v[140:143], a[12:15], a[108:111], v[140:143]
    v_mfma_f32_16x16x32_bf16 v[136:139], a[0:3], a[104:107], 0
    v_mfma_f32_16x16x32_bf16 v[136:139], a[4:7], a[108:111], v[136:139]
    s_waitcnt lgkmcnt(0)
    s_barrier
    v_mfma_f32_16x16x32_bf16 v[0:3], a[176:179], a[112:115], v[0:3]
    s_add_u32 m0, s26, 57344
    s_mov_b32 s28, 788480
    v_mfma_f32_16x16x32_bf16 v[0:3], a[180:183], a[116:119], v[0:3]
    buffer_load_dwordx4 v196, s[12:15], s28 offen offset:0  lds
    v_mfma_f32_16x16x32_bf16 v[8:11], a[176:179], a[120:123], v[8:11]
    v_mfma_f32_16x16x32_bf16 v[8:11], a[180:183], a[124:127], v[8:11]
    v_mfma_f32_16x16x32_bf16 v[16:19], a[176:179], a[128:131], v[16:19]
    v_mfma_f32_16x16x32_bf16 v[16:19], a[180:183], a[132:135], v[16:19]
    buffer_load_dwordx4 v197, s[12:15], s28 offen offset:1024  lds
    v_mfma_f32_16x16x32_bf16 v[24:27], a[176:179], a[136:139], v[24:27]
    v_mfma_f32_16x16x32_bf16 v[24:27], a[180:183], a[140:143], v[24:27]
    v_mfma_f32_16x16x32_bf16 v[32:35], a[176:179], a[144:147], v[32:35]
    s_add_u32 m0, s25, 81920
    s_mov_b32 s27, 131328
    v_mfma_f32_16x16x32_bf16 v[32:35], a[180:183], a[148:151], v[32:35]
    buffer_load_dwordx4 v192, s[8:11], s27 offen offset:0  lds
    v_mfma_f32_16x16x32_bf16 v[40:43], a[176:179], a[152:155], v[40:43]
    v_mfma_f32_16x16x32_bf16 v[40:43], a[180:183], a[156:159], v[40:43]
    v_mfma_f32_16x16x32_bf16 v[48:51], a[176:179], a[160:163], v[48:51]
    v_mfma_f32_16x16x32_bf16 v[48:51], a[180:183], a[164:167], v[48:51]
    buffer_load_dwordx4 v193, s[8:11], s27 offen offset:1024  lds
    v_mfma_f32_16x16x32_bf16 v[56:59], a[176:179], a[168:171], v[56:59]
    v_mfma_f32_16x16x32_bf16 v[56:59], a[180:183], a[172:175], v[56:59]
    v_mfma_f32_16x16x32_bf16 v[60:63], a[184:187], a[168:171], v[60:63]
    v_mfma_f32_16x16x32_bf16 v[60:63], a[188:191], a[172:175], v[60:63]
    buffer_load_dwordx4 v194, s[8:11], s27 offen offset:2048  lds
    v_mfma_f32_16x16x32_bf16 v[52:55], a[184:187], a[160:163], v[52:55]
    v_mfma_f32_16x16x32_bf16 v[52:55], a[188:191], a[164:167], v[52:55]
    v_mfma_f32_16x16x32_bf16 v[44:47], a[184:187], a[152:155], v[44:47]
    v_mfma_f32_16x16x32_bf16 v[44:47], a[188:191], a[156:159], v[44:47]
    buffer_load_dwordx4 v195, s[8:11], s27 offen offset:3072  lds
    v_mfma_f32_16x16x32_bf16 v[36:39], a[184:187], a[144:147], v[36:39]
    v_mfma_f32_16x16x32_bf16 v[36:39], a[188:191], a[148:151], v[36:39]
    v_mfma_f32_16x16x32_bf16 v[28:31], a[184:187], a[136:139], v[28:31]
    s_add_u32 m0, s26, 0
    s_mov_b32 s28, 790528
    v_mfma_f32_16x16x32_bf16 v[28:31], a[188:191], a[140:143], v[28:31]
    buffer_load_dwordx4 v196, s[12:15], s28 offen offset:0  lds
    v_mfma_f32_16x16x32_bf16 v[20:23], a[184:187], a[128:131], v[20:23]
    v_mfma_f32_16x16x32_bf16 v[20:23], a[188:191], a[132:135], v[20:23]
    v_mfma_f32_16x16x32_bf16 v[12:15], a[184:187], a[120:123], v[12:15]
    v_mfma_f32_16x16x32_bf16 v[12:15], a[188:191], a[124:127], v[12:15]
    buffer_load_dwordx4 v197, s[12:15], s28 offen offset:1024  lds
    v_mfma_f32_16x16x32_bf16 v[4:7], a[184:187], a[112:115], v[4:7]
    v_mfma_f32_16x16x32_bf16 v[4:7], a[188:191], a[116:119], v[4:7]
    v_mfma_f32_16x16x32_bf16 v[64:67], a[192:195], a[112:115], v[64:67]
    s_add_u32 m0, s26, 8192
    s_mov_b32 s28, 1179648
    v_mfma_f32_16x16x32_bf16 v[64:67], a[196:199], a[116:119], v[64:67]
    buffer_load_dwordx4 v196, s[12:15], s28 offen offset:0  lds
    v_mfma_f32_16x16x32_bf16 v[72:75], a[192:195], a[120:123], v[72:75]
    v_mfma_f32_16x16x32_bf16 v[72:75], a[196:199], a[124:127], v[72:75]
    v_mfma_f32_16x16x32_bf16 v[80:83], a[192:195], a[128:131], v[80:83]
    v_mfma_f32_16x16x32_bf16 v[80:83], a[196:199], a[132:135], v[80:83]
    buffer_load_dwordx4 v197, s[12:15], s28 offen offset:1024  lds
    v_mfma_f32_16x16x32_bf16 v[88:91], a[192:195], a[136:139], v[88:91]
    v_mfma_f32_16x16x32_bf16 v[88:91], a[196:199], a[140:143], v[88:91]
    v_mfma_f32_16x16x32_bf16 v[96:99], a[192:195], a[144:147], v[96:99]
    s_add_u32 m0, s25, 0
    s_mov_b32 s27, 384
    v_mfma_f32_16x16x32_bf16 v[96:99], a[196:199], a[148:151], v[96:99]
    buffer_load_dwordx4 v192, s[8:11], s27 offen offset:0  lds
    v_mfma_f32_16x16x32_bf16 v[104:107], a[192:195], a[152:155], v[104:107]
    v_mfma_f32_16x16x32_bf16 v[104:107], a[196:199], a[156:159], v[104:107]
    v_mfma_f32_16x16x32_bf16 v[112:115], a[192:195], a[160:163], v[112:115]
    v_mfma_f32_16x16x32_bf16 v[112:115], a[196:199], a[164:167], v[112:115]
    buffer_load_dwordx4 v193, s[8:11], s27 offen offset:1024  lds
    v_mfma_f32_16x16x32_bf16 v[120:123], a[192:195], a[168:171], v[120:123]
    v_mfma_f32_16x16x32_bf16 v[120:123], a[196:199], a[172:175], v[120:123]
    v_mfma_f32_16x16x32_bf16 v[124:127], a[200:203], a[168:171], v[124:127]
    v_mfma_f32_16x16x32_bf16 v[124:127], a[204:207], a[172:175], v[124:127]
    buffer_load_dwordx4 v194, s[8:11], s27 offen offset:2048  lds
    v_mfma_f32_16x16x32_bf16 v[116:119], a[200:203], a[160:163], v[116:119]
    v_mfma_f32_16x16x32_bf16 v[116:119], a[204:207], a[164:167], v[116:119]
    v_mfma_f32_16x16x32_bf16 v[108:111], a[200:203], a[152:155], v[108:111]
    v_mfma_f32_16x16x32_bf16 v[108:111], a[204:207], a[156:159], v[108:111]
    buffer_load_dwordx4 v195, s[8:11], s27 offen offset:3072  lds
    v_mfma_f32_16x16x32_bf16 v[100:103], a[200:203], a[144:147], v[100:103]
    v_mfma_f32_16x16x32_bf16 v[100:103], a[204:207], a[148:151], v[100:103]
    v_mfma_f32_16x16x32_bf16 v[92:95], a[200:203], a[136:139], v[92:95]
    s_add_u32 m0, s26, 16384
    s_mov_b32 s28, 1181696
    s_waitcnt vmcnt(6)
    s_barrier
    v_mfma_f32_16x16x32_bf16 v[92:95], a[204:207], a[140:143], v[92:95]
    buffer_load_dwordx4 v196, s[12:15], s28 offen offset:0  lds
    ds_read_b64_tr_b16 a[64:65], v202 offset:49152
    ds_read_b64_tr_b16 a[66:67], v202 offset:49664
    v_mfma_f32_16x16x32_bf16 v[84:87], a[200:203], a[128:131], v[84:87]
    ds_read_b64_tr_b16 a[68:69], v202 offset:53248
    v_mfma_f32_16x16x32_bf16 v[84:87], a[204:207], a[132:135], v[84:87]
    ds_read_b64_tr_b16 a[70:71], v202 offset:53760
    v_mfma_f32_16x16x32_bf16 v[76:79], a[200:203], a[120:123], v[76:79]
    ds_read_b64_tr_b16 a[72:73], v203 offset:49152
    v_mfma_f32_16x16x32_bf16 v[76:79], a[204:207], a[124:127], v[76:79]
    buffer_load_dwordx4 v197, s[12:15], s28 offen offset:1024  lds
    ds_read_b64_tr_b16 a[74:75], v203 offset:49664
    ds_read_b64_tr_b16 a[76:77], v203 offset:53248
    v_mfma_f32_16x16x32_bf16 v[68:71], a[200:203], a[112:115], v[68:71]
    ds_read_b64_tr_b16 a[78:79], v203 offset:53760
    v_mfma_f32_16x16x32_bf16 v[68:71], a[204:207], a[116:119], v[68:71]
    ds_read_b128 a[0:3], v200 offset:0
    v_mfma_f32_16x16x32_bf16 v[128:131], a[112:115], a[208:211], v[128:131]
    s_mov_b32 s35, 1572864
    ds_read_b128 a[4:7], v201 offset:0
    v_mfma_f32_16x16x32_bf16 v[128:131], a[116:119], a[212:215], v[128:131]
    buffer_load_dword v206, v208, s[12:15], s35 offen
    ds_read_b128 a[8:11], v200 offset:2048
    v_mfma_f32_16x16x32_bf16 v[132:135], a[120:123], a[208:211], v[132:135]
    ds_read_b128 a[12:15], v201 offset:2048
    ds_read_b128 a[16:19], v200 offset:4096
    v_mfma_f32_16x16x32_bf16 v[132:135], a[124:127], a[212:215], v[132:135]
    ds_read_b128 a[20:23], v201 offset:4096
    v_mfma_f32_16x16x32_bf16 v[144:147], a[128:131], a[208:211], v[144:147]
    s_mov_b32 s35, 512
    ds_read_b128 a[24:27], v200 offset:6144
    v_mfma_f32_16x16x32_bf16 v[144:147], a[132:135], a[212:215], v[144:147]
    buffer_load_dword v206, v207, s[8:11], s35 offen
    ds_read_b128 a[28:31], v201 offset:6144
    v_mfma_f32_16x16x32_bf16 v[148:151], a[136:139], a[208:211], v[148:151]
    ds_read_b64_tr_b16 a[80:81], v202 offset:57344
    v_mfma_f32_16x16x32_bf16 v[148:151], a[140:143], a[212:215], v[148:151]
    ds_read_b64_tr_b16 a[82:83], v202 offset:57856
    ds_read_b64_tr_b16 a[84:85], v202 offset:61440
    v_mfma_f32_16x16x32_bf16 v[160:163], a[144:147], a[208:211], v[160:163]
    ds_read_b64_tr_b16 a[86:87], v202 offset:61952
    v_mfma_f32_16x16x32_bf16 v[160:163], a[148:151], a[212:215], v[160:163]
    ds_read_b64_tr_b16 a[88:89], v203 offset:57344
    v_mfma_f32_16x16x32_bf16 v[164:167], a[152:155], a[208:211], v[164:167]
    ds_read_b64_tr_b16 a[90:91], v203 offset:57856
    v_mfma_f32_16x16x32_bf16 v[164:167], a[156:159], a[212:215], v[164:167]
    ds_read_b64_tr_b16 a[92:93], v203 offset:61440
    ds_read_b64_tr_b16 a[94:95], v203 offset:61952
    v_mfma_f32_16x16x32_bf16 v[176:179], a[160:163], a[208:211], v[176:179]
    ds_read_b128 a[32:35], v200 offset:16384
    v_mfma_f32_16x16x32_bf16 v[176:179], a[164:167], a[212:215], v[176:179]
    ds_read_b128 a[36:39], v201 offset:16384
    v_mfma_f32_16x16x32_bf16 v[180:183], a[168:171], a[208:211], v[180:183]
    ds_read_b128 a[40:43], v200 offset:18432
    v_mfma_f32_16x16x32_bf16 v[180:183], a[172:175], a[212:215], v[180:183]
    ds_read_b128 a[44:47], v201 offset:18432
    v_mfma_f32_16x16x32_bf16 v[188:191], a[168:171], a[216:219], v[188:191]
    ds_read_b128 a[48:51], v200 offset:20480
    ds_read_b128 a[52:55], v201 offset:20480
    v_mfma_f32_16x16x32_bf16 v[188:191], a[172:175], a[220:223], v[188:191]
    ds_read_b128 a[56:59], v200 offset:22528
    v_mfma_f32_16x16x32_bf16 v[184:187], a[160:163], a[216:219], v[184:187]
    ds_read_b128 a[60:63], v201 offset:22528
    v_mfma_f32_16x16x32_bf16 v[184:187], a[164:167], a[220:223], v[184:187]
    ds_read_b64_tr_b16 a[96:97], v202 offset:0
    v_mfma_f32_16x16x32_bf16 v[172:175], a[152:155], a[216:219], v[172:175]
    ds_read_b64_tr_b16 a[98:99], v202 offset:512
    v_mfma_f32_16x16x32_bf16 v[172:175], a[156:159], a[220:223], v[172:175]
    ds_read_b64_tr_b16 a[100:101], v202 offset:4096
    ds_read_b64_tr_b16 a[102:103], v202 offset:4608
    v_mfma_f32_16x16x32_bf16 v[168:171], a[144:147], a[216:219], v[168:171]
    ds_read_b64_tr_b16 a[104:105], v203 offset:0
    v_mfma_f32_16x16x32_bf16 v[168:171], a[148:151], a[220:223], v[168:171]
    ds_read_b64_tr_b16 a[106:107], v203 offset:512
    v_mfma_f32_16x16x32_bf16 v[156:159], a[136:139], a[216:219], v[156:159]
    ds_read_b64_tr_b16 a[108:109], v203 offset:4096
    v_mfma_f32_16x16x32_bf16 v[156:159], a[140:143], a[220:223], v[156:159]
    ds_read_b64_tr_b16 a[110:111], v203 offset:4608
    v_mfma_f32_16x16x32_bf16 v[152:155], a[128:131], a[216:219], v[152:155]
    v_mfma_f32_16x16x32_bf16 v[152:155], a[132:135], a[220:223], v[152:155]
    v_mfma_f32_16x16x32_bf16 v[140:143], a[120:123], a[216:219], v[140:143]
    v_mfma_f32_16x16x32_bf16 v[140:143], a[124:127], a[220:223], v[140:143]
    v_mfma_f32_16x16x32_bf16 v[136:139], a[112:115], a[216:219], v[136:139]
    v_mfma_f32_16x16x32_bf16 v[136:139], a[116:119], a[220:223], v[136:139]
    s_waitcnt lgkmcnt(0)
    s_barrier
    v_mfma_f32_16x16x32_bf16 v[0:3], a[64:67], a[0:3], v[0:3]
    s_add_u32 m0, s25, 16384
    s_mov_b32 s27, 131456
    v_mfma_f32_16x16x32_bf16 v[0:3], a[68:71], a[4:7], v[0:3]
    buffer_load_dwordx4 v192, s[8:11], s27 offen offset:0  lds
    v_mfma_f32_16x16x32_bf16 v[8:11], a[64:67], a[8:11], v[8:11]
    v_mfma_f32_16x16x32_bf16 v[8:11], a[68:71], a[12:15], v[8:11]
    v_mfma_f32_16x16x32_bf16 v[16:19], a[64:67], a[16:19], v[16:19]
    v_mfma_f32_16x16x32_bf16 v[16:19], a[68:71], a[20:23], v[16:19]
    buffer_load_dwordx4 v193, s[8:11], s27 offen offset:1024  lds
    v_mfma_f32_16x16x32_bf16 v[24:27], a[64:67], a[24:27], v[24:27]
    v_mfma_f32_16x16x32_bf16 v[24:27], a[68:71], a[28:31], v[24:27]
    v_mfma_f32_16x16x32_bf16 v[32:35], a[64:67], a[32:35], v[32:35]
    v_mfma_f32_16x16x32_bf16 v[32:35], a[68:71], a[36:39], v[32:35]
    buffer_load_dwordx4 v194, s[8:11], s27 offen offset:2048  lds
    v_mfma_f32_16x16x32_bf16 v[40:43], a[64:67], a[40:43], v[40:43]
    v_mfma_f32_16x16x32_bf16 v[40:43], a[68:71], a[44:47], v[40:43]
    v_mfma_f32_16x16x32_bf16 v[48:51], a[64:67], a[48:51], v[48:51]
    v_mfma_f32_16x16x32_bf16 v[48:51], a[68:71], a[52:55], v[48:51]
    buffer_load_dwordx4 v195, s[8:11], s27 offen offset:3072  lds
    v_mfma_f32_16x16x32_bf16 v[56:59], a[64:67], a[56:59], v[56:59]
    v_mfma_f32_16x16x32_bf16 v[56:59], a[68:71], a[60:63], v[56:59]
    v_mfma_f32_16x16x32_bf16 v[60:63], a[72:75], a[56:59], v[60:63]
    s_add_u32 m0, s26, 24576
    s_mov_b32 s28, 1183744
    v_mfma_f32_16x16x32_bf16 v[60:63], a[76:79], a[60:63], v[60:63]
    buffer_load_dwordx4 v196, s[12:15], s28 offen offset:0  lds
    v_mfma_f32_16x16x32_bf16 v[52:55], a[72:75], a[48:51], v[52:55]
    v_mfma_f32_16x16x32_bf16 v[52:55], a[76:79], a[52:55], v[52:55]
    v_mfma_f32_16x16x32_bf16 v[44:47], a[72:75], a[40:43], v[44:47]
    v_mfma_f32_16x16x32_bf16 v[44:47], a[76:79], a[44:47], v[44:47]
    buffer_load_dwordx4 v197, s[12:15], s28 offen offset:1024  lds
    v_mfma_f32_16x16x32_bf16 v[36:39], a[72:75], a[32:35], v[36:39]
    v_mfma_f32_16x16x32_bf16 v[36:39], a[76:79], a[36:39], v[36:39]
    v_mfma_f32_16x16x32_bf16 v[28:31], a[72:75], a[24:27], v[28:31]
    s_add_u32 m0, s26, 32768
    s_mov_b32 s28, 1572864
    v_mfma_f32_16x16x32_bf16 v[28:31], a[76:79], a[28:31], v[28:31]
    buffer_load_dwordx4 v196, s[12:15], s28 offen offset:0  lds
    v_mfma_f32_16x16x32_bf16 v[20:23], a[72:75], a[16:19], v[20:23]
    v_mfma_f32_16x16x32_bf16 v[20:23], a[76:79], a[20:23], v[20:23]
    v_mfma_f32_16x16x32_bf16 v[12:15], a[72:75], a[8:11], v[12:15]
    v_mfma_f32_16x16x32_bf16 v[12:15], a[76:79], a[12:15], v[12:15]
    buffer_load_dwordx4 v197, s[12:15], s28 offen offset:1024  lds
    v_mfma_f32_16x16x32_bf16 v[4:7], a[72:75], a[0:3], v[4:7]
    v_mfma_f32_16x16x32_bf16 v[4:7], a[76:79], a[4:7], v[4:7]
    v_mfma_f32_16x16x32_bf16 v[64:67], a[80:83], a[0:3], v[64:67]
    s_add_u32 m0, s25, 32768
    s_mov_b32 s27, 512
    v_mfma_f32_16x16x32_bf16 v[64:67], a[84:87], a[4:7], v[64:67]
    buffer_load_dwordx4 v192, s[8:11], s27 offen offset:0  lds
    v_mfma_f32_16x16x32_bf16 v[72:75], a[80:83], a[8:11], v[72:75]
    v_mfma_f32_16x16x32_bf16 v[72:75], a[84:87], a[12:15], v[72:75]
    v_mfma_f32_16x16x32_bf16 v[80:83], a[80:83], a[16:19], v[80:83]
    v_mfma_f32_16x16x32_bf16 v[80:83], a[84:87], a[20:23], v[80:83]
    buffer_load_dwordx4 v193, s[8:11], s27 offen offset:1024  lds
    v_mfma_f32_16x16x32_bf16 v[88:91], a[80:83], a[24:27], v[88:91]
    v_mfma_f32_16x16x32_bf16 v[88:91], a[84:87], a[28:31], v[88:91]
    v_mfma_f32_16x16x32_bf16 v[96:99], a[80:83], a[32:35], v[96:99]
    v_mfma_f32_16x16x32_bf16 v[96:99], a[84:87], a[36:39], v[96:99]
    buffer_load_dwordx4 v194, s[8:11], s27 offen offset:2048  lds
    v_mfma_f32_16x16x32_bf16 v[104:107], a[80:83], a[40:43], v[104:107]
    v_mfma_f32_16x16x32_bf16 v[104:107], a[84:87], a[44:47], v[104:107]
    v_mfma_f32_16x16x32_bf16 v[112:115], a[80:83], a[48:51], v[112:115]
    v_mfma_f32_16x16x32_bf16 v[112:115], a[84:87], a[52:55], v[112:115]
    buffer_load_dwordx4 v195, s[8:11], s27 offen offset:3072  lds
    v_mfma_f32_16x16x32_bf16 v[120:123], a[80:83], a[56:59], v[120:123]
    v_mfma_f32_16x16x32_bf16 v[120:123], a[84:87], a[60:63], v[120:123]
    v_mfma_f32_16x16x32_bf16 v[124:127], a[88:91], a[56:59], v[124:127]
    s_add_u32 m0, s26, 40960
    s_mov_b32 s28, 1574912
    v_mfma_f32_16x16x32_bf16 v[124:127], a[92:95], a[60:63], v[124:127]
    buffer_load_dwordx4 v196, s[12:15], s28 offen offset:0  lds
    v_mfma_f32_16x16x32_bf16 v[116:119], a[88:91], a[48:51], v[116:119]
    s_waitcnt vmcnt(7)
    s_barrier
    v_mfma_f32_16x16x32_bf16 v[116:119], a[92:95], a[52:55], v[116:119]
    ds_read_b64_tr_b16 a[176:177], v202 offset:8192
    ds_read_b64_tr_b16 a[178:179], v202 offset:8704
    v_mfma_f32_16x16x32_bf16 v[108:111], a[88:91], a[40:43], v[108:111]
    ds_read_b64_tr_b16 a[180:181], v202 offset:12288
    v_mfma_f32_16x16x32_bf16 v[108:111], a[92:95], a[44:47], v[108:111]
    buffer_load_dwordx4 v197, s[12:15], s28 offen offset:1024  lds
    ds_read_b64_tr_b16 a[182:183], v202 offset:12800
    v_mfma_f32_16x16x32_bf16 v[100:103], a[88:91], a[32:35], v[100:103]
    ds_read_b64_tr_b16 a[184:185], v203 offset:8192
    v_mfma_f32_16x16x32_bf16 v[100:103], a[92:95], a[36:39], v[100:103]
    ds_read_b64_tr_b16 a[186:187], v203 offset:8704
    v_mfma_f32_16x16x32_bf16 v[92:95], a[88:91], a[24:27], v[92:95]
    s_add_u32 m0, s25, 49152
    s_mov_b32 s27, 131584
    ds_read_b64_tr_b16 a[188:189], v203 offset:12288
    v_mfma_f32_16x16x32_bf16 v[92:95], a[92:95], a[28:31], v[92:95]
    buffer_load_dwordx4 v192, s[8:11], s27 offen offset:0  lds
    ds_read_b64_tr_b16 a[190:191], v203 offset:12800
    v_mfma_f32_16x16x32_bf16 v[84:87], a[88:91], a[16:19], v[84:87]
    ds_read_b128 a[112:115], v198 offset:0
    v_mfma_f32_16x16x32_bf16 v[84:87], a[92:95], a[20:23], v[84:87]
    ds_read_b128 a[116:119], v199 offset:0
    v_mfma_f32_16x16x32_bf16 v[76:79], a[88:91], a[8:11], v[76:79]
    ds_read_b128 a[120:123], v198 offset:2048
    v_mfma_f32_16x16x32_bf16 v[76:79], a[92:95], a[12:15], v[76:79]
    buffer_load_dwordx4 v193, s[8:11], s27 offen offset:1024  lds
    ds_read_b128 a[124:127], v199 offset:2048
    v_mfma_f32_16x16x32_bf16 v[68:71], a[88:91], a[0:3], v[68:71]
    ds_read_b128 a[128:131], v198 offset:4096
    v_mfma_f32_16x16x32_bf16 v[68:71], a[92:95], a[4:7], v[68:71]
    ds_read_b128 a[132:135], v199 offset:4096
    v_mfma_f32_16x16x32_bf16 v[128:131], a[0:3], a[96:99], v[128:131]
    ds_read_b128 a[136:139], v198 offset:6144
    v_mfma_f32_16x16x32_bf16 v[128:131], a[4:7], a[100:103], v[128:131]
    buffer_load_dwordx4 v194, s[8:11], s27 offen offset:2048  lds
    ds_read_b128 a[140:143], v199 offset:6144
    v_mfma_f32_16x16x32_bf16 v[132:135], a[8:11], a[96:99], v[132:135]
    ds_read_b64_tr_b16 a[192:193], v202 offset:16384
    v_mfma_f32_16x16x32_bf16 v[132:135], a[12:15], a[100:103], v[132:135]
    ds_read_b64_tr_b16 a[194:195], v202 offset:16896
    v_mfma_f32_16x16x32_bf16 v[144:147], a[16:19], a[96:99], v[144:147]
    ds_read_b64_tr_b16 a[196:197], v202 offset:20480
    v_mfma_f32_16x16x32_bf16 v[144:147], a[20:23], a[100:103], v[144:147]
    buffer_load_dwordx4 v195, s[8:11], s27 offen offset:3072  lds
    ds_read_b64_tr_b16 a[198:199], v202 offset:20992
    v_mfma_f32_16x16x32_bf16 v[148:151], a[24:27], a[96:99], v[148:151]
    ds_read_b64_tr_b16 a[200:201], v203 offset:16384
    v_mfma_f32_16x16x32_bf16 v[148:151], a[28:31], a[100:103], v[148:151]
    ds_read_b64_tr_b16 a[202:203], v203 offset:16896
    v_mfma_f32_16x16x32_bf16 v[160:163], a[32:35], a[96:99], v[160:163]
    s_mov_b32 s35, 2359296
    ds_read_b64_tr_b16 a[204:205], v203 offset:20480
L_pg0:
    s_cbranch_execz L_pg1
    v_mfma_f32_16x16x32_bf16 v[160:163], a[36:39], a[100:103], v[160:163]
    buffer_load_dword v206, v208, s[12:15], s35 offen
    ds_read_b64_tr_b16 a[206:207], v203 offset:20992
    v_mfma_f32_16x16x32_bf16 v[164:167], a[40:43], a[96:99], v[164:167]
    ds_read_b128 a[144:147], v198 offset:16384
    v_mfma_f32_16x16x32_bf16 v[164:167], a[44:47], a[100:103], v[164:167]
    ds_read_b128 a[148:151], v199 offset:16384
    v_mfma_f32_16x16x32_bf16 v[176:179], a[48:51], a[96:99], v[176:179]
    s_mov_b32 s35, 768
    ds_read_b128 a[152:155], v198 offset:18432
    v_mfma_f32_16x16x32_bf16 v[176:179], a[52:55], a[100:103], v[176:179]
    buffer_load_dword v206, v207, s[8:11], s35 offen
    ds_read_b128 a[156:159], v199 offset:18432
    v_mfma_f32_16x16x32_bf16 v[180:183], a[56:59], a[96:99], v[180:183]
    ds_read_b128 a[160:163], v198 offset:20480
    v_mfma_f32_16x16x32_bf16 v[180:183], a[60:63], a[100:103], v[180:183]
    ds_read_b128 a[164:167], v199 offset:20480
    v_mfma_f32_16x16x32_bf16 v[188:191], a[56:59], a[104:107], v[188:191]
    ds_read_b128 a[168:171], v198 offset:22528
    v_mfma_f32_16x16x32_bf16 v[188:191], a[60:63], a[108:111], v[188:191]
    ds_read_b128 a[172:175], v199 offset:22528
    v_mfma_f32_16x16x32_bf16 v[184:187], a[48:51], a[104:107], v[184:187]
    ds_read_b64_tr_b16 a[208:209], v202 offset:24576
    v_mfma_f32_16x16x32_bf16 v[184:187], a[52:55], a[108:111], v[184:187]
    ds_read_b64_tr_b16 a[210:211], v202 offset:25088
    v_mfma_f32_16x16x32_bf16 v[172:175], a[40:43], a[104:107], v[172:175]
    ds_read_b64_tr_b16 a[212:213], v202 offset:28672
    v_mfma_f32_16x16x32_bf16 v[172:175], a[44:47], a[108:111], v[172:175]
    ds_read_b64_tr_b16 a[214:215], v202 offset:29184
    v_mfma_f32_16x16x32_bf16 v[168:171], a[32:35], a[104:107], v[168:171]
    ds_read_b64_tr_b16 a[216:217], v203 offset:24576
    v_mfma_f32_16x16x32_bf16 v[168:171], a[36:39], a[108:111], v[168:171]
    ds_read_b64_tr_b16 a[218:219], v203 offset:25088
    v_mfma_f32_16x16x32_bf16 v[156:159], a[24:27], a[104:107], v[156:159]
    ds_read_b64_tr_b16 a[220:221], v203 offset:28672
    v_mfma_f32_16x16x32_bf16 v[156:159], a[28:31], a[108:111], v[156:159]
    ds_read_b64_tr_b16 a[222:223], v203 offset:29184
    v_mfma_f32_16x16x32_bf16 v[152:155], a[16:19], a[104:107], v[152:155]
    v_mfma_f32_16x16x32_bf16 v[152:155], a[20:23], a[108:111], v[152:155]
    v_mfma_f32_16x16x32_bf16 v[140:143], a[8:11], a[104:107], v[140:143]
    v_mfma_f32_16x16x32_bf16 v[140:143], a[12:15], a[108:111], v[140:143]
    v_mfma_f32_16x16x32_bf16 v[136:139], a[0:3], a[104:107], v[136:139]
    v_mfma_f32_16x16x32_bf16 v[136:139], a[4:7], a[108:111], v[136:139]
    s_waitcnt lgkmcnt(0)
    s_barrier
    v_mfma_f32_16x16x32_bf16 v[0:3], a[176:179], a[112:115], v[0:3]
    s_add_u32 m0, s26, 49152
    s_mov_b32 s28, 1576960
    v_mfma_f32_16x16x32_bf16 v[0:3], a[180:183], a[116:119], v[0:3]
    buffer_load_dwordx4 v196, s[12:15], s28 offen offset:0  lds
    v_mfma_f32_16x16x32_bf16 v[8:11], a[176:179], a[120:123], v[8:11]
    v_mfma_f32_16x16x32_bf16 v[8:11], a[180:183], a[124:127], v[8:11]
    v_mfma_f32_16x16x32_bf16 v[16:19], a[176:179], a[128:131], v[16:19]
    v_mfma_f32_16x16x32_bf16 v[16:19], a[180:183], a[132:135], v[16:19]
    buffer_load_dwordx4 v197, s[12:15], s28 offen offset:1024  lds
    v_mfma_f32_16x16x32_bf16 v[24:27], a[176:179], a[136:139], v[24:27]
    v_mfma_f32_16x16x32_bf16 v[24:27], a[180:183], a[140:143], v[24:27]
    v_mfma_f32_16x16x32_bf16 v[32:35], a[176:179], a[144:147], v[32:35]
    s_add_u32 m0, s26, 57344
    s_mov_b32 s28, 1966080
    v_mfma_f32_16x16x32_bf16 v[32:35], a[180:183], a[148:151], v[32:35]
    buffer_load_dwordx4 v196, s[12:15], s28 offen offset:0  lds
    v_mfma_f32_16x16x32_bf16 v[40:43], a[176:179], a[152:155], v[40:43]
    v_mfma_f32_16x16x32_bf16 v[40:43], a[180:183], a[156:159], v[40:43]
    v_mfma_f32_16x16x32_bf16 v[48:51], a[176:179], a[160:163], v[48:51]
    v_mfma_f32_16x16x32_bf16 v[48:51], a[180:183], a[164:167], v[48:51]
    buffer_load_dwordx4 v197, s[12:15], s28 offen offset:1024  lds
    v_mfma_f32_16x16x32_bf16 v[56:59], a[176:179], a[168:171], v[56:59]
    v_mfma_f32_16x16x32_bf16 v[56:59], a[180:183], a[172:175], v[56:59]
    v_mfma_f32_16x16x32_bf16 v[60:63], a[184:187], a[168:171], v[60:63]
    s_add_u32 m0, s25, 65536
    s_mov_b32 s27, 640
    v_mfma_f32_16x16x32_bf16 v[60:63], a[188:191], a[172:175], v[60:63]
    buffer_load_dwordx4 v192, s[8:11], s27 offen offset:0  lds
    v_mfma_f32_16x16x32_bf16 v[52:55], a[184:187], a[160:163], v[52:55]
    v_mfma_f32_16x16x32_bf16 v[52:55], a[188:191], a[164:167], v[52:55]
    v_mfma_f32_16x16x32_bf16 v[44:47], a[184:187], a[152:155], v[44:47]
    v_mfma_f32_16x16x32_bf16 v[44:47], a[188:191], a[156:159], v[44:47]
    buffer_load_dwordx4 v193, s[8:11], s27 offen offset:1024  lds
    v_mfma_f32_16x16x32_bf16 v[36:39], a[184:187], a[144:147], v[36:39]
    v_mfma_f32_16x16x32_bf16 v[36:39], a[188:191], a[148:151], v[36:39]
    v_mfma_f32_16x16x32_bf16 v[28:31], a[184:187], a[136:139], v[28:31]
    v_mfma_f32_16x16x32_bf16 v[28:31], a[188:191], a[140:143], v[28:31]
    buffer_load_dwordx4 v194, s[8:11], s27 offen offset:2048  lds
    v_mfma_f32_16x16x32_bf16 v[20:23], a[184:187], a[128:131], v[20:23]
    v_mfma_f32_16x16x32_bf16 v[20:23], a[188:191], a[132:135], v[20:23]
    v_mfma_f32_16x16x32_bf16 v[12:15], a[184:187], a[120:123], v[12:15]
    v_mfma_f32_16x16x32_bf16 v[12:15], a[188:191], a[124:127], v[12:15]
    buffer_load_dwordx4 v195, s[8:11], s27 offen offset:3072  lds
    v_mfma_f32_16x16x32_bf16 v[4:7], a[184:187], a[112:115], v[4:7]
    v_mfma_f32_16x16x32_bf16 v[4:7], a[188:191], a[116:119], v[4:7]
    v_mfma_f32_16x16x32_bf16 v[64:67], a[192:195], a[112:115], v[64:67]
    s_add_u32 m0, s26, 0
    s_mov_b32 s28, 1968128
    v_mfma_f32_16x16x32_bf16 v[64:67], a[196:199], a[116:119], v[64:67]
    buffer_load_dwordx4 v196, s[12:15], s28 offen offset:0  lds
    v_mfma_f32_16x16x32_bf16 v[72:75], a[192:195], a[120:123], v[72:75]
    v_mfma_f32_16x16x32_bf16 v[72:75], a[196:199], a[124:127], v[72:75]
    v_mfma_f32_16x16x32_bf16 v[80:83], a[192:195], a[128:131], v[80:83]
    v_mfma_f32_16x16x32_bf16 v[80:83], a[196:199], a[132:135], v[80:83]
    buffer_load_dwordx4 v197, s[12:15], s28 offen offset:1024  lds
    v_mfma_f32_16x16x32_bf16 v[88:91], a[192:195], a[136:139], v[88:91]
    v_mfma_f32_16x16x32_bf16 v[88:91], a[196:199], a[140:143], v[88:91]
    v_mfma_f32_16x16x32_bf16 v[96:99], a[192:195], a[144:147], v[96:99]
    s_add_u32 m0, s25, 81920
    s_mov_b32 s27, 131712
    s_waitcnt vmcnt(8)
    s_barrier
    v_mfma_f32_16x16x32_bf16 v[96:99], a[196:199], a[148:151], v[96:99]
    buffer_load_dwordx4 v192, s[8:11], s27 offen offset:0  lds
    ds_read_b64_tr_b16 a[64:65], v202 offset:32768
    v_mfma_f32_16x16x32_bf16 v[104:107], a[192:195], a[152:155], v[104:107]
    ds_read_b64_tr_b16 a[66:67], v202 offset:33280
    v_mfma_f32_16x16x32_bf16 v[104:107], a[196:199], a[156:159], v[104:107]
    ds_read_b64_tr_b16 a[68:69], v202 offset:36864
    v_mfma_f32_16x16x32_bf16 v[112:115], a[192:195], a[160:163], v[112:115]
    ds_read_b64_tr_b16 a[70:71], v202 offset:37376
    v_mfma_f32_16x16x32_bf16 v[112:115], a[196:199], a[164:167], v[112:115]
    buffer_load_dwordx4 v193, s[8:11], s27 offen offset:1024  lds
    ds_read_b64_tr_b16 a[72:73], v203 offset:32768
    v_mfma_f32_16x16x32_bf16 v[120:123], a[192:195], a[168:171], v[120:123]
    v_mfma_f32_16x16x32_bf16 v[120:123], a[196:199], a[172:175], v[120:123]
    ds_read_b64_tr_b16 a[74:75], v203 offset:33280
    v_mfma_f32_16x16x32_bf16 v[124:127], a[200:203], a[168:171], v[124:127]
    ds_read_b64_tr_b16 a[76:77], v203 offset:36864
    v_mfma_f32_16x16x32_bf16 v[124:127], a[204:207], a[172:175], v[124:127]
    buffer_load_dwordx4 v194, s[8:11], s27 offen offset:2048  lds
    ds_read_b64_tr_b16 a[78:79], v203 offset:37376
    v_mfma_f32_16x16x32_bf16 v[116:119], a[200:203], a[160:163], v[116:119]
    ds_read_b128 a[0:3], v198 offset:32768
    v_mfma_f32_16x16x32_bf16 v[116:119], a[204:207], a[164:167], v[116:119]
    v_mfma_f32_16x16x32_bf16 v[108:111], a[200:203], a[152:155], v[108:111]
    ds_read_b128 a[4:7], v199 offset:32768
    v_mfma_f32_16x16x32_bf16 v[108:111], a[204:207], a[156:159], v[108:111]
    buffer_load_dwordx4 v195, s[8:11], s27 offen offset:3072  lds
    ds_read_b128 a[8:11], v198 offset:34816
    v_mfma_f32_16x16x32_bf16 v[100:103], a[200:203], a[144:147], v[100:103]
    ds_read_b128 a[12:15], v199 offset:34816
    v_mfma_f32_16x16x32_bf16 v[100:103], a[204:207], a[148:151], v[100:103]
    ds_read_b128 a[16:19], v198 offset:36864
    v_mfma_f32_16x16x32_bf16 v[92:95], a[200:203], a[136:139], v[92:95]
    s_add_u32 m0, s26, 8192
    s_mov_b32 s28, 1970176
    ds_read_b128 a[20:23], v199 offset:36864
    v_mfma_f32_16x16x32_bf16 v[92:95], a[204:207], a[140:143], v[92:95]
    buffer_load_dwordx4 v196, s[12:15], s28 offen offset:0  lds
    v_mfma_f32_16x16x32_bf16 v[84:87], a[200:203], a[128:131], v[84:87]
    ds_read_b128 a[24:27], v198 offset:38912
    v_mfma_f32_16x16x32_bf16 v[84:87], a[204:207], a[132:135], v[84:87]
    ds_read_b128 a[28:31], v199 offset:38912
    v_mfma_f32_16x16x32_bf16 v[76:79], a[200:203], a[120:123], v[76:79]
    ds_read_b64_tr_b16 a[80:81], v202 offset:40960
    v_mfma_f32_16x16x32_bf16 v[76:79], a[204:207], a[124:127], v[76:79]
    buffer_load_dwordx4 v197, s[12:15], s28 offen offset:1024  lds
    ds_read_b64_tr_b16 a[82:83], v202 offset:41472
    v_mfma_f32_16x16x32_bf16 v[68:71], a[200:203], a[112:115], v[68:71]
    v_mfma_f32_16x16x32_bf16 v[68:71], a[204:207], a[116:119], v[68:71]
    ds_read_b64_tr_b16 a[84:85], v202 offset:45056
    v_mfma_f32_16x16x32_bf16 v[128:131], a[112:115], a[208:211], v[128:131]
    ds_read_b64_tr_b16 a[86:87], v202 offset:45568
    v_mfma_f32_16x16x32_bf16 v[128:131], a[116:119], a[212:215], v[128:131]
    buffer_store_dword v242, off, s[16:19], s71 sc1
    ds_read_b64_tr_b16 a[88:89], v203 offset:40960
    v_mfma_f32_16x16x32_bf16 v[132:135], a[120:123], a[208:211], v[132:135]
    ds_read_b64_tr_b16 a[90:91], v203 offset:41472
    v_mfma_f32_16x16x32_bf16 v[132:135], a[124:127], a[212:215], v[132:135]
    ds_read_b64_tr_b16 a[92:93], v203 offset:45056
    v_mfma_f32_16x16x32_bf16 v[144:147], a[128:131], a[208:211], v[144:147]
    v_mfma_f32_16x16x32_bf16 v[144:147], a[132:135], a[212:215], v[144:147]
    buffer_store_dword v242, v235, s[16:19], s92 offen sc1
    ds_read_b64_tr_b16 a[94:95], v203 offset:45568
    v_mfma_f32_16x16x32_bf16 v[148:151], a[136:139], a[208:211], v[148:151]
    ds_read_b128 a[32:35], v198 offset:49152
    v_mfma_f32_16x16x32_bf16 v[148:151], a[140:143], a[212:215], v[148:151]
    ds_read_b128 a[36:39], v199 offset:49152
    v_mfma_f32_16x16x32_bf16 v[160:163], a[144:147], a[208:211], v[160:163]
    ds_read_b128 a[40:43], v198 offset:51200
    v_mfma_f32_16x16x32_bf16 v[160:163], a[148:151], a[212:215], v[160:163]
    buffer_store_dwordx4 v[244:247], v233, s[16:19], s42 offen offset:0 sc1
    v_mfma_f32_16x16x32_bf16 v[164:167], a[152:155], a[208:211], v[164:167]
    ds_read_b128 a[44:47], v199 offset:51200
    v_mfma_f32_16x16x32_bf16 v[164:167], a[156:159], a[212:215], v[164:167]
    ds_read_b128 a[48:51], v198 offset:53248
    v_mfma_f32_16x16x32_bf16 v[176:179], a[160:163], a[208:211], v[176:179]
    ds_read_b128 a[52:55], v199 offset:53248
    v_mfma_f32_16x16x32_bf16 v[176:179], a[164:167], a[212:215], v[176:179]
    buffer_store_dwordx4 v[244:247], v233, s[16:19], s42 offen offset:1024 sc1
    ds_read_b128 a[56:59], v198 offset:55296
    v_mfma_f32_16x16x32_bf16 v[180:183], a[168:171], a[208:211], v[180:183]
    ds_read_b128 a[60:63], v199 offset:55296
    v_mfma_f32_16x16x32_bf16 v[180:183], a[172:175], a[212:215], v[180:183]
    v_mfma_f32_16x16x32_bf16 v[188:191], a[168:171], a[216:219], v[188:191]
    ds_read_b64_tr_b16 a[96:97], v202 offset:49152
    v_mfma_f32_16x16x32_bf16 v[188:191], a[172:175], a[220:223], v[188:191]
    buffer_store_dword v244, v239, s[16:19], s22 offen sc1
    ds_read_b64_tr_b16 a[98:99], v202 offset:49664
    v_mfma_f32_16x16x32_bf16 v[184:187], a[160:163], a[216:219], v[184:187]
    ds_read_b64_tr_b16 a[100:101], v202 offset:53248
    v_mfma_f32_16x16x32_bf16 v[184:187], a[164:167], a[220:223], v[184:187]
    ds_read_b64_tr_b16 a[102:103], v202 offset:53760
    v_mfma_f32_16x16x32_bf16 v[172:175], a[152:155], a[216:219], v[172:175]
    v_mfma_f32_16x16x32_bf16 v[172:175], a[156:159], a[220:223], v[172:175]
    ds_read_b64_tr_b16 a[104:105], v203 offset:49152
    v_mfma_f32_16x16x32_bf16 v[168:171], a[144:147], a[216:219], v[168:171]
    ds_read_b64_tr_b16 a[106:107], v203 offset:49664
    v_mfma_f32_16x16x32_bf16 v[168:171], a[148:151], a[220:223], v[168:171]
    ds_read_b64_tr_b16 a[108:109], v203 offset:53248
    v_mfma_f32_16x16x32_bf16 v[156:159], a[136:139], a[216:219], v[156:159]
    ds_read_b64_tr_b16 a[110:111], v203 offset:53760
    v_mfma_f32_16x16x32_bf16 v[156:159], a[140:143], a[220:223], v[156:159]
    v_mfma_f32_16x16x32_bf16 v[152:155], a[128:131], a[216:219], v[152:155]
    v_mfma_f32_16x16x32_bf16 v[152:155], a[132:135], a[220:223], v[152:155]
    v_mfma_f32_16x16x32_bf16 v[140:143], a[120:123], a[216:219], v[140:143]
    v_mfma_f32_16x16x32_bf16 v[140:143], a[124:127], a[220:223], v[140:143]
    v_mfma_f32_16x16x32_bf16 v[136:139], a[112:115], a[216:219], v[136:139]
    v_mfma_f32_16x16x32_bf16 v[136:139], a[116:119], a[220:223], v[136:139]
    s_waitcnt lgkmcnt(0)
    s_barrier
    v_mfma_f32_16x16x32_bf16 v[0:3], a[64:67], a[0:3], v[0:3]
    s_add_u32 m0, s26, 16384
    s_mov_b32 s28, 2359296
    v_mfma_f32_16x16x32_bf16 v[0:3], a[68:71], a[4:7], v[0:3]
    buffer_load_dwordx4 v196, s[12:15], s28 offen offset:0  lds
    v_mfma_f32_16x16x32_bf16 v[8:11], a[64:67], a[8:11], v[8:11]
    v_mfma_f32_16x16x32_bf16 v[8:11], a[68:71], a[12:15], v[8:11]
    v_mfma_f32_16x16x32_bf16 v[16:19], a[64:67], a[16:19], v[16:19]
    v_mfma_f32_16x16x32_bf16 v[16:19], a[68:71], a[20:23], v[16:19]
    buffer_load_dwordx4 v197, s[12:15], s28 offen offset:1024  lds
    v_mfma_f32_16x16x32_bf16 v[24:27], a[64:67], a[24:27], v[24:27]
    v_mfma_f32_16x16x32_bf16 v[24:27], a[68:71], a[28:31], v[24:27]
    v_mfma_f32_16x16x32_bf16 v[32:35], a[64:67], a[32:35], v[32:35]
    s_add_u32 m0, s25, 0
    s_mov_b32 s27, 768
    v_mfma_f32_16x16x32_bf16 v[32:35], a[68:71], a[36:39], v[32:35]
    buffer_load_dwordx4 v192, s[8:11], s27 offen offset:0  lds
    v_mfma_f32_16x16x32_bf16 v[40:43], a[64:67], a[40:43], v[40:43]
    v_mfma_f32_16x16x32_bf16 v[40:43], a[68:71], a[44:47], v[40:43]
    v_mfma_f32_16x16x32_bf16 v[48:51], a[64:67], a[48:51], v[48:51]
    v_mfma_f32_16x16x32_bf16 v[48:51], a[68:71], a[52:55], v[48:51]
    buffer_load_dwordx4 v193, s[8:11], s27 offen offset:1024  lds
    v_mfma_f32_16x16x32_bf16 v[56:59], a[64:67], a[56:59], v[56:59]
    v_mfma_f32_16x16x32_bf16 v[56:59], a[68:71], a[60:63], v[56:59]
    v_mfma_f32_16x16x32_bf16 v[60:63], a[72:75], a[56:59], v[60:63]
    v_mfma_f32_16x16x32_bf16 v[60:63], a[76:79], a[60:63], v[60:63]
    buffer_load_dwordx4 v194, s[8:11], s27 offen offset:2048  lds
    v_mfma_f32_16x16x32_bf16 v[52:55], a[72:75], a[48:51], v[52:55]
    v_mfma_f32_16x16x32_bf16 v[52:55], a[76:79], a[52:55], v[52:55]
    v_mfma_f32_16x16x32_bf16 v[44:47], a[72:75], a[40:43], v[44:47]
    v_mfma_f32_16x16x32_bf16 v[44:47], a[76:79], a[44:47], v[44:47]
    buffer_load_dwordx4 v195, s[8:11], s27 offen offset:3072  lds
    v_mfma_f32_16x16x32_bf16 v[36:39], a[72:75], a[32:35], v[36:39]
    v_mfma_f32_16x16x32_bf16 v[36:39], a[76:79], a[36:39], v[36:39]
    v_mfma_f32_16x16x32_bf16 v[28:31], a[72:75], a[24:27], v[28:31]
    s_add_u32 m0, s26, 24576
    s_mov_b32 s28, 2361344
    v_mfma_f32_16x16x32_bf16 v[28:31], a[76:79], a[28:31], v[28:31]
    buffer_load_dwordx4 v196, s[12:15], s28 offen offset:0  lds
    v_mfma_f32_16x16x32_bf16 v[20:23], a[72:75], a[16:19], v[20:23]
    v_mfma_f32_16x16x32_bf16 v[20:23], a[76:79], a[20:23], v[20:23]
    v_mfma_f32_16x16x32_bf16 v[12:15], a[72:75], a[8:11], v[12:15]
    v_mfma_f32_16x16x32_bf16 v[12:15], a[76:79], a[12:15], v[12:15]
    buffer_load_dwordx4 v197, s[12:15], s28 offen offset:1024  lds
    v_mfma_f32_16x16x32_bf16 v[4:7], a[72:75], a[0:3], v[4:7]
    s_waitcnt vmcnt(13)
    s_barrier
    v_mfma_f32_16x16x32_bf16 v[4:7], a[76:79], a[4:7], v[4:7]
    ds_read_b64_tr_b16 a[176:177], v202 offset:57344
    v_mfma_f32_16x16x32_bf16 v[64:67], a[80:83], a[0:3], v[64:67]
    s_add_u32 m0, s25, 16384
    s_mov_b32 s27, 131840
    ds_read_b64_tr_b16 a[178:179], v202 offset:57856
    v_mfma_f32_16x16x32_bf16 v[64:67], a[84:87], a[4:7], v[64:67]
    buffer_load_dwordx4 v192, s[8:11], s27 offen offset:0  lds
    ds_read_b64_tr_b16 a[180:181], v202 offset:61440
    v_mfma_f32_16x16x32_bf16 v[72:75], a[80:83], a[8:11], v[72:75]
    v_mfma_f32_16x16x32_bf16 v[72:75], a[84:87], a[12:15], v[72:75]
    ds_read_b64_tr_b16 a[182:183], v202 offset:61952
    v_mfma_f32_16x16x32_bf16 v[80:83], a[80:83], a[16:19], v[80:83]
    ds_read_b64_tr_b16 a[184:185], v203 offset:57344
    v_mfma_f32_16x16x32_bf16 v[80:83], a[84:87], a[20:23], v[80:83]
    buffer_load_dwordx4 v193, s[8:11], s27 offen offset:1024  lds
    v_mfma_f32_16x16x32_bf16 v[88:91], a[80:83], a[24:27], v[88:91]
    ds_read_b64_tr_b16 a[186:187], v203 offset:57856
    v_mfma_f32_16x16x32_bf16 v[88:91], a[84:87], a[28:31], v[88:91]
    ds_read_b64_tr_b16 a[188:189], v203 offset:61440
    v_mfma_f32_16x16x32_bf16 v[96:99], a[80:83], a[32:35], v[96:99]
    v_mfma_f32_16x16x32_bf16 v[96:99], a[84:87], a[36:39], v[96:99]
    buffer_load_dwordx4 v194, s[8:11], s27 offen offset:2048  lds
    ds_read_b64_tr_b16 a[190:191], v203 offset:61952
    v_mfma_f32_16x16x32_bf16 v[104:107], a[80:83], a[40:43], v[104:107]
    ds_read_b128 a[112:115], v200 offset:0
    v_mfma_f32_16x16x32_bf16 v[104:107], a[84:87], a[44:47], v[104:107]
    v_mfma_f32_16x16x32_bf16 v[112:115], a[80:83], a[48:51], v[112:115]
    ds_read_b128 a[116:119], v201 offset:0
    v_mfma_f32_16x16x32_bf16 v[112:115], a[84:87], a[52:55], v[112:115]
    buffer_load_dwordx4 v195, s[8:11], s27 offen offset:3072  lds
    ds_read_b128 a[120:123], v200 offset:2048
    v_mfma_f32_16x16x32_bf16 v[120:123], a[80:83], a[56:59], v[120:123]
    v_mfma_f32_16x16x32_bf16 v[120:123], a[84:87], a[60:63], v[120:123]
    ds_read_b128 a[124:127], v201 offset:2048
    v_mfma_f32_16x16x32_bf16 v[124:127], a[88:91], a[56:59], v[124:127]
    s_add_u32 m0, s26, 32768
    s_mov_b32 s28, 2363392
    ds_read_b128 a[128:131], v200 offset:4096
    v_mfma_f32_16x16x32_bf16 v[124:127], a[92:95], a[60:63], v[124:127]
    buffer_load_dwordx4 v196, s[12:15], s28 offen offset:0  lds
    v_mfma_f32_16x16x32_bf16 v[116:119], a[88:91], a[48:51], v[116:119]
    ds_read_b128 a[132:135], v201 offset:4096
    v_mfma_f32_16x16x32_bf16 v[116:119], a[92:95], a[52:55], v[116:119]
    ds_read_b128 a[136:139], v200 offset:6144
    v_mfma_f32_16x16x32_bf16 v[108:111], a[88:91], a[40:43], v[108:111]
    v_mfma_f32_16x16x32_bf16 v[108:111], a[92:95], a[44:47], v[108:111]
    buffer_load_dwordx4 v197, s[12:15], s28 offen offset:1024  lds
    ds_read_b128 a[140:143], v201 offset:6144
    v_mfma_f32_16x16x32_bf16 v[100:103], a[88:91], a[32:35], v[100:103]
    ds_read_b64_tr_b16 a[192:193], v202 offset:0
    v_mfma_f32_16x16x32_bf16 v[100:103], a[92:95], a[36:39], v[100:103]
    v_mfma_f32_16x16x32_bf16 v[92:95], a[88:91], a[24:27], v[92:95]
    s_add_u32 m0, s26, 40960
    s_mov_b32 s28, 2752512
    ds_read_b64_tr_b16 a[194:195], v202 offset:512
    v_mfma_f32_16x16x32_bf16 v[92:95], a[92:95], a[28:31], v[92:95]
    buffer_load_dwordx4 v196, s[12:15], s28 offen offset:0  lds
    ds_read_b64_tr_b16 a[196:197], v202 offset:4096
    v_mfma_f32_16x16x32_bf16 v[84:87], a[88:91], a[16:19], v[84:87]
    v_mfma_f32_16x16x32_bf16 v[84:87], a[92:95], a[20:23], v[84:87]
    ds_read_b64_tr_b16 a[198:199], v202 offset:4608
    v_mfma_f32_16x16x32_bf16 v[76:79], a[88:91], a[8:11], v[76:79]
    ds_read_b64_tr_b16 a[200:201], v203 offset:0
    v_mfma_f32_16x16x32_bf16 v[76:79], a[92:95], a[12:15], v[76:79]
    buffer_load_dwordx4 v197, s[12:15], s28 offen offset:1024  lds
    ds_read_b64_tr_b16 a[202:203], v203 offset:512
    v_mfma_f32_16x16x32_bf16 v[68:71], a[88:91], a[0:3], v[68:71]
    v_mfma_f32_16x16x32_bf16 v[68:71], a[92:95], a[4:7], v[68:71]
    ds_read_b64_tr_b16 a[204:205], v203 offset:4096
    v_mfma_f32_16x16x32_bf16 v[128:131], a[0:3], a[96:99], v[128:131]
    s_mov_b32 s35, 3145728
    ds_read_b64_tr_b16 a[206:207], v203 offset:4608
    v_mfma_f32_16x16x32_bf16 v[128:131], a[4:7], a[100:103], v[128:131]
    buffer_load_dword v206, v208, s[12:15], s35 offen
    v_mfma_f32_16x16x32_bf16 v[132:135], a[8:11], a[96:99], v[132:135]
    ds_read_b128 a[144:147], v200 offset:16384
    v_mfma_f32_16x16x32_bf16 v[132:135], a[12:15], a[100:103], v[132:135]
    ds_read_b128 a[148:151], v201 offset:16384
    v_mfma_f32_16x16x32_bf16 v[144:147], a[16:19], a[96:99], v[144:147]
    s_mov_b32 s35, 1024
    v_mfma_f32_16x16x32_bf16 v[144:147], a[20:23], a[100:103], v[144:147]
    buffer_load_dword v206, v207, s[8:11], s35 offen
    ds_read_b128 a[152:155], v200 offset:18432
    v_mfma_f32_16x16x32_bf16 v[148:151], a[24:27], a[96:99], v[148:151]
    ds_read_b128 a[156:159], v201 offset:18432
    v_mfma_f32_16x16x32_bf16 v[148:151], a[28:31], a[100:103], v[148:151]
    v_mfma_f32_16x16x32_bf16 v[160:163], a[32:35], a[96:99], v[160:163]
    ds_read_b128 a[160:163], v200 offset:20480
    v_mfma_f32_16x16x32_bf16 v[160:163], a[36:39], a[100:103], v[160:163]
    ds_read_b128 a[164:167], v201 offset:20480
    v_mfma_f32_16x16x32_bf16 v[164:167], a[40:43], a[96:99], v[164:167]
    v_mfma_f32_16x16x32_bf16 v[164:167], a[44:47], a[100:103], v[164:167]
    ds_read_b128 a[168:171], v200 offset:22528
    v_mfma_f32_16x16x32_bf16 v[176:179], a[48:51], a[96:99], v[176:179]
    ds_read_b128 a[172:175], v201 offset:22528
    v_mfma_f32_16x16x32_bf16 v[176:179], a[52:55], a[100:103], v[176:179]
    v_mfma_f32_16x16x32_bf16 v[180:183], a[56:59], a[96:99], v[180:183]
    ds_read_b64_tr_b16 a[208:209], v202 offset:8192
    v_mfma_f32_16x16x32_bf16 v[180:183], a[60:63], a[100:103], v[180:183]
    ds_read_b64_tr_b16 a[210:211], v202 offset:8704
    v_mfma_f32_16x16x32_bf16 v[188:191], a[56:59], a[104:107], v[188:191]
    v_mfma_f32_16x16x32_bf16 v[188:191], a[60:63], a[108:111], v[188:191]
    ds_read_b64_tr_b16 a[212:213], v202 offset:12288
    v_mfma_f32_16x16x32_bf16 v[184:187], a[48:51], a[104:107], v[184:187]
    ds_read_b64_tr_b16 a[214:215], v202 offset:12800
    v_mfma_f32_16x16x32_bf16 v[184:187], a[52:55], a[108:111], v[184:187]
    v_mfma_f32_16x16x32_bf16 v[172:175], a[40:43], a[104:107], v[172:175]
    ds_read_b64_tr_b16 a[216:217], v203 offset:8192
    v_mfma_f32_16x16x32_bf16 v[172:175], a[44:47], a[108:111], v[172:175]
    ds_read_b64_tr_b16 a[218:219], v203 offset:8704
    v_mfma_f32_16x16x32_bf16 v[168:171], a[32:35], a[104:107], v[168:171]
    v_mfma_f32_16x16x32_bf16 v[168:171], a[36:39], a[108:111], v[168:171]
    ds_read_b64_tr_b16 a[220:221], v203 offset:12288
    v_mfma_f32_16x16x32_bf16 v[156:159], a[24:27], a[104:107], v[156:159]
    ds_read_b64_tr_b16 a[222:223], v203 offset:12800
    v_mfma_f32_16x16x32_bf16 v[156:159], a[28:31], a[108:111], v[156:159]
    v_mfma_f32_16x16x32_bf16 v[152:155], a[16:19], a[104:107], v[152:155]
    v_mfma_f32_16x16x32_bf16 v[152:155], a[20:23], a[108:111], v[152:155]
    v_mfma_f32_16x16x32_bf16 v[140:143], a[8:11], a[104:107], v[140:143]
    v_mfma_f32_16x16x32_bf16 v[140:143], a[12:15], a[108:111], v[140:143]
    v_mfma_f32_16x16x32_bf16 v[136:139], a[0:3], a[104:107], v[136:139]
    v_mfma_f32_16x16x32_bf16 v[136:139], a[4:7], a[108:111], v[136:139]
    s_waitcnt vmcnt(18)
    s_waitcnt vmcnt(4) lgkmcnt(0)
    s_barrier
    v_mfma_f32_16x16x32_bf16 v[0:3], a[176:179], a[112:115], v[0:3]
    s_add_u32 m0, s25, 32768
    s_mov_b32 s27, 896
    v_mfma_f32_16x16x32_bf16 v[0:3], a[180:183], a[116:119], v[0:3]
    buffer_load_dwordx4 v192, s[8:11], s27 offen offset:0  lds
    v_mfma_f32_16x16x32_bf16 v[8:11], a[176:179], a[120:123], v[8:11]
    ds_read_b64_tr_b16 a[64:65], v202 offset:16384
    v_mfma_f32_16x16x32_bf16 v[8:11], a[180:183], a[124:127], v[8:11]
    v_mfma_f32_16x16x32_bf16 v[16:19], a[176:179], a[128:131], v[16:19]
    ds_read_b64_tr_b16 a[66:67], v202 offset:16896
    v_mfma_f32_16x16x32_bf16 v[16:19], a[180:183], a[132:135], v[16:19]
    buffer_load_dwordx4 v193, s[8:11], s27 offen offset:1024  lds
    v_mfma_f32_16x16x32_bf16 v[24:27], a[176:179], a[136:139], v[24:27]
    ds_read_b64_tr_b16 a[68:69], v202 offset:20480
    v_mfma_f32_16x16x32_bf16 v[24:27], a[180:183], a[140:143], v[24:27]
    v_mfma_f32_16x16x32_bf16 v[32:35], a[176:179], a[144:147], v[32:35]
    ds_read_b64_tr_b16 a[70:71], v202 offset:20992
    v_mfma_f32_16x16x32_bf16 v[32:35], a[180:183], a[148:151], v[32:35]
    buffer_load_dwordx4 v194, s[8:11], s27 offen offset:2048  lds
    v_mfma_f32_16x16x32_bf16 v[40:43], a[176:179], a[152:155], v[40:43]
    ds_read_b64_tr_b16 a[72:73], v203 offset:16384
    v_mfma_f32_16x16x32_bf16 v[40:43], a[180:183], a[156:159], v[40:43]
    v_mfma_f32_16x16x32_bf16 v[48:51], a[176:179], a[160:163], v[48:51]
    ds_read_b64_tr_b16 a[74:75], v203 offset:16896
    v_mfma_f32_16x16x32_bf16 v[48:51], a[180:183], a[164:167], v[48:51]
    buffer_load_dwordx4 v195, s[8:11], s27 offen offset:3072  lds
    v_mfma_f32_16x16x32_bf16 v[56:59], a[176:179], a[168:171], v[56:59]
    ds_read_b64_tr_b16 a[76:77], v203 offset:20480
    v_mfma_f32_16x16x32_bf16 v[56:59], a[180:183], a[172:175], v[56:59]
    v_mfma_f32_16x16x32_bf16 v[60:63], a[184:187], a[168:171], v[60:63]
    s_add_u32 m0, s26, 49152
    s_mov_b32 s28, 2754560
    ds_read_b64_tr_b16 a[78:79], v203 offset:20992
    v_mfma_f32_16x16x32_bf16 v[60:63], a[188:191], a[172:175], v[60:63]
    buffer_load_dwordx4 v196, s[12:15], s28 offen offset:0  lds
    v_mfma_f32_16x16x32_bf16 v[52:55], a[184:187], a[160:163], v[52:55]
    ds_read_b128 a[0:3], v198 offset:0
    v_mfma_f32_16x16x32_bf16 v[52:55], a[188:191], a[164:167], v[52:55]
    v_mfma_f32_16x16x32_bf16 v[44:47], a[184:187], a[152:155], v[44:47]
    ds_read_b128 a[4:7], v199 offset:0
    v_mfma_f32_16x16x32_bf16 v[44:47], a[188:191], a[156:159], v[44:47]
    buffer_load_dwordx4 v197, s[12:15], s28 offen offset:1024  lds
    v_mfma_f32_16x16x32_bf16 v[36:39], a[184:187], a[144:147], v[36:39]
    v_mfma_f32_16x16x32_bf16 v[36:39], a[188:191], a[148:151], v[36:39]
    ds_read_b128 a[8:11], v198 offset:2048
    v_mfma_f32_16x16x32_bf16 v[28:31], a[184:187], a[136:139], v[28:31]
    s_add_u32 m0, s25, 49152
    s_mov_b32 s27, 131968
    v_mfma_f32_16x16x32_bf16 v[28:31], a[188:191], a[140:143], v[28:31]
    buffer_load_dwordx4 v192, s[8:11], s27 offen offset:0  lds
    ds_read_b128 a[12:15], v199 offset:2048
    v_mfma_f32_16x16x32_bf16 v[20:23], a[184:187], a[128:131], v[20:23]
    v_mfma_f32_16x16x32_bf16 v[20:23], a[188:191], a[132:135], v[20:23]
    ds_read_b128 a[16:19], v198 offset:4096
    v_mfma_f32_16x16x32_bf16 v[12:15], a[184:187], a[120:123], v[12:15]
    v_mfma_f32_16x16x32_bf16 v[12:15], a[188:191], a[124:127], v[12:15]
    buffer_load_dwordx4 v193, s[8:11], s27 offen offset:1024  lds
    ds_read_b128 a[20:23], v199 offset:4096
    v_mfma_f32_16x16x32_bf16 v[4:7], a[184:187], a[112:115], v[4:7]
    v_mfma_f32_16x16x32_bf16 v[4:7], a[188:191], a[116:119], v[4:7]
    ds_read_b128 a[24:27], v198 offset:6144
    v_mfma_f32_16x16x32_bf16 v[64:67], a[192:195], a[112:115], v[64:67]
    v_mfma_f32_16x16x32_bf16 v[64:67], a[196:199], a[116:119], v[64:67]
    buffer_load_dwordx4 v194, s[8:11], s27 offen offset:2048  lds
    ds_read_b128 a[28:31], v199 offset:6144
    v_mfma_f32_16x16x32_bf16 v[72:75], a[192:195], a[120:123], v[72:75]
    v_mfma_f32_16x16x32_bf16 v[72:75], a[196:199], a[124:127], v[72:75]
    ds_read_b64_tr_b16 a[80:81], v202 offset:24576
    v_mfma_f32_16x16x32_bf16 v[80:83], a[192:195], a[128:131], v[80:83]
    v_mfma_f32_16x16x32_bf16 v[80:83], a[196:199], a[132:135], v[80:83]
    buffer_load_dwordx4 v195, s[8:11], s27 offen offset:3072  lds
    ds_read_b64_tr_b16 a[82:83], v202 offset:25088
    v_mfma_f32_16x16x32_bf16 v[88:91], a[192:195], a[136:139], v[88:91]
    v_mfma_f32_16x16x32_bf16 v[88:91], a[196:199], a[140:143], v[88:91]
    ds_read_b64_tr_b16 a[84:85], v202 offset:28672
    v_mfma_f32_16x16x32_bf16 v[96:99], a[192:195], a[144:147], v[96:99]
    s_add_u32 m0, s26, 57344
    s_mov_b32 s28, 2756608
    v_mfma_f32_16x16x32_bf16 v[96:99], a[196:199], a[148:151], v[96:99]
    buffer_load_dwordx4 v196, s[12:15], s28 offen offset:0  lds
    ds_read_b64_tr_b16 a[86:87], v202 offset:29184
    v_mfma_f32_16x16x32_bf16 v[104:107], a[192:195], a[152:155], v[104:107]
    v_mfma_f32_16x16x32_bf16 v[104:107], a[196:199], a[156:159], v[104:107]
    v_mfma_f32_16x16x32_bf16 v[112:115], a[192:195], a[160:163], v[112:115]
    ds_read_b64_tr_b16 a[88:89], v203 offset:24576
    v_mfma_f32_16x16x32_bf16 v[112:115], a[196:199], a[164:167], v[112:115]
    buffer_load_dwordx4 v197, s[12:15], s28 offen offset:1024  lds
    v_mfma_f32_16x16x32_bf16 v[120:123], a[192:195], a[168:171], v[120:123]
    ds_read_b64_tr_b16 a[90:91], v203 offset:25088
    v_mfma_f32_16x16x32_bf16 v[120:123], a[196:199], a[172:175], v[120:123]
    v_mfma_f32_16x16x32_bf16 v[124:127], a[200:203], a[168:171], v[124:127]
    s_add_u32 m0, s26, 0
    s_mov_b32 s28, 3145728
    ds_read_b64_tr_b16 a[92:93], v203 offset:28672
    v_mfma_f32_16x16x32_bf16 v[124:127], a[204:207], a[172:175], v[124:127]
    buffer_load_dwordx4 v196, s[12:15], s28 offen offset:0  lds
    v_mfma_f32_16x16x32_bf16 v[116:119], a[200:203], a[160:163], v[116:119]
    ds_read_b64_tr_b16 a[94:95], v203 offset:29184
    v_mfma_f32_16x16x32_bf16 v[116:119], a[204:207], a[164:167], v[116:119]
    v_mfma_f32_16x16x32_bf16 v[108:111], a[200:203], a[152:155], v[108:111]
    ds_read_b128 a[32:35], v198 offset:16384
    v_mfma_f32_16x16x32_bf16 v[108:111], a[204:207], a[156:159], v[108:111]
    buffer_load_dwordx4 v197, s[12:15], s28 offen offset:1024  lds
    v_mfma_f32_16x16x32_bf16 v[100:103], a[200:203], a[144:147], v[100:103]
    ds_read_b128 a[36:39], v199 offset:16384
    v_mfma_f32_16x16x32_bf16 v[100:103], a[204:207], a[148:151], v[100:103]
    v_mfma_f32_16x16x32_bf16 v[92:95], a[200:203], a[136:139], v[92:95]
    s_add_u32 m0, s25, 65536
    s_mov_b32 s27, 1024
    ds_read_b128 a[40:43], v198 offset:18432
    v_mfma_f32_16x16x32_bf16 v[92:95], a[204:207], a[140:143], v[92:95]
    buffer_load_dwordx4 v192, s[8:11], s27 offen offset:0  lds
    v_mfma_f32_16x16x32_bf16 v[84:87], a[200:203], a[128:131], v[84:87]
    ds_read_b128 a[44:47], v199 offset:18432
    v_mfma_f32_16x16x32_bf16 v[84:87], a[204:207], a[132:135], v[84:87]
    v_mfma_f32_16x16x32_bf16 v[76:79], a[200:203], a[120:123], v[76:79]
    ds_read_b128 a[48:51], v198 offset:20480
    v_mfma_f32_16x16x32_bf16 v[76:79], a[204:207], a[124:127], v[76:79]
    buffer_load_dwordx4 v193, s[8:11], s27 offen offset:1024  lds
    v_mfma_f32_16x16x32_bf16 v[68:71], a[200:203], a[112:115], v[68:71]
    ds_read_b128 a[52:55], v199 offset:20480
    v_mfma_f32_16x16x32_bf16 v[68:71], a[204:207], a[116:119], v[68:71]
    v_mfma_f32_16x16x32_bf16 v[128:131], a[112:115], a[208:211], v[128:131]
    v_mfma_f32_16x16x32_bf16 v[128:131], a[116:119], a[212:215], v[128:131]
    buffer_load_dwordx4 v194, s[8:11], s27 offen offset:2048  lds
    ds_read_b128 a[56:59], v198 offset:22528
    v_mfma_f32_16x16x32_bf16 v[132:135], a[120:123], a[208:211], v[132:135]
    v_mfma_f32_16x16x32_bf16 v[132:135], a[124:127], a[212:215], v[132:135]
L_pg1:
    s_cbranch_execz L_body
    ds_read_b128 a[60:63], v199 offset:22528
    v_mfma_f32_16x16x32_bf16 v[144:147], a[128:131], a[208:211], v[144:147]
    v_mfma_f32_16x16x32_bf16 v[144:147], a[132:135], a[212:215], v[144:147]
    buffer_load_dwordx4 v195, s[8:11], s27 offen offset:3072  lds
    ds_read_b64_tr_b16 a[96:97], v202 offset:32768
    v_mfma_f32_16x16x32_bf16 v[148:151], a[136:139], a[208:211], v[148:151]
    s_cmp_lg_u32 s68, 5
    s_cbranch_scc1 L_nocert5
    s_mov_b64 exec, 1
    buffer_atomic_add v243, off, s[36:39], s75 sc1
    s_mov_b64 exec, -1
    s_nop 3
L_nocert5:
    v_mfma_f32_16x16x32_bf16 v[148:151], a[140:143], a[212:215], v[148:151]
    ds_read_b64_tr_b16 a[98:99], v202 offset:33280
    v_mfma_f32_16x16x32_bf16 v[160:163], a[144:147], a[208:211], v[160:163]
    v_mfma_f32_16x16x32_bf16 v[160:163], a[148:151], a[212:215], v[160:163]
    ds_read_b64_tr_b16 a[100:101], v202 offset:36864
    v_mfma_f32_16x16x32_bf16 v[164:167], a[152:155], a[208:211], v[164:167]
    v_mfma_f32_16x16x32_bf16 v[164:167], a[156:159], a[212:215], v[164:167]
    ds_read_b64_tr_b16 a[102:103], v202 offset:37376
    v_mfma_f32_16x16x32_bf16 v[176:179], a[160:163], a[208:211], v[176:179]
    v_mfma_f32_16x16x32_bf16 v[176:179], a[164:167], a[212:215], v[176:179]
    ds_read_b64_tr_b16 a[104:105], v203 offset:32768
    v_mfma_f32_16x16x32_bf16 v[180:183], a[168:171], a[208:211], v[180:183]
    v_mfma_f32_16x16x32_bf16 v[180:183], a[172:175], a[212:215], v[180:183]
    ds_read_b64_tr_b16 a[106:107], v203 offset:33280
    v_mfma_f32_16x16x32_bf16 v[188:191], a[168:171], a[216:219], v[188:191]
    v_mfma_f32_16x16x32_bf16 v[188:191], a[172:175], a[220:223], v[188:191]
    ds_read_b64_tr_b16 a[108:109], v203 offset:36864
    v_mfma_f32_16x16x32_bf16 v[184:187], a[160:163], a[216:219], v[184:187]
    v_mfma_f32_16x16x32_bf16 v[184:187], a[164:167], a[220:223], v[184:187]
    ds_read_b64_tr_b16 a[110:111], v203 offset:37376
    v_mfma_f32_16x16x32_bf16 v[172:175], a[152:155], a[216:219], v[172:175]
    v_mfma_f32_16x16x32_bf16 v[172:175], a[156:159], a[220:223], v[172:175]
    v_mfma_f32_16x16x32_bf16 v[168:171], a[144:147], a[216:219], v[168:171]
    v_mfma_f32_16x16x32_bf16 v[168:171], a[148:151], a[220:223], v[168:171]
    v_mfma_f32_16x16x32_bf16 v[156:159], a[136:139], a[216:219], v[156:159]
    v_mfma_f32_16x16x32_bf16 v[156:159], a[140:143], a[220:223], v[156:159]
    v_mfma_f32_16x16x32_bf16 v[152:155], a[128:131], a[216:219], v[152:155]
    v_mfma_f32_16x16x32_bf16 v[152:155], a[132:135], a[220:223], v[152:155]
    v_mfma_f32_16x16x32_bf16 v[140:143], a[120:123], a[216:219], v[140:143]
    v_mfma_f32_16x16x32_bf16 v[140:143], a[124:127], a[220:223], v[140:143]
    v_mfma_f32_16x16x32_bf16 v[136:139], a[112:115], a[216:219], v[136:139]
    v_mfma_f32_16x16x32_bf16 v[136:139], a[116:119], a[220:223], v[136:139]
    s_waitcnt vmcnt(6) lgkmcnt(0)
    s_barrier
    v_mfma_f32_16x16x32_bf16 v[0:3], a[64:67], a[0:3], v[0:3]
    s_add_u32 m0, s26, 8192
    s_mov_b32 s28, 3147776
    v_mfma_f32_16x16x32_bf16 v[0:3], a[68:71], a[4:7], v[0:3]
    buffer_load_dwordx4 v196, s[12:15], s28 offen offset:0  lds
    v_mfma_f32_16x16x32_bf16 v[8:11], a[64:67], a[8:11], v[8:11]
    ds_read_b64_tr_b16 a[176:177], v202 offset:40960
    v_mfma_f32_16x16x32_bf16 v[8:11], a[68:71], a[12:15], v[8:11]
    v_mfma_f32_16x16x32_bf16 v[16:19], a[64:67], a[16:19], v[16:19]
    ds_read_b64_tr_b16 a[178:179], v202 offset:41472
    v_mfma_f32_16x16x32_bf16 v[16:19], a[68:71], a[20:23], v[16:19]
    buffer_load_dwordx4 v197, s[12:15], s28 offen offset:1024  lds
    v_mfma_f32_16x16x32_bf16 v[24:27], a[64:67], a[24:27], v[24:27]
    ds_read_b64_tr_b16 a[180:181], v202 offset:45056
    v_mfma_f32_16x16x32_bf16 v[24:27], a[68:71], a[28:31], v[24:27]
    v_mfma_f32_16x16x32_bf16 v[32:35], a[64:67], a[32:35], v[32:35]
    s_add_u32 m0, s25, 81920
    s_mov_b32 s27, 132096
    ds_read_b64_tr_b16 a[182:183], v202 offset:45568
    v_mfma_f32_16x16x32_bf16 v[32:35], a[68:71], a[36:39], v[32:35]
    buffer_load_dwordx4 v192, s[8:11], s27 offen offset:0  lds
    v_mfma_f32_16x16x32_bf16 v[40:43], a[64:67], a[40:43], v[40:43]
    ds_read_b64_tr_b16 a[184:185], v203 offset:40960
    v_mfma_f32_16x16x32_bf16 v[40:43], a[68:71], a[44:47], v[40:43]
    v_mfma_f32_16x16x32_bf16 v[48:51], a[64:67], a[48:51], v[48:51]
    ds_read_b64_tr_b16 a[186:187], v203 offset:41472
    v_mfma_f32_16x16x32_bf16 v[48:51], a[68:71], a[52:55], v[48:51]
    buffer_load_dwordx4 v193, s[8:11], s27 offen offset:1024  lds
    v_mfma_f32_16x16x32_bf16 v[56:59], a[64:67], a[56:59], v[56:59]
    ds_read_b64_tr_b16 a[188:189], v203 offset:45056
    v_mfma_f32_16x16x32_bf16 v[56:59], a[68:71], a[60:63], v[56:59]
    v_mfma_f32_16x16x32_bf16 v[60:63], a[72:75], a[56:59], v[60:63]
    ds_read_b64_tr_b16 a[190:191], v203 offset:45568
    v_mfma_f32_16x16x32_bf16 v[60:63], a[76:79], a[60:63], v[60:63]
    buffer_load_dwordx4 v194, s[8:11], s27 offen offset:2048  lds
    v_mfma_f32_16x16x32_bf16 v[52:55], a[72:75], a[48:51], v[52:55]
    ds_read_b128 a[112:115], v198 offset:32768
    v_mfma_f32_16x16x32_bf16 v[52:55], a[76:79], a[52:55], v[52:55]
    v_mfma_f32_16x16x32_bf16 v[44:47], a[72:75], a[40:43], v[44:47]
    ds_read_b128 a[116:119], v199 offset:32768
    v_mfma_f32_16x16x32_bf16 v[44:47], a[76:79], a[44:47], v[44:47]
    buffer_load_dwordx4 v195, s[8:11], s27 offen offset:3072  lds
    v_mfma_f32_16x16x32_bf16 v[36:39], a[72:75], a[32:35], v[36:39]
    v_mfma_f32_16x16x32_bf16 v[36:39], a[76:79], a[36:39], v[36:39]
    ds_read_b128 a[120:123], v198 offset:34816
    v_mfma_f32_16x16x32_bf16 v[28:31], a[72:75], a[24:27], v[28:31]
    s_add_u32 m0, s26, 16384
    s_mov_b32 s28, 3149824
    v_mfma_f32_16x16x32_bf16 v[28:31], a[76:79], a[28:31], v[28:31]
    buffer_load_dwordx4 v196, s[12:15], s28 offen offset:0  lds
    ds_read_b128 a[124:127], v199 offset:34816
    v_mfma_f32_16x16x32_bf16 v[20:23], a[72:75], a[16:19], v[20:23]
    v_mfma_f32_16x16x32_bf16 v[20:23], a[76:79], a[20:23], v[20:23]
    ds_read_b128 a[128:131], v198 offset:36864
    v_mfma_f32_16x16x32_bf16 v[12:15], a[72:75], a[8:11], v[12:15]
    v_mfma_f32_16x16x32_bf16 v[12:15], a[76:79], a[12:15], v[12:15]
    buffer_load_dwordx4 v197, s[12:15], s28 offen offset:1024  lds
    ds_read_b128 a[132:135], v199 offset:36864
    v_mfma_f32_16x16x32_bf16 v[4:7], a[72:75], a[0:3], v[4:7]
    v_mfma_f32_16x16x32_bf16 v[4:7], a[76:79], a[4:7], v[4:7]
    ds_read_b128 a[136:139], v198 offset:38912
    v_mfma_f32_16x16x32_bf16 v[64:67], a[80:83], a[0:3], v[64:67]
    s_add_u32 m0, s26, 24576
    s_mov_b32 s28, 3538944
    v_mfma_f32_16x16x32_bf16 v[64:67], a[84:87], a[4:7], v[64:67]
    buffer_load_dwordx4 v196, s[12:15], s28 offen offset:0  lds
    ds_read_b128 a[140:143], v199 offset:38912
    v_mfma_f32_16x16x32_bf16 v[72:75], a[80:83], a[8:11], v[72:75]
    v_mfma_f32_16x16x32_bf16 v[72:75], a[84:87], a[12:15], v[72:75]
    ds_read_b64_tr_b16 a[192:193], v202 offset:49152
    v_mfma_f32_16x16x32_bf16 v[80:83], a[80:83], a[16:19], v[80:83]
    v_mfma_f32_16x16x32_bf16 v[80:83], a[84:87], a[20:23], v[80:83]
    buffer_load_dwordx4 v197, s[12:15], s28 offen offset:1024  lds
    ds_read_b64_tr_b16 a[194:195], v202 offset:49664
    v_mfma_f32_16x16x32_bf16 v[88:91], a[80:83], a[24:27], v[88:91]
    v_mfma_f32_16x16x32_bf16 v[88:91], a[84:87], a[28:31], v[88:91]
    ds_read_b64_tr_b16 a[196:197], v202 offset:53248
    v_mfma_f32_16x16x32_bf16 v[96:99], a[80:83], a[32:35], v[96:99]
    s_add_u32 m0, s25, 0
    s_mov_b32 s27, 1152
    v_mfma_f32_16x16x32_bf16 v[96:99], a[84:87], a[36:39], v[96:99]
    buffer_load_dwordx4 v192, s[8:11], s27 offen offset:0  lds
    ds_read_b64_tr_b16 a[198:199], v202 offset:53760
    v_mfma_f32_16x16x32_bf16 v[104:107], a[80:83], a[40:43], v[104:107]
    v_mfma_f32_16x16x32_bf16 v[104:107], a[84:87], a[44:47], v[104:107]
    v_mfma_f32_16x16x32_bf16 v[112:115], a[80:83], a[48:51], v[112:115]
    ds_read_b64_tr_b16 a[200:201], v203 offset:49152
    v_mfma_f32_16x16x32_bf16 v[112:115], a[84:87], a[52:55], v[112:115]
    buffer_load_dwordx4 v193, s[8:11], s27 offen offset:1024  lds
    v_mfma_f32_16x16x32_bf16 v[120:123], a[80:83], a[56:59], v[120:123]
    ds_read_b64_tr_b16 a[202:203], v203 offset:49664
    v_mfma_f32_16x16x32_bf16 v[120:123], a[84:87], a[60:63], v[120:123]
    v_mfma_f32_16x16x32_bf16 v[124:127], a[88:91], a[56:59], v[124:127]
    ds_read_b64_tr_b16 a[204:205], v203 offset:53248
    v_mfma_f32_16x16x32_bf16 v[124:127], a[92:95], a[60:63], v[124:127]
    buffer_load_dwordx4 v194, s[8:11], s27 offen offset:2048  lds
    v_mfma_f32_16x16x32_bf16 v[116:119], a[88:91], a[48:51], v[116:119]
    ds_read_b64_tr_b16 a[206:207], v203 offset:53760
    v_mfma_f32_16x16x32_bf16 v[116:119], a[92:95], a[52:55], v[116:119]
    v_mfma_f32_16x16x32_bf16 v[108:111], a[88:91], a[40:43], v[108:111]
    ds_read_b128 a[144:147], v198 offset:49152
    v_mfma_f32_16x16x32_bf16 v[108:111], a[92:95], a[44:47], v[108:111]
    buffer_load_dwordx4 v195, s[8:11], s27 offen offset:3072  lds
    v_mfma_f32_16x16x32_bf16 v[100:103], a[88:91], a[32:35], v[100:103]
    ds_read_b128 a[148:151], v199 offset:49152
    v_mfma_f32_16x16x32_bf16 v[100:103], a[92:95], a[36:39], v[100:103]
    v_mfma_f32_16x16x32_bf16 v[92:95], a[88:91], a[24:27], v[92:95]
    s_add_u32 m0, s26, 32768
    s_mov_b32 s28, 3540992
    ds_read_b128 a[152:155], v198 offset:51200
    v_mfma_f32_16x16x32_bf16 v[92:95], a[92:95], a[28:31], v[92:95]
    buffer_load_dwordx4 v196, s[12:15], s28 offen offset:0  lds
    v_mfma_f32_16x16x32_bf16 v[84:87], a[88:91], a[16:19], v[84:87]
    ds_read_b128 a[156:159], v199 offset:51200
    v_mfma_f32_16x16x32_bf16 v[84:87], a[92:95], a[20:23], v[84:87]
    v_mfma_f32_16x16x32_bf16 v[76:79], a[88:91], a[8:11], v[76:79]
    ds_read_b128 a[160:163], v198 offset:53248
    v_mfma_f32_16x16x32_bf16 v[76:79], a[92:95], a[12:15], v[76:79]
    buffer_load_dwordx4 v197, s[12:15], s28 offen offset:1024  lds
    v_mfma_f32_16x16x32_bf16 v[68:71], a[88:91], a[0:3], v[68:71]
    ds_read_b128 a[164:167], v199 offset:53248
    v_mfma_f32_16x16x32_bf16 v[68:71], a[92:95], a[4:7], v[68:71]
    v_mfma_f32_16x16x32_bf16 v[128:131], a[0:3], a[96:99], v[128:131]
    s_mov_b32 s35, 3932160
    v_mfma_f32_16x16x32_bf16 v[128:131], a[4:7], a[100:103], v[128:131]
    buffer_load_dword v206, v208, s[12:15], s35 offen
    ds_read_b128 a[168:171], v198 offset:55296
    v_mfma_f32_16x16x32_bf16 v[132:135], a[8:11], a[96:99], v[132:135]
    v_mfma_f32_16x16x32_bf16 v[132:135], a[12:15], a[100:103], v[132:135]
    ds_read_b128 a[172:175], v199 offset:55296
    v_mfma_f32_16x16x32_bf16 v[144:147], a[16:19], a[96:99], v[144:147]
    s_mov_b32 s35, 1280
    v_mfma_f32_16x16x32_bf16 v[144:147], a[20:23], a[100:103], v[144:147]
    buffer_load_dword v206, v207, s[8:11], s35 offen
    ds_read_b64_tr_b16 a[208:209], v202 offset:57344
    v_mfma_f32_16x16x32_bf16 v[148:151], a[24:27], a[96:99], v[148:151]
    s_cmp_lg_u32 s68, 6
    s_cbranch_scc1 L_nocert6
    s_mov_b64 exec, 1
    buffer_atomic_add v243, off, s[36:39], s75 sc1
    s_mov_b64 exec, -1
    s_nop 3
L_nocert6:
    v_mfma_f32_16x16x32_bf16 v[148:151], a[28:31], a[100:103], v[148:151]
    ds_read_b64_tr_b16 a[210:211], v202 offset:57856
    v_mfma_f32_16x16x32_bf16 v[160:163], a[32:35], a[96:99], v[160:163]
    v_mfma_f32_16x16x32_bf16 v[160:163], a[36:39], a[100:103], v[160:163]
    ds_read_b64_tr_b16 a[212:213], v202 offset:61440
    v_mfma_f32_16x16x32_bf16 v[164:167], a[40:43], a[96:99], v[164:167]
    v_mfma_f32_16x16x32_bf16 v[164:167], a[44:47], a[100:103], v[164:167]
    ds_read_b64_tr_b16 a[214:215], v202 offset:61952
    v_mfma_f32_16x16x32_bf16 v[176:179], a[48:51], a[96:99], v[176:179]
    v_mfma_f32_16x16x32_bf16 v[176:179], a[52:55], a[100:103], v[176:179]
    ds_read_b64_tr_b16 a[216:217], v203 offset:57344
    v_mfma_f32_16x16x32_bf16 v[180:183], a[56:59], a[96:99], v[180:183]
    v_mfma_f32_16x16x32_bf16 v[180:183], a[60:63], a[100:103], v[180:183]
    ds_read_b64_tr_b16 a[218:219], v203 offset:57856
    v_mfma_f32_16x16x32_bf16 v[188:191], a[56:59], a[104:107], v[188:191]
    v_mfma_f32_16x16x32_bf16 v[188:191], a[60:63], a[108:111], v[188:191]
    ds_read_b64_tr_b16 a[220:221], v203 offset:61440
    v_mfma_f32_16x16x32_bf16 v[184:187], a[48:51], a[104:107], v[184:187]
    v_mfma_f32_16x16x32_bf16 v[184:187], a[52:55], a[108:111], v[184:187]
    ds_read_b64_tr_b16 a[222:223], v203 offset:61952
    v_mfma_f32_16x16x32_bf16 v[172:175], a[40:43], a[104:107], v[172:175]
    v_mfma_f32_16x16x32_bf16 v[172:175], a[44:47], a[108:111], v[172:175]
    v_mfma_f32_16x16x32_bf16 v[168:171], a[32:35], a[104:107], v[168:171]
    v_mfma_f32_16x16x32_bf16 v[168:171], a[36:39], a[108:111], v[168:171]
    v_mfma_f32_16x16x32_bf16 v[156:159], a[24:27], a[104:107], v[156:159]
    v_mfma_f32_16x16x32_bf16 v[156:159], a[28:31], a[108:111], v[156:159]
    v_mfma_f32_16x16x32_bf16 v[152:155], a[16:19], a[104:107], v[152:155]
    v_mfma_f32_16x16x32_bf16 v[152:155], a[20:23], a[108:111], v[152:155]
    v_mfma_f32_16x16x32_bf16 v[140:143], a[8:11], a[104:107], v[140:143]
    v_mfma_f32_16x16x32_bf16 v[140:143], a[12:15], a[108:111], v[140:143]
    v_mfma_f32_16x16x32_bf16 v[136:139], a[0:3], a[104:107], v[136:139]
    v_mfma_f32_16x16x32_bf16 v[136:139], a[4:7], a[108:111], v[136:139]
    s_waitcnt vmcnt(10) lgkmcnt(0)
    s_barrier
    v_mfma_f32_16x16x32_bf16 v[0:3], a[176:179], a[112:115], v[0:3]
    s_add_u32 m0, s25, 16384
    s_mov_b32 s27, 132224
    v_mfma_f32_16x16x32_bf16 v[0:3], a[180:183], a[116:119], v[0:3]
    buffer_load_dwordx4 v192, s[8:11], s27 offen offset:0  lds
    v_mfma_f32_16x16x32_bf16 v[8:11], a[176:179], a[120:123], v[8:11]
    ds_read_b64_tr_b16 a[64:65], v202 offset:0
    v_mfma_f32_16x16x32_bf16 v[8:11], a[180:183], a[124:127], v[8:11]
    v_mfma_f32_16x16x32_bf16 v[16:19], a[176:179], a[128:131], v[16:19]
    ds_read_b64_tr_b16 a[66:67], v202 offset:512
    v_mfma_f32_16x16x32_bf16 v[16:19], a[180:183], a[132:135], v[16:19]
    buffer_load_dwordx4 v193, s[8:11], s27 offen offset:1024  lds
    v_mfma_f32_16x16x32_bf16 v[24:27], a[176:179], a[136:139], v[24:27]
    ds_read_b64_tr_b16 a[68:69], v202 offset:4096
    v_mfma_f32_16x16x32_bf16 v[24:27], a[180:183], a[140:143], v[24:27]
    v_mfma_f32_16x16x32_bf16 v[32:35], a[176:179], a[144:147], v[32:35]
    ds_read_b64_tr_b16 a[70:71], v202 offset:4608
    v_mfma_f32_16x16x32_bf16 v[32:35], a[180:183], a[148:151], v[32:35]
    buffer_load_dwordx4 v194, s[8:11], s27 offen offset:2048  lds
    v_mfma_f32_16x16x32_bf16 v[40:43], a[176:179], a[152:155], v[40:43]
    ds_read_b64_tr_b16 a[72:73], v203 offset:0
    v_mfma_f32_16x16x32_bf16 v[40:43], a[180:183], a[156:159], v[40:43]
    v_mfma_f32_16x16x32_bf16 v[48:51], a[176:179], a[160:163], v[48:51]
    ds_read_b64_tr_b16 a[74:75], v203 offset:512
    v_mfma_f32_16x16x32_bf16 v[48:51], a[180:183], a[164:167], v[48:51]
    buffer_load_dwordx4 v195, s[8:11], s27 offen offset:3072  lds
    v_mfma_f32_16x16x32_bf16 v[56:59], a[176:179], a[168:171], v[56:59]
    ds_read_b64_tr_b16 a[76:77], v203 offset:4096
    v_mfma_f32_16x16x32_bf16 v[56:59], a[180:183], a[172:175], v[56:59]
    v_mfma_f32_16x16x32_bf16 v[60:63], a[184:187], a[168:171], v[60:63]
    s_add_u32 m0, s26, 40960
    s_mov_b32 s28, 3543040
    ds_read_b64_tr_b16 a[78:79], v203 offset:4608
    v_mfma_f32_16x16x32_bf16 v[60:63], a[188:191], a[172:175], v[60:63]
    buffer_load_dwordx4 v196, s[12:15], s28 offen offset:0  lds
    v_mfma_f32_16x16x32_bf16 v[52:55], a[184:187], a[160:163], v[52:55]
    ds_read_b128 a[0:3], v200 offset:0
    v_mfma_f32_16x16x32_bf16 v[52:55], a[188:191], a[164:167], v[52:55]
    v_mfma_f32_16x16x32_bf16 v[44:47], a[184:187], a[152:155], v[44:47]
    ds_read_b128 a[4:7], v201 offset:0
    v_mfma_f32_16x16x32_bf16 v[44:47], a[188:191], a[156:159], v[44:47]
    buffer_load_dwordx4 v197, s[12:15], s28 offen offset:1024  lds
    v_mfma_f32_16x16x32_bf16 v[36:39], a[184:187], a[144:147], v[36:39]
    v_mfma_f32_16x16x32_bf16 v[36:39], a[188:191], a[148:151], v[36:39]
    ds_read_b128 a[8:11], v200 offset:2048
    v_mfma_f32_16x16x32_bf16 v[28:31], a[184:187], a[136:139], v[28:31]
    s_add_u32 m0, s26, 49152
    s_mov_b32 s28, 3932160
    v_mfma_f32_16x16x32_bf16 v[28:31], a[188:191], a[140:143], v[28:31]
    buffer_load_dwordx4 v196, s[12:15], s28 offen offset:0  lds
    ds_read_b128 a[12:15], v201 offset:2048
    v_mfma_f32_16x16x32_bf16 v[20:23], a[184:187], a[128:131], v[20:23]
    v_mfma_f32_16x16x32_bf16 v[20:23], a[188:191], a[132:135], v[20:23]
    ds_read_b128 a[16:19], v200 offset:4096
    v_mfma_f32_16x16x32_bf16 v[12:15], a[184:187], a[120:123], v[12:15]
    v_mfma_f32_16x16x32_bf16 v[12:15], a[188:191], a[124:127], v[12:15]
    buffer_load_dwordx4 v197, s[12:15], s28 offen offset:1024  lds
    ds_read_b128 a[20:23], v201 offset:4096
    v_mfma_f32_16x16x32_bf16 v[4:7], a[184:187], a[112:115], v[4:7]
    v_mfma_f32_16x16x32_bf16 v[4:7], a[188:191], a[116:119], v[4:7]
    ds_read_b128 a[24:27], v200 offset:6144
    v_mfma_f32_16x16x32_bf16 v[64:67], a[192:195], a[112:115], v[64:67]
    s_add_u32 m0, s25, 32768
    s_mov_b32 s27, 1280
    v_mfma_f32_16x16x32_bf16 v[64:67], a[196:199], a[116:119], v[64:67]
    buffer_load_dwordx4 v192, s[8:11], s27 offen offset:0  lds
    ds_read_b128 a[28:31], v201 offset:6144
    v_mfma_f32_16x16x32_bf16 v[72:75], a[192:195], a[120:123], v[72:75]
    v_mfma_f32_16x16x32_bf16 v[72:75], a[196:199], a[124:127], v[72:75]
    ds_read_b64_tr_b16 a[80:81], v202 offset:8192
    v_mfma_f32_16x16x32_bf16 v[80:83], a[192:195], a[128:131], v[80:83]
    v_mfma_f32_16x16x32_bf16 v[80:83], a[196:199], a[132:135], v[80:83]
    buffer_load_dwordx4 v193, s[8:11], s27 offen offset:1024  lds
    ds_read_b64_tr_b16 a[82:83], v202 offset:8704
    v_mfma_f32_16x16x32_bf16 v[88:91], a[192:195], a[136:139], v[88:91]
    v_mfma_f32_16x16x32_bf16 v[88:91], a[196:199], a[140:143], v[88:91]
    ds_read_b64_tr_b16 a[84:85], v202 offset:12288
    v_mfma_f32_16x16x32_bf16 v[96:99], a[192:195], a[144:147], v[96:99]
    v_mfma_f32_16x16x32_bf16 v[96:99], a[196:199], a[148:151], v[96:99]
    buffer_load_dwordx4 v194, s[8:11], s27 offen offset:2048  lds
    ds_read_b64_tr_b16 a[86:87], v202 offset:12800
    v_mfma_f32_16x16x32_bf16 v[104:107], a[192:195], a[152:155], v[104:107]
    v_mfma_f32_16x16x32_bf16 v[104:107], a[196:199], a[156:159], v[104:107]
    v_mfma_f32_16x16x32_bf16 v[112:115], a[192:195], a[160:163], v[112:115]
    ds_read_b64_tr_b16 a[88:89], v203 offset:8192
    v_mfma_f32_16x16x32_bf16 v[112:115], a[196:199], a[164:167], v[112:115]
    buffer_load_dwordx4 v195, s[8:11], s27 offen offset:3072  lds
    v_mfma_f32_16x16x32_bf16 v[120:123], a[192:195], a[168:171], v[120:123]
    ds_read_b64_tr_b16 a[90:91], v203 offset:8704
    v_mfma_f32_16x16x32_bf16 v[120:123], a[196:199], a[172:175], v[120:123]
    v_mfma_f32_16x16x32_bf16 v[124:127], a[200:203], a[168:171], v[124:127]
    s_add_u32 m0, s26, 57344
    s_mov_b32 s28, 3934208
    ds_read_b64_tr_b16 a[92:93], v203 offset:12288
    v_mfma_f32_16x16x32_bf16 v[124:127], a[204:207], a[172:175], v[124:127]
    buffer_load_dwordx4 v196, s[12:15], s28 offen offset:0  lds
    v_mfma_f32_16x16x32_bf16 v[116:119], a[200:203], a[160:163], v[116:119]
    ds_read_b64_tr_b16 a[94:95], v203 offset:12800
    v_mfma_f32_16x16x32_bf16 v[116:119], a[204:207], a[164:167], v[116:119]
    v_mfma_f32_16x16x32_bf16 v[108:111], a[200:203], a[152:155], v[108:111]
    ds_read_b128 a[32:35], v200 offset:16384
    v_mfma_f32_16x16x32_bf16 v[108:111], a[204:207], a[156:159], v[108:111]
    buffer_load_dwordx4 v197, s[12:15], s28 offen offset:1024  lds
    v_mfma_f32_16x16x32_bf16 v[100:103], a[200:203], a[144:147], v[100:103]
    ds_read_b128 a[36:39], v201 offset:16384
    v_mfma_f32_16x16x32_bf16 v[100:103], a[204:207], a[148:151], v[100:103]
    v_mfma_f32_16x16x32_bf16 v[92:95], a[200:203], a[136:139], v[92:95]
    s_add_u32 m0, s25, 49152
    s_mov_b32 s27, 132352
    ds_read_b128 a[40:43], v200 offset:18432
    v_mfma_f32_16x16x32_bf16 v[92:95], a[204:207], a[140:143], v[92:95]
    buffer_load_dwordx4 v192, s[8:11], s27 offen offset:0  lds
    v_mfma_f32_16x16x32_bf16 v[84:87], a[200:203], a[128:131], v[84:87]
    ds_read_b128 a[44:47], v201 offset:18432
    v_mfma_f32_16x16x32_bf16 v[84:87], a[204:207], a[132:135], v[84:87]
    v_mfma_f32_16x16x32_bf16 v[76:79], a[200:203], a[120:123], v[76:79]
    ds_read_b128 a[48:51], v200 offset:20480
    v_mfma_f32_16x16x32_bf16 v[76:79], a[204:207], a[124:127], v[76:79]
    buffer_load_dwordx4 v193, s[8:11], s27 offen offset:1024  lds
    v_mfma_f32_16x16x32_bf16 v[68:71], a[200:203], a[112:115], v[68:71]
    ds_read_b128 a[52:55], v201 offset:20480
    v_mfma_f32_16x16x32_bf16 v[68:71], a[204:207], a[116:119], v[68:71]
    v_mfma_f32_16x16x32_bf16 v[128:131], a[112:115], a[208:211], v[128:131]
    v_mfma_f32_16x16x32_bf16 v[128:131], a[116:119], a[212:215], v[128:131]
    buffer_load_dwordx4 v194, s[8:11], s27 offen offset:2048  lds
    ds_read_b128 a[56:59], v200 offset:22528
    v_mfma_f32_16x16x32_bf16 v[132:135], a[120:123], a[208:211], v[132:135]
    v_mfma_f32_16x16x32_bf16 v[132:135], a[124:127], a[212:215], v[132:135]
    ds_read_b128 a[60:63], v201 offset:22528
    v_mfma_f32_16x16x32_bf16 v[144:147], a[128:131], a[208:211], v[144:147]
    v_mfma_f32_16x16x32_bf16 v[144:147], a[132:135], a[212:215], v[144:147]
    buffer_load_dwordx4 v195, s[8:11], s27 offen offset:3072  lds
    ds_read_b64_tr_b16 a[96:97], v202 offset:16384
    v_mfma_f32_16x16x32_bf16 v[148:151], a[136:139], a[208:211], v[148:151]
    s_cmp_lg_u32 s68, 7
    s_cbranch_scc1 L_nocert7
    s_mov_b64 exec, 1
    buffer_atomic_add v243, off, s[36:39], s75 sc1
    s_mov_b64 exec, -1
    s_nop 3
L_nocert7:
    v_mfma_f32_16x16x32_bf16 v[148:151], a[140:143], a[212:215], v[148:151]
    ds_read_b64_tr_b16 a[98:99], v202 offset:16896
    v_mfma_f32_16x16x32_bf16 v[160:163], a[144:147], a[208:211], v[160:163]
    v_mfma_f32_16x16x32_bf16 v[160:163], a[148:151], a[212:215], v[160:163]
    ds_read_b64_tr_b16 a[100:101], v202 offset:20480
    v_mfma_f32_16x16x32_bf16 v[164:167], a[152:155], a[208:211], v[164:167]
    v_mfma_f32_16x16x32_bf16 v[164:167], a[156:159], a[212:215], v[164:167]
    ds_read_b64_tr_b16 a[102:103], v202 offset:20992
    v_mfma_f32_16x16x32_bf16 v[176:179], a[160:163], a[208:211], v[176:179]
    v_mfma_f32_16x16x32_bf16 v[176:179], a[164:167], a[212:215], v[176:179]
    ds_read_b64_tr_b16 a[104:105], v203 offset:16384
    v_mfma_f32_16x16x32_bf16 v[180:183], a[168:171], a[208:211], v[180:183]
    v_mfma_f32_16x16x32_bf16 v[180:183], a[172:175], a[212:215], v[180:183]
    ds_read_b64_tr_b16 a[106:107], v203 offset:16896
    v_mfma_f32_16x16x32_bf16 v[188:191], a[168:171], a[216:219], v[188:191]
    v_mfma_f32_16x16x32_bf16 v[188:191], a[172:175], a[220:223], v[188:191]
    ds_read_b64_tr_b16 a[108:109], v203 offset:20480
    v_mfma_f32_16x16x32_bf16 v[184:187], a[160:163], a[216:219], v[184:187]
    v_mfma_f32_16x16x32_bf16 v[184:187], a[164:167], a[220:223], v[184:187]
    ds_read_b64_tr_b16 a[110:111], v203 offset:20992
    v_mfma_f32_16x16x32_bf16 v[172:175], a[152:155], a[216:219], v[172:175]
    v_mfma_f32_16x16x32_bf16 v[172:175], a[156:159], a[220:223], v[172:175]
    v_mfma_f32_16x16x32_bf16 v[168:171], a[144:147], a[216:219], v[168:171]
    v_mfma_f32_16x16x32_bf16 v[168:171], a[148:151], a[220:223], v[168:171]
    v_mfma_f32_16x16x32_bf16 v[156:159], a[136:139], a[216:219], v[156:159]
    v_mfma_f32_16x16x32_bf16 v[156:159], a[140:143], a[220:223], v[156:159]
    v_mfma_f32_16x16x32_bf16 v[152:155], a[128:131], a[216:219], v[152:155]
    v_mfma_f32_16x16x32_bf16 v[152:155], a[132:135], a[220:223], v[152:155]
    v_mfma_f32_16x16x32_bf16 v[140:143], a[120:123], a[216:219], v[140:143]
    v_mfma_f32_16x16x32_bf16 v[140:143], a[124:127], a[220:223], v[140:143]
    v_mfma_f32_16x16x32_bf16 v[136:139], a[112:115], a[216:219], v[136:139]
    v_mfma_f32_16x16x32_bf16 v[136:139], a[116:119], a[220:223], v[136:139]
    s_waitcnt vmcnt(12) lgkmcnt(0)
    s_barrier
    v_mfma_f32_16x16x32_bf16 v[0:3], a[64:67], a[0:3], v[0:3]
    s_add_u32 m0, s26, 0
    s_mov_b32 s28, 3936256
    v_mfma_f32_16x16x32_bf16 v[0:3], a[68:71], a[4:7], v[0:3]
    buffer_load_dwordx4 v196, s[12:15], s28 offen offset:0  lds
    v_mfma_f32_16x16x32_bf16 v[8:11], a[64:67], a[8:11], v[8:11]
    ds_read_b64_tr_b16 a[176:177], v202 offset:24576
    v_mfma_f32_16x16x32_bf16 v[8:11], a[68:71], a[12:15], v[8:11]
    v_mfma_f32_16x16x32_bf16 v[16:19], a[64:67], a[16:19], v[16:19]
    ds_read_b64_tr_b16 a[178:179], v202 offset:25088
    v_mfma_f32_16x16x32_bf16 v[16:19], a[68:71], a[20:23], v[16:19]
    buffer_load_dwordx4 v197, s[12:15], s28 offen offset:1024  lds
    v_mfma_f32_16x16x32_bf16 v[24:27], a[64:67], a[24:27], v[24:27]
    ds_read_b64_tr_b16 a[180:181], v202 offset:28672
    v_mfma_f32_16x16x32_bf16 v[24:27], a[68:71], a[28:31], v[24:27]
    v_mfma_f32_16x16x32_bf16 v[32:35], a[64:67], a[32:35], v[32:35]
    s_add_u32 m0, s26, 8192
    s_mov_b32 s28, 4325376
    ds_read_b64_tr_b16 a[182:183], v202 offset:29184
    v_mfma_f32_16x16x32_bf16 v[32:35], a[68:71], a[36:39], v[32:35]
    buffer_load_dwordx4 v196, s[12:15], s28 offen offset:0  lds
    v_mfma_f32_16x16x32_bf16 v[40:43], a[64:67], a[40:43], v[40:43]
    ds_read_b64_tr_b16 a[184:185], v203 offset:24576
    v_mfma_f32_16x16x32_bf16 v[40:43], a[68:71], a[44:47], v[40:43]
    v_mfma_f32_16x16x32_bf16 v[48:51], a[64:67], a[48:51], v[48:51]
    ds_read_b64_tr_b16 a[186:187], v203 offset:25088
    v_mfma_f32_16x16x32_bf16 v[48:51], a[68:71], a[52:55], v[48:51]
    buffer_load_dwordx4 v197, s[12:15], s28 offen offset:1024  lds
    v_mfma_f32_16x16x32_bf16 v[56:59], a[64:67], a[56:59], v[56:59]
    ds_read_b64_tr_b16 a[188:189], v203 offset:28672
    v_mfma_f32_16x16x32_bf16 v[56:59], a[68:71], a[60:63], v[56:59]
    v_mfma_f32_16x16x32_bf16 v[60:63], a[72:75], a[56:59], v[60:63]
    s_add_u32 m0, s25, 65536
    s_mov_b32 s27, 1408
    ds_read_b64_tr_b16 a[190:191], v203 offset:29184
    v_mfma_f32_16x16x32_bf16 v[60:63], a[76:79], a[60:63], v[60:63]
    buffer_load_dwordx4 v192, s[8:11], s27 offen offset:0  lds
    v_mfma_f32_16x16x32_bf16 v[52:55], a[72:75], a[48:51], v[52:55]
    ds_read_b128 a[112:115], v198 offset:0
    v_mfma_f32_16x16x32_bf16 v[52:55], a[76:79], a[52:55], v[52:55]
    v_mfma_f32_16x16x32_bf16 v[44:47], a[72:75], a[40:43], v[44:47]
    ds_read_b128 a[116:119], v199 offset:0
    v_mfma_f32_16x16x32_bf16 v[44:47], a[76:79], a[44:47], v[44:47]
    buffer_load_dwordx4 v193, s[8:11], s27 offen offset:1024  lds
    v_mfma_f32_16x16x32_bf16 v[36:39], a[72:75], a[32:35], v[36:39]
    v_mfma_f32_16x16x32_bf16 v[36:39], a[76:79], a[36:39], v[36:39]
    ds_read_b128 a[120:123], v198 offset:2048
    v_mfma_f32_16x16x32_bf16 v[28:31], a[72:75], a[24:27], v[28:31]
    v_mfma_f32_16x16x32_bf16 v[28:31], a[76:79], a[28:31], v[28:31]
    buffer_load_dwordx4 v194, s[8:11], s27 offen offset:2048  lds
    ds_read_b128 a[124:127], v199 offset:2048
    v_mfma_f32_16x16x32_bf16 v[20:23], a[72:75], a[16:19], v[20:23]
    v_mfma_f32_16x16x32_bf16 v[20:23], a[76:79], a[20:23], v[20:23]
    ds_read_b128 a[128:131], v198 offset:4096
    v_mfma_f32_16x16x32_bf16 v[12:15], a[72:75], a[8:11], v[12:15]
    v_mfma_f32_16x16x32_bf16 v[12:15], a[76:79], a[12:15], v[12:15]
    buffer_load_dwordx4 v195, s[8:11], s27 offen offset:3072  lds
    ds_read_b128 a[132:135], v199 offset:4096
    v_mfma_f32_16x16x32_bf16 v[4:7], a[72:75], a[0:3], v[4:7]
    v_mfma_f32_16x16x32_bf16 v[4:7], a[76:79], a[4:7], v[4:7]
    ds_read_b128 a[136:139], v198 offset:6144
    v_mfma_f32_16x16x32_bf16 v[64:67], a[80:83], a[0:3], v[64:67]
    s_add_u32 m0, s26, 16384
    s_mov_b32 s28, 4327424
    v_mfma_f32_16x16x32_bf16 v[64:67], a[84:87], a[4:7], v[64:67]
    buffer_load_dwordx4 v196, s[12:15], s28 offen offset:0  lds
    ds_read_b128 a[140:143], v199 offset:6144
    v_mfma_f32_16x16x32_bf16 v[72:75], a[80:83], a[8:11], v[72:75]
    v_mfma_f32_16x16x32_bf16 v[72:75], a[84:87], a[12:15], v[72:75]
    ds_read_b64_tr_b16 a[192:193], v202 offset:32768
    v_mfma_f32_16x16x32_bf16 v[80:83], a[80:83], a[16:19], v[80:83]
    v_mfma_f32_16x16x32_bf16 v[80:83], a[84:87], a[20:23], v[80:83]
    buffer_load_dwordx4 v197, s[12:15], s28 offen offset:1024  lds
    ds_read_b64_tr_b16 a[194:195], v202 offset:33280
    v_mfma_f32_16x16x32_bf16 v[88:91], a[80:83], a[24:27], v[88:91]
    v_mfma_f32_16x16x32_bf16 v[88:91], a[84:87], a[28:31], v[88:91]
    ds_read_b64_tr_b16 a[196:197], v202 offset:36864
    v_mfma_f32_16x16x32_bf16 v[96:99], a[80:83], a[32:35], v[96:99]
    s_add_u32 m0, s25, 81920
    s_mov_b32 s27, 132480
    v_mfma_f32_16x16x32_bf16 v[96:99], a[84:87], a[36:39], v[96:99]
    buffer_load_dwordx4 v192, s[8:11], s27 offen offset:0  lds
    ds_read_b64_tr_b16 a[198:199], v202 offset:37376
    v_mfma_f32_16x16x32_bf16 v[104:107], a[80:83], a[40:43], v[104:107]
    v_mfma_f32_16x16x32_bf16 v[104:107], a[84:87], a[44:47], v[104:107]
    v_mfma_f32_16x16x32_bf16 v[112:115], a[80:83], a[48:51], v[112:115]
    ds_read_b64_tr_b16 a[200:201], v203 offset:32768
    v_mfma_f32_16x16x32_bf16 v[112:115], a[84:87], a[52:55], v[112:115]
    buffer_load_dwordx4 v193, s[8:11], s27 offen offset:1024  lds
    v_mfma_f32_16x16x32_bf16 v[120:123], a[80:83], a[56:59], v[120:123]
    ds_read_b64_tr_b16 a[202:203], v203 offset:33280
    v_mfma_f32_16x16x32_bf16 v[120:123], a[84:87], a[60:63], v[120:123]
    v_mfma_f32_16x16x32_bf16 v[124:127], a[88:91], a[56:59], v[124:127]
    ds_read_b64_tr_b16 a[204:205], v203 offset:36864
    v_mfma_f32_16x16x32_bf16 v[124:127], a[92:95], a[60:63], v[124:127]
    buffer_load_dwordx4 v194, s[8:11], s27 offen offset:2048  lds
    v_mfma_f32_16x16x32_bf16 v[116:119], a[88:91], a[48:51], v[116:119]
    ds_read_b64_tr_b16 a[206:207], v203 offset:37376
    v_mfma_f32_16x16x32_bf16 v[116:119], a[92:95], a[52:55], v[116:119]
    v_mfma_f32_16x16x32_bf16 v[108:111], a[88:91], a[40:43], v[108:111]
    ds_read_b128 a[144:147], v198 offset:16384
    v_mfma_f32_16x16x32_bf16 v[108:111], a[92:95], a[44:47], v[108:111]
    buffer_load_dwordx4 v195, s[8:11], s27 offen offset:3072  lds
    v_mfma_f32_16x16x32_bf16 v[100:103], a[88:91], a[32:35], v[100:103]
    ds_read_b128 a[148:151], v199 offset:16384
    v_mfma_f32_16x16x32_bf16 v[100:103], a[92:95], a[36:39], v[100:103]
    v_mfma_f32_16x16x32_bf16 v[92:95], a[88:91], a[24:27], v[92:95]
    s_mov_b32 s35, 4718592
    ds_read_b128 a[152:155], v198 offset:18432
    v_mfma_f32_16x16x32_bf16 v[92:95], a[92:95], a[28:31], v[92:95]
    buffer_load_dword v206, v208, s[12:15], s35 offen
    v_mfma_f32_16x16x32_bf16 v[84:87], a[88:91], a[16:19], v[84:87]
    ds_read_b128 a[156:159], v199 offset:18432
    v_mfma_f32_16x16x32_bf16 v[84:87], a[92:95], a[20:23], v[84:87]
    v_mfma_f32_16x16x32_bf16 v[76:79], a[88:91], a[8:11], v[76:79]
    s_mov_b32 s35, 1536
    ds_read_b128 a[160:163], v198 offset:20480
    v_mfma_f32_16x16x32_bf16 v[76:79], a[92:95], a[12:15], v[76:79]
    buffer_load_dword v206, v207, s[8:11], s35 offen
    v_mfma_f32_16x16x32_bf16 v[68:71], a[88:91], a[0:3], v[68:71]
    ds_read_b128 a[164:167], v199 offset:20480
    v_mfma_f32_16x16x32_bf16 v[68:71], a[92:95], a[4:7], v[68:71]
    v_mfma_f32_16x16x32_bf16 v[128:131], a[0:3], a[96:99], v[128:131]
    v_mfma_f32_16x16x32_bf16 v[128:131], a[4:7], a[100:103], v[128:131]
    ds_read_b128 a[168:171], v198 offset:22528
    v_mfma_f32_16x16x32_bf16 v[132:135], a[8:11], a[96:99], v[132:135]
    v_mfma_f32_16x16x32_bf16 v[132:135], a[12:15], a[100:103], v[132:135]
L_pg2:
    s_cbranch_execz L_pg3
    ds_read_b128 a[172:175], v199 offset:22528
    v_mfma_f32_16x16x32_bf16 v[144:147], a[16:19], a[96:99], v[144:147]
    v_mfma_f32_16x16x32_bf16 v[144:147], a[20:23], a[100:103], v[144:147]
    ds_read_b64_tr_b16 a[208:209], v202 offset:40960
    v_mfma_f32_16x16x32_bf16 v[148:151], a[24:27], a[96:99], v[148:151]
    s_cmp_lg_u32 s68, 8
    s_cbranch_scc1 L_nocert8
    s_mov_b64 exec, 1
    buffer_atomic_add v243, off, s[36:39], s75 sc1
    s_mov_b64 exec, -1
    s_nop 3
L_nocert8:
    v_mfma_f32_16x16x32_bf16 v[148:151], a[28:31], a[100:103], v[148:151]
    ds_read_b64_tr_b16 a[210:211], v202 offset:41472
    v_mfma_f32_16x16x32_bf16 v[160:163], a[32:35], a[96:99], v[160:163]
    v_mfma_f32_16x16x32_bf16 v[160:163], a[36:39], a[100:103], v[160:163]
    ds_read_b64_tr_b16 a[212:213], v202 offset:45056
    v_mfma_f32_16x16x32_bf16 v[164:167], a[40:43], a[96:99], v[164:167]
    v_mfma_f32_16x16x32_bf16 v[164:167], a[44:47], a[100:103], v[164:167]
    ds_read_b64_tr_b16 a[214:215], v202 offset:45568
    v_mfma_f32_16x16x32_bf16 v[176:179], a[48:51], a[96:99], v[176:179]
    v_mfma_f32_16x16x32_bf16 v[176:179], a[52:55], a[100:103], v[176:179]
    ds_read_b64_tr_b16 a[216:217], v203 offset:40960
    v_mfma_f32_16x16x32_bf16 v[180:183], a[56:59], a[96:99], v[180:183]
    v_mfma_f32_16x16x32_bf16 v[180:183], a[60:63], a[100:103], v[180:183]
    ds_read_b64_tr_b16 a[218:219], v203 offset:41472
    v_mfma_f32_16x16x32_bf16 v[188:191], a[56:59], a[104:107], v[188:191]
    v_mfma_f32_16x16x32_bf16 v[188:191], a[60:63], a[108:111], v[188:191]
    ds_read_b64_tr_b16 a[220:221], v203 offset:45056
    v_mfma_f32_16x16x32_bf16 v[184:187], a[48:51], a[104:107], v[184:187]
    v_mfma_f32_16x16x32_bf16 v[184:187], a[52:55], a[108:111], v[184:187]
    ds_read_b64_tr_b16 a[222:223], v203 offset:45568
    v_mfma_f32_16x16x32_bf16 v[172:175], a[40:43], a[104:107], v[172:175]
    v_mfma_f32_16x16x32_bf16 v[172:175], a[44:47], a[108:111], v[172:175]
    v_mfma_f32_16x16x32_bf16 v[168:171], a[32:35], a[104:107], v[168:171]
    v_mfma_f32_16x16x32_bf16 v[168:171], a[36:39], a[108:111], v[168:171]
    v_mfma_f32_16x16x32_bf16 v[156:159], a[24:27], a[104:107], v[156:159]
    v_mfma_f32_16x16x32_bf16 v[156:159], a[28:31], a[108:111], v[156:159]
    v_mfma_f32_16x16x32_bf16 v[152:155], a[16:19], a[104:107], v[152:155]
    v_mfma_f32_16x16x32_bf16 v[152:155], a[20:23], a[108:111], v[152:155]
    v_mfma_f32_16x16x32_bf16 v[140:143], a[8:11], a[104:107], v[140:143]
    v_mfma_f32_16x16x32_bf16 v[140:143], a[12:15], a[108:111], v[140:143]
    v_mfma_f32_16x16x32_bf16 v[136:139], a[0:3], a[104:107], v[136:139]
    v_mfma_f32_16x16x32_bf16 v[136:139], a[4:7], a[108:111], v[136:139]
    s_waitcnt vmcnt(14) lgkmcnt(0)
    s_barrier
    v_mfma_f32_16x16x32_bf16 v[0:3], a[176:179], a[112:115], v[0:3]
    s_add_u32 m0, s26, 24576
    s_mov_b32 s28, 4329472
    v_mfma_f32_16x16x32_bf16 v[0:3], a[180:183], a[116:119], v[0:3]
    buffer_load_dwordx4 v196, s[12:15], s28 offen offset:0  lds
    v_mfma_f32_16x16x32_bf16 v[8:11], a[176:179], a[120:123], v[8:11]
    ds_read_b64_tr_b16 a[64:65], v202 offset:49152
    v_mfma_f32_16x16x32_bf16 v[8:11], a[180:183], a[124:127], v[8:11]
    v_mfma_f32_16x16x32_bf16 v[16:19], a[176:179], a[128:131], v[16:19]
    ds_read_b64_tr_b16 a[66:67], v202 offset:49664
    v_mfma_f32_16x16x32_bf16 v[16:19], a[180:183], a[132:135], v[16:19]
    buffer_load_dwordx4 v197, s[12:15], s28 offen offset:1024  lds
    v_mfma_f32_16x16x32_bf16 v[24:27], a[176:179], a[136:139], v[24:27]
    ds_read_b64_tr_b16 a[68:69], v202 offset:53248
    v_mfma_f32_16x16x32_bf16 v[24:27], a[180:183], a[140:143], v[24:27]
    v_mfma_f32_16x16x32_bf16 v[32:35], a[176:179], a[144:147], v[32:35]
    s_add_u32 m0, s26, 32768
    s_mov_b32 s28, 4718592
    ds_read_b64_tr_b16 a[70:71], v202 offset:53760
    v_mfma_f32_16x16x32_bf16 v[32:35], a[180:183], a[148:151], v[32:35]
    buffer_load_dwordx4 v196, s[12:15], s28 offen offset:0  lds
    v_mfma_f32_16x16x32_bf16 v[40:43], a[176:179], a[152:155], v[40:43]
    ds_read_b64_tr_b16 a[72:73], v203 offset:49152
    v_mfma_f32_16x16x32_bf16 v[40:43], a[180:183], a[156:159], v[40:43]
    v_mfma_f32_16x16x32_bf16 v[48:51], a[176:179], a[160:163], v[48:51]
    ds_read_b64_tr_b16 a[74:75], v203 offset:49664
    v_mfma_f32_16x16x32_bf16 v[48:51], a[180:183], a[164:167], v[48:51]
    buffer_load_dwordx4 v197, s[12:15], s28 offen offset:1024  lds
    v_mfma_f32_16x16x32_bf16 v[56:59], a[176:179], a[168:171], v[56:59]
    ds_read_b64_tr_b16 a[76:77], v203 offset:53248
    v_mfma_f32_16x16x32_bf16 v[56:59], a[180:183], a[172:175], v[56:59]
    v_mfma_f32_16x16x32_bf16 v[60:63], a[184:187], a[168:171], v[60:63]
    s_add_u32 m0, s25, 0
    s_mov_b32 s27, 1536
    ds_read_b64_tr_b16 a[78:79], v203 offset:53760
    v_mfma_f32_16x16x32_bf16 v[60:63], a[188:191], a[172:175], v[60:63]
    buffer_load_dwordx4 v192, s[8:11], s27 offen offset:0  lds
    v_mfma_f32_16x16x32_bf16 v[52:55], a[184:187], a[160:163], v[52:55]
    ds_read_b128 a[0:3], v198 offset:32768
    v_mfma_f32_16x16x32_bf16 v[52:55], a[188:191], a[164:167], v[52:55]
    v_mfma_f32_16x16x32_bf16 v[44:47], a[184:187], a[152:155], v[44:47]
    ds_read_b128 a[4:7], v199 offset:32768
    v_mfma_f32_16x16x32_bf16 v[44:47], a[188:191], a[156:159], v[44:47]
    buffer_load_dwordx4 v193, s[8:11], s27 offen offset:1024  lds
    v_mfma_f32_16x16x32_bf16 v[36:39], a[184:187], a[144:147], v[36:39]
    v_mfma_f32_16x16x32_bf16 v[36:39], a[188:191], a[148:151], v[36:39]
    ds_read_b128 a[8:11], v198 offset:34816
    v_mfma_f32_16x16x32_bf16 v[28:31], a[184:187], a[136:139], v[28:31]
    v_mfma_f32_16x16x32_bf16 v[28:31], a[188:191], a[140:143], v[28:31]
    buffer_load_dwordx4 v194, s[8:11], s27 offen offset:2048  lds
    ds_read_b128 a[12:15], v199 offset:34816
    v_mfma_f32_16x16x32_bf16 v[20:23], a[184:187], a[128:131], v[20:23]
    v_mfma_f32_16x16x32_bf16 v[20:23], a[188:191], a[132:135], v[20:23]
    ds_read_b128 a[16:19], v198 offset:36864
    v_mfma_f32_16x16x32_bf16 v[12:15], a[184:187], a[120:123], v[12:15]
    v_mfma_f32_16x16x32_bf16 v[12:15], a[188:191], a[124:127], v[12:15]
    buffer_load_dwordx4 v195, s[8:11], s27 offen offset:3072  lds
    ds_read_b128 a[20:23], v199 offset:36864
    v_mfma_f32_16x16x32_bf16 v[4:7], a[184:187], a[112:115], v[4:7]
    v_mfma_f32_16x16x32_bf16 v[4:7], a[188:191], a[116:119], v[4:7]
    ds_read_b128 a[24:27], v198 offset:38912
    v_mfma_f32_16x16x32_bf16 v[64:67], a[192:195], a[112:115], v[64:67]
    s_add_u32 m0, s26, 40960
    s_mov_b32 s28, 4720640
    v_mfma_f32_16x16x32_bf16 v[64:67], a[196:199], a[116:119], v[64:67]
    buffer_load_dwordx4 v196, s[12:15], s28 offen offset:0  lds
    ds_read_b128 a[28:31], v199 offset:38912
    v_mfma_f32_16x16x32_bf16 v[72:75], a[192:195], a[120:123], v[72:75]
    v_mfma_f32_16x16x32_bf16 v[72:75], a[196:199], a[124:127], v[72:75]
    ds_read_b64_tr_b16 a[80:81], v202 offset:57344
    v_mfma_f32_16x16x32_bf16 v[80:83], a[192:195], a[128:131], v[80:83]
    v_mfma_f32_16x16x32_bf16 v[80:83], a[196:199], a[132:135], v[80:83]
    buffer_load_dwordx4 v197, s[12:15], s28 offen offset:1024  lds
    ds_read_b64_tr_b16 a[82:83], v202 offset:57856
    v_mfma_f32_16x16x32_bf16 v[88:91], a[192:195], a[136:139], v[88:91]
    v_mfma_f32_16x16x32_bf16 v[88:91], a[196:199], a[140:143], v[88:91]
    ds_read_b64_tr_b16 a[84:85], v202 offset:61440
    v_mfma_f32_16x16x32_bf16 v[96:99], a[192:195], a[144:147], v[96:99]
    s_add_u32 m0, s25, 16384
    s_mov_b32 s27, 132608
    v_mfma_f32_16x16x32_bf16 v[96:99], a[196:199], a[148:151], v[96:99]
    buffer_load_dwordx4 v192, s[8:11], s27 offen offset:0  lds
    ds_read_b64_tr_b16 a[86:87], v202 offset:61952
    v_mfma_f32_16x16x32_bf16 v[104:107], a[192:195], a[152:155], v[104:107]
    v_mfma_f32_16x16x32_bf16 v[104:107], a[196:199], a[156:159], v[104:107]
    v_mfma_f32_16x16x32_bf16 v[112:115], a[192:195], a[160:163], v[112:115]
    ds_read_b64_tr_b16 a[88:89], v203 offset:57344
    v_mfma_f32_16x16x32_bf16 v[112:115], a[196:199], a[164:167], v[112:115]
    buffer_load_dwordx4 v193, s[8:11], s27 offen offset:1024  lds
    v_mfma_f32_16x16x32_bf16 v[120:123], a[192:195], a[168:171], v[120:123]
    ds_read_b64_tr_b16 a[90:91], v203 offset:57856
    v_mfma_f32_16x16x32_bf16 v[120:123], a[196:199], a[172:175], v[120:123]
    v_mfma_f32_16x16x32_bf16 v[124:127], a[200:203], a[168:171], v[124:127]
    ds_read_b64_tr_b16 a[92:93], v203 offset:61440
    v_mfma_f32_16x16x32_bf16 v[124:127], a[204:207], a[172:175], v[124:127]
    buffer_load_dwordx4 v194, s[8:11], s27 offen offset:2048  lds
    v_mfma_f32_16x16x32_bf16 v[116:119], a[200:203], a[160:163], v[116:119]
    ds_read_b64_tr_b16 a[94:95], v203 offset:61952
    v_mfma_f32_16x16x32_bf16 v[116:119], a[204:207], a[164:167], v[116:119]
    v_mfma_f32_16x16x32_bf16 v[108:111], a[200:203], a[152:155], v[108:111]
    ds_read_b128 a[32:35], v198 offset:49152
    v_mfma_f32_16x16x32_bf16 v[108:111], a[204:207], a[156:159], v[108:111]
    buffer_load_dwordx4 v195, s[8:11], s27 offen offset:3072  lds
    v_mfma_f32_16x16x32_bf16 v[100:103], a[200:203], a[144:147], v[100:103]
    ds_read_b128 a[36:39], v199 offset:49152
    v_mfma_f32_16x16x32_bf16 v[100:103], a[204:207], a[148:151], v[100:103]
    v_mfma_f32_16x16x32_bf16 v[92:95], a[200:203], a[136:139], v[92:95]
    ds_read_b128 a[40:43], v198 offset:51200
    v_mfma_f32_16x16x32_bf16 v[92:95], a[204:207], a[140:143], v[92:95]
    v_mfma_f32_16x16x32_bf16 v[84:87], a[200:203], a[128:131], v[84:87]
    ds_read_b128 a[44:47], v199 offset:51200
    v_mfma_f32_16x16x32_bf16 v[84:87], a[204:207], a[132:135], v[84:87]
    v_mfma_f32_16x16x32_bf16 v[76:79], a[200:203], a[120:123], v[76:79]
    ds_read_b128 a[48:51], v198 offset:53248
    v_mfma_f32_16x16x32_bf16 v[76:79], a[204:207], a[124:127], v[76:79]
    v_mfma_f32_16x16x32_bf16 v[68:71], a[200:203], a[112:115], v[68:71]
    ds_read_b128 a[52:55], v199 offset:53248
    v_mfma_f32_16x16x32_bf16 v[68:71], a[204:207], a[116:119], v[68:71]
    v_mfma_f32_16x16x32_bf16 v[128:131], a[112:115], a[208:211], v[128:131]
    v_mfma_f32_16x16x32_bf16 v[128:131], a[116:119], a[212:215], v[128:131]
    ds_read_b128 a[56:59], v198 offset:55296
    v_mfma_f32_16x16x32_bf16 v[132:135], a[120:123], a[208:211], v[132:135]
    v_mfma_f32_16x16x32_bf16 v[132:135], a[124:127], a[212:215], v[132:135]
    ds_read_b128 a[60:63], v199 offset:55296
    v_mfma_f32_16x16x32_bf16 v[144:147], a[128:131], a[208:211], v[144:147]
    v_mfma_f32_16x16x32_bf16 v[144:147], a[132:135], a[212:215], v[144:147]
    ds_read_b64_tr_b16 a[96:97], v202 offset:0
    v_mfma_f32_16x16x32_bf16 v[148:151], a[136:139], a[208:211], v[148:151]
    s_cmp_lg_u32 s68, 9
    s_cbranch_scc1 L_nocert9
    s_mov_b64 exec, 1
    buffer_atomic_add v243, off, s[36:39], s75 sc1
    s_mov_b64 exec, -1
    s_nop 3
L_nocert9:
    v_mfma_f32_16x16x32_bf16 v[148:151], a[140:143], a[212:215], v[148:151]
    ds_read_b64_tr_b16 a[98:99], v202 offset:512
    v_mfma_f32_16x16x32_bf16 v[160:163], a[144:147], a[208:211], v[160:163]
    v_mfma_f32_16x16x32_bf16 v[160:163], a[148:151], a[212:215], v[160:163]
    ds_read_b64_tr_b16 a[100:101], v202 offset:4096
    v_mfma_f32_16x16x32_bf16 v[164:167], a[152:155], a[208:211], v[164:167]
    v_mfma_f32_16x16x32_bf16 v[164:167], a[156:159], a[212:215], v[164:167]
    ds_read_b64_tr_b16 a[102:103], v202 offset:4608
    v_mfma_f32_16x16x32_bf16 v[176:179], a[160:163], a[208:211], v[176:179]
    v_mfma_f32_16x16x32_bf16 v[176:179], a[164:167], a[212:215], v[176:179]
    ds_read_b64_tr_b16 a[104:105], v203 offset:0
    v_mfma_f32_16x16x32_bf16 v[180:183], a[168:171], a[208:211], v[180:183]
    v_mfma_f32_16x16x32_bf16 v[180:183], a[172:175], a[212:215], v[180:183]
    ds_read_b64_tr_b16 a[106:107], v203 offset:512
    v_mfma_f32_16x16x32_bf16 v[188:191], a[168:171], a[216:219], v[188:191]
    v_mfma_f32_16x16x32_bf16 v[188:191], a[172:175], a[220:223], v[188:191]
    ds_read_b64_tr_b16 a[108:109], v203 offset:4096
    v_mfma_f32_16x16x32_bf16 v[184:187], a[160:163], a[216:219], v[184:187]
    v_mfma_f32_16x16x32_bf16 v[184:187], a[164:167], a[220:223], v[184:187]
    ds_read_b64_tr_b16 a[110:111], v203 offset:4608
    v_mfma_f32_16x16x32_bf16 v[172:175], a[152:155], a[216:219], v[172:175]
    v_mfma_f32_16x16x32_bf16 v[172:175], a[156:159], a[220:223], v[172:175]
    v_mfma_f32_16x16x32_bf16 v[168:171], a[144:147], a[216:219], v[168:171]
    v_mfma_f32_16x16x32_bf16 v[168:171], a[148:151], a[220:223], v[168:171]
    v_mfma_f32_16x16x32_bf16 v[156:159], a[136:139], a[216:219], v[156:159]
    v_mfma_f32_16x16x32_bf16 v[156:159], a[140:143], a[220:223], v[156:159]
    v_mfma_f32_16x16x32_bf16 v[152:155], a[128:131], a[216:219], v[152:155]
    v_mfma_f32_16x16x32_bf16 v[152:155], a[132:135], a[220:223], v[152:155]
    v_mfma_f32_16x16x32_bf16 v[140:143], a[120:123], a[216:219], v[140:143]
    v_mfma_f32_16x16x32_bf16 v[140:143], a[124:127], a[220:223], v[140:143]
    v_mfma_f32_16x16x32_bf16 v[136:139], a[112:115], a[216:219], v[136:139]
    v_mfma_f32_16x16x32_bf16 v[136:139], a[116:119], a[220:223], v[136:139]
    s_waitcnt vmcnt(12) lgkmcnt(0)
    s_barrier
    v_mfma_f32_16x16x32_bf16 v[0:3], a[64:67], a[0:3], v[0:3]
    s_add_u32 m0, s26, 49152
    s_mov_b32 s28, 4722688
    v_mfma_f32_16x16x32_bf16 v[0:3], a[68:71], a[4:7], v[0:3]
    buffer_load_dwordx4 v196, s[12:15], s28 offen offset:0  lds
    v_mfma_f32_16x16x32_bf16 v[8:11], a[64:67], a[8:11], v[8:11]
    ds_read_b64_tr_b16 a[176:177], v202 offset:8192
    v_mfma_f32_16x16x32_bf16 v[8:11], a[68:71], a[12:15], v[8:11]
    v_mfma_f32_16x16x32_bf16 v[16:19], a[64:67], a[16:19], v[16:19]
    ds_read_b64_tr_b16 a[178:179], v202 offset:8704
    v_mfma_f32_16x16x32_bf16 v[16:19], a[68:71], a[20:23], v[16:19]
    buffer_load_dwordx4 v197, s[12:15], s28 offen offset:1024  lds
    v_mfma_f32_16x16x32_bf16 v[24:27], a[64:67], a[24:27], v[24:27]
    ds_read_b64_tr_b16 a[180:181], v202 offset:12288
    v_mfma_f32_16x16x32_bf16 v[24:27], a[68:71], a[28:31], v[24:27]
    v_mfma_f32_16x16x32_bf16 v[32:35], a[64:67], a[32:35], v[32:35]
    s_add_u32 m0, s26, 57344
    s_mov_b32 s28, 5111808
    ds_read_b64_tr_b16 a[182:183], v202 offset:12800
    v_mfma_f32_16x16x32_bf16 v[32:35], a[68:71], a[36:39], v[32:35]
    buffer_load_dwordx4 v196, s[12:15], s28 offen offset:0  lds
    v_mfma_f32_16x16x32_bf16 v[40:43], a[64:67], a[40:43], v[40:43]
    ds_read_b64_tr_b16 a[184:185], v203 offset:8192
    v_mfma_f32_16x16x32_bf16 v[40:43], a[68:71], a[44:47], v[40:43]
    v_mfma_f32_16x16x32_bf16 v[48:51], a[64:67], a[48:51], v[48:51]
    ds_read_b64_tr_b16 a[186:187], v203 offset:8704
    v_mfma_f32_16x16x32_bf16 v[48:51], a[68:71], a[52:55], v[48:51]
    buffer_load_dwordx4 v197, s[12:15], s28 offen offset:1024  lds
    v_mfma_f32_16x16x32_bf16 v[56:59], a[64:67], a[56:59], v[56:59]
    ds_read_b64_tr_b16 a[188:189], v203 offset:12288
    v_mfma_f32_16x16x32_bf16 v[56:59], a[68:71], a[60:63], v[56:59]
    v_mfma_f32_16x16x32_bf16 v[60:63], a[72:75], a[56:59], v[60:63]
    s_add_u32 m0, s25, 32768
    s_mov_b32 s27, 1664
    ds_read_b64_tr_b16 a[190:191], v203 offset:12800
    v_mfma_f32_16x16x32_bf16 v[60:63], a[76:79], a[60:63], v[60:63]
    buffer_load_dwordx4 v192, s[8:11], s27 offen offset:0  lds
    v_mfma_f32_16x16x32_bf16 v[52:55], a[72:75], a[48:51], v[52:55]
    ds_read_b128 a[112:115], v200 offset:0
    v_mfma_f32_16x16x32_bf16 v[52:55], a[76:79], a[52:55], v[52:55]
    v_mfma_f32_16x16x32_bf16 v[44:47], a[72:75], a[40:43], v[44:47]
    ds_read_b128 a[116:119], v201 offset:0
    v_mfma_f32_16x16x32_bf16 v[44:47], a[76:79], a[44:47], v[44:47]
    buffer_load_dwordx4 v193, s[8:11], s27 offen offset:1024  lds
    v_mfma_f32_16x16x32_bf16 v[36:39], a[72:75], a[32:35], v[36:39]
    v_mfma_f32_16x16x32_bf16 v[36:39], a[76:79], a[36:39], v[36:39]
    ds_read_b128 a[120:123], v200 offset:2048
    v_mfma_f32_16x16x32_bf16 v[28:31], a[72:75], a[24:27], v[28:31]
    v_mfma_f32_16x16x32_bf16 v[28:31], a[76:79], a[28:31], v[28:31]
    buffer_load_dwordx4 v194, s[8:11], s27 offen offset:2048  lds
    ds_read_b128 a[124:127], v201 offset:2048
    v_mfma_f32_16x16x32_bf16 v[20:23], a[72:75], a[16:19], v[20:23]
    v_mfma_f32_16x16x32_bf16 v[20:23], a[76:79], a[20:23], v[20:23]
    ds_read_b128 a[128:131], v200 offset:4096
    v_mfma_f32_16x16x32_bf16 v[12:15], a[72:75], a[8:11], v[12:15]
    v_mfma_f32_16x16x32_bf16 v[12:15], a[76:79], a[12:15], v[12:15]
    buffer_load_dwordx4 v195, s[8:11], s27 offen offset:3072  lds
    ds_read_b128 a[132:135], v201 offset:4096
    v_mfma_f32_16x16x32_bf16 v[4:7], a[72:75], a[0:3], v[4:7]
    v_mfma_f32_16x16x32_bf16 v[4:7], a[76:79], a[4:7], v[4:7]
    ds_read_b128 a[136:139], v200 offset:6144
    v_mfma_f32_16x16x32_bf16 v[64:67], a[80:83], a[0:3], v[64:67]
    s_add_u32 m0, s26, 0
    s_mov_b32 s28, 5113856
    v_mfma_f32_16x16x32_bf16 v[64:67], a[84:87], a[4:7], v[64:67]
    buffer_load_dwordx4 v196, s[12:15], s28 offen offset:0  lds
    ds_read_b128 a[140:143], v201 offset:6144
    v_mfma_f32_16x16x32_bf16 v[72:75], a[80:83], a[8:11], v[72:75]
    v_mfma_f32_16x16x32_bf16 v[72:75], a[84:87], a[12:15], v[72:75]
    ds_read_b64_tr_b16 a[192:193], v202 offset:16384
    v_mfma_f32_16x16x32_bf16 v[80:83], a[80:83], a[16:19], v[80:83]
    v_mfma_f32_16x16x32_bf16 v[80:83], a[84:87], a[20:23], v[80:83]
    buffer_load_dwordx4 v197, s[12:15], s28 offen offset:1024  lds
    ds_read_b64_tr_b16 a[194:195], v202 offset:16896
    v_mfma_f32_16x16x32_bf16 v[88:91], a[80:83], a[24:27], v[88:91]
    v_mfma_f32_16x16x32_bf16 v[88:91], a[84:87], a[28:31], v[88:91]
    ds_read_b64_tr_b16 a[196:197], v202 offset:20480
    v_mfma_f32_16x16x32_bf16 v[96:99], a[80:83], a[32:35], v[96:99]
    s_add_u32 m0, s25, 49152
    s_mov_b32 s27, 132736
    v_mfma_f32_16x16x32_bf16 v[96:99], a[84:87], a[36:39], v[96:99]
    buffer_load_dwordx4 v192, s[8:11], s27 offen offset:0  lds
    ds_read_b64_tr_b16 a[198:199], v202 offset:20992
    v_mfma_f32_16x16x32_bf16 v[104:107], a[80:83], a[40:43], v[104:107]
    v_mfma_f32_16x16x32_bf16 v[104:107], a[84:87], a[44:47], v[104:107]
    v_mfma_f32_16x16x32_bf16 v[112:115], a[80:83], a[48:51], v[112:115]
    ds_read_b64_tr_b16 a[200:201], v203 offset:16384
    v_mfma_f32_16x16x32_bf16 v[112:115], a[84:87], a[52:55], v[112:115]
    buffer_load_dwordx4 v193, s[8:11], s27 offen offset:1024  lds
    v_mfma_f32_16x16x32_bf16 v[120:123], a[80:83], a[56:59], v[120:123]
    ds_read_b64_tr_b16 a[202:203], v203 offset:16896
    v_mfma_f32_16x16x32_bf16 v[120:123], a[84:87], a[60:63], v[120:123]
    v_mfma_f32_16x16x32_bf16 v[124:127], a[88:91], a[56:59], v[124:127]
    ds_read_b64_tr_b16 a[204:205], v203 offset:20480
    v_mfma_f32_16x16x32_bf16 v[124:127], a[92:95], a[60:63], v[124:127]
    buffer_load_dwordx4 v194, s[8:11], s27 offen offset:2048  lds
    v_mfma_f32_16x16x32_bf16 v[116:119], a[88:91], a[48:51], v[116:119]
    ds_read_b64_tr_b16 a[206:207], v203 offset:20992
    v_mfma_f32_16x16x32_bf16 v[116:119], a[92:95], a[52:55], v[116:119]
    v_mfma_f32_16x16x32_bf16 v[108:111], a[88:91], a[40:43], v[108:111]
    ds_read_b128 a[144:147], v200 offset:16384
    v_mfma_f32_16x16x32_bf16 v[108:111], a[92:95], a[44:47], v[108:111]
    buffer_load_dwordx4 v195, s[8:11], s27 offen offset:3072  lds
    v_mfma_f32_16x16x32_bf16 v[100:103], a[88:91], a[32:35], v[100:103]
    ds_read_b128 a[148:151], v201 offset:16384
    v_mfma_f32_16x16x32_bf16 v[100:103], a[92:95], a[36:39], v[100:103]
    v_mfma_f32_16x16x32_bf16 v[92:95], a[88:91], a[24:27], v[92:95]
    s_mov_b32 s35, 5505024
    ds_read_b128 a[152:155], v200 offset:18432
    v_mfma_f32_16x16x32_bf16 v[92:95], a[92:95], a[28:31], v[92:95]
    buffer_load_dword v206, v208, s[12:15], s35 offen
    v_mfma_f32_16x16x32_bf16 v[84:87], a[88:91], a[16:19], v[84:87]
    ds_read_b128 a[156:159], v201 offset:18432
    v_mfma_f32_16x16x32_bf16 v[84:87], a[92:95], a[20:23], v[84:87]
    v_mfma_f32_16x16x32_bf16 v[76:79], a[88:91], a[8:11], v[76:79]
    s_mov_b32 s35, 1792
    ds_read_b128 a[160:163], v200 offset:20480
    v_mfma_f32_16x16x32_bf16 v[76:79], a[92:95], a[12:15], v[76:79]
    buffer_load_dword v206, v207, s[8:11], s35 offen
    v_mfma_f32_16x16x32_bf16 v[68:71], a[88:91], a[0:3], v[68:71]
    ds_read_b128 a[164:167], v201 offset:20480
    v_mfma_f32_16x16x32_bf16 v[68:71], a[92:95], a[4:7], v[68:71]
    v_mfma_f32_16x16x32_bf16 v[128:131], a[0:3], a[96:99], v[128:131]
    v_mfma_f32_16x16x32_bf16 v[128:131], a[4:7], a[100:103], v[128:131]
    ds_read_b128 a[168:171], v200 offset:22528
    v_mfma_f32_16x16x32_bf16 v[132:135], a[8:11], a[96:99], v[132:135]
    v_mfma_f32_16x16x32_bf16 v[132:135], a[12:15], a[100:103], v[132:135]
    ds_read_b128 a[172:175], v201 offset:22528
    v_mfma_f32_16x16x32_bf16 v[144:147], a[16:19], a[96:99], v[144:147]
    v_mfma_f32_16x16x32_bf16 v[144:147], a[20:23], a[100:103], v[144:147]
    ds_read_b64_tr_b16 a[208:209], v202 offset:24576
    v_mfma_f32_16x16x32_bf16 v[148:151], a[24:27], a[96:99], v[148:151]
    s_cmp_lg_u32 s68, 10
    s_cbranch_scc1 L_nocert10
    s_mov_b64 exec, 1
    buffer_atomic_add v243, off, s[36:39], s75 sc1
    s_mov_b64 exec, -1
    s_nop 3
L_nocert10:
    v_mfma_f32_16x16x32_bf16 v[148:151], a[28:31], a[100:103], v[148:151]
    ds_read_b64_tr_b16 a[210:211], v202 offset:25088
    v_mfma_f32_16x16x32_bf16 v[160:163], a[32:35], a[96:99], v[160:163]
    v_mfma_f32_16x16x32_bf16 v[160:163], a[36:39], a[100:103], v[160:163]
    ds_read_b64_tr_b16 a[212:213], v202 offset:28672
    v_mfma_f32_16x16x32_bf16 v[164:167], a[40:43], a[96:99], v[164:167]
    v_mfma_f32_16x16x32_bf16 v[164:167], a[44:47], a[100:103], v[164:167]
    ds_read_b64_tr_b16 a[214:215], v202 offset:29184
    v_mfma_f32_16x16x32_bf16 v[176:179], a[48:51], a[96:99], v[176:179]
    v_mfma_f32_16x16x32_bf16 v[176:179], a[52:55], a[100:103], v[176:179]
    ds_read_b64_tr_b16 a[216:217], v203 offset:24576
    v_mfma_f32_16x16x32_bf16 v[180:183], a[56:59], a[96:99], v[180:183]
    v_mfma_f32_16x16x32_bf16 v[180:183], a[60:63], a[100:103], v[180:183]
    ds_read_b64_tr_b16 a[218:219], v203 offset:25088
    v_mfma_f32_16x16x32_bf16 v[188:191], a[56:59], a[104:107], v[188:191]
    v_mfma_f32_16x16x32_bf16 v[188:191], a[60:63], a[108:111], v[188:191]
    ds_read_b64_tr_b16 a[220:221], v203 offset:28672
    v_mfma_f32_16x16x32_bf16 v[184:187], a[48:51], a[104:107], v[184:187]
    v_mfma_f32_16x16x32_bf16 v[184:187], a[52:55], a[108:111], v[184:187]
    ds_read_b64_tr_b16 a[222:223], v203 offset:29184
    v_mfma_f32_16x16x32_bf16 v[172:175], a[40:43], a[104:107], v[172:175]
    v_mfma_f32_16x16x32_bf16 v[172:175], a[44:47], a[108:111], v[172:175]
    v_mfma_f32_16x16x32_bf16 v[168:171], a[32:35], a[104:107], v[168:171]
    v_mfma_f32_16x16x32_bf16 v[168:171], a[36:39], a[108:111], v[168:171]
    v_mfma_f32_16x16x32_bf16 v[156:159], a[24:27], a[104:107], v[156:159]
    v_mfma_f32_16x16x32_bf16 v[156:159], a[28:31], a[108:111], v[156:159]
    v_mfma_f32_16x16x32_bf16 v[152:155], a[16:19], a[104:107], v[152:155]
    v_mfma_f32_16x16x32_bf16 v[152:155], a[20:23], a[108:111], v[152:155]
    v_mfma_f32_16x16x32_bf16 v[140:143], a[8:11], a[104:107], v[140:143]
    v_mfma_f32_16x16x32_bf16 v[140:143], a[12:15], a[108:111], v[140:143]
    v_mfma_f32_16x16x32_bf16 v[136:139], a[0:3], a[104:107], v[136:139]
    v_mfma_f32_16x16x32_bf16 v[136:139], a[4:7], a[108:111], v[136:139]
    s_waitcnt vmcnt(14) lgkmcnt(0)
    s_barrier
    v_mfma_f32_16x16x32_bf16 v[0:3], a[176:179], a[112:115], v[0:3]
    s_add_u32 m0, s26, 8192
    s_mov_b32 s28, 5115904
    v_mfma_f32_16x16x32_bf16 v[0:3], a[180:183], a[116:119], v[0:3]
    buffer_load_dwordx4 v196, s[12:15], s28 offen offset:0  lds
    v_mfma_f32_16x16x32_bf16 v[8:11], a[176:179], a[120:123], v[8:11]
    ds_read_b64_tr_b16 a[64:65], v202 offset:32768
    v_mfma_f32_16x16x32_bf16 v[8:11], a[180:183], a[124:127], v[8:11]
    v_mfma_f32_16x16x32_bf16 v[16:19], a[176:179], a[128:131], v[16:19]
    ds_read_b64_tr_b16 a[66:67], v202 offset:33280
    v_mfma_f32_16x16x32_bf16 v[16:19], a[180:183], a[132:135], v[16:19]
    buffer_load_dwordx4 v197, s[12:15], s28 offen offset:1024  lds
    v_mfma_f32_16x16x32_bf16 v[24:27], a[176:179], a[136:139], v[24:27]
    ds_read_b64_tr_b16 a[68:69], v202 offset:36864
    v_mfma_f32_16x16x32_bf16 v[24:27], a[180:183], a[140:143], v[24:27]
    v_mfma_f32_16x16x32_bf16 v[32:35], a[176:179], a[144:147], v[32:35]
    s_add_u32 m0, s26, 16384
    s_mov_b32 s28, 5505024
    ds_read_b64_tr_b16 a[70:71], v202 offset:37376
    v_mfma_f32_16x16x32_bf16 v[32:35], a[180:183], a[148:151], v[32:35]
    buffer_load_dwordx4 v196, s[12:15], s28 offen offset:0  lds
    v_mfma_f32_16x16x32_bf16 v[40:43], a[176:179], a[152:155], v[40:43]
    ds_read_b64_tr_b16 a[72:73], v203 offset:32768
    v_mfma_f32_16x16x32_bf16 v[40:43], a[180:183], a[156:159], v[40:43]
    v_mfma_f32_16x16x32_bf16 v[48:51], a[176:179], a[160:163], v[48:51]
    ds_read_b64_tr_b16 a[74:75], v203 offset:33280
    v_mfma_f32_16x16x32_bf16 v[48:51], a[180:183], a[164:167], v[48:51]
    buffer_load_dwordx4 v197, s[12:15], s28 offen offset:1024  lds
    v_mfma_f32_16x16x32_bf16 v[56:59], a[176:179], a[168:171], v[56:59]
    ds_read_b64_tr_b16 a[76:77], v203 offset:36864
    v_mfma_f32_16x16x32_bf16 v[56:59], a[180:183], a[172:175], v[56:59]
    v_mfma_f32_16x16x32_bf16 v[60:63], a[184:187], a[168:171], v[60:63]
    s_add_u32 m0, s25, 65536
    s_mov_b32 s27, 1792
    ds_read_b64_tr_b16 a[78:79], v203 offset:37376
    v_mfma_f32_16x16x32_bf16 v[60:63], a[188:191], a[172:175], v[60:63]
    buffer_load_dwordx4 v192, s[8:11], s27 offen offset:0  lds
    v_mfma_f32_16x16x32_bf16 v[52:55], a[184:187], a[160:163], v[52:55]
    ds_read_b128 a[0:3], v198 offset:0
    v_mfma_f32_16x16x32_bf16 v[52:55], a[188:191], a[164:167], v[52:55]
    v_mfma_f32_16x16x32_bf16 v[44:47], a[184:187], a[152:155], v[44:47]
    ds_read_b128 a[4:7], v199 offset:0
    v_mfma_f32_16x16x32_bf16 v[44:47], a[188:191], a[156:159], v[44:47]
    buffer_load_dwordx4 v193, s[8:11], s27 offen offset:1024  lds
    v_mfma_f32_16x16x32_bf16 v[36:39], a[184:187], a[144:147], v[36:39]
    v_mfma_f32_16x16x32_bf16 v[36:39], a[188:191], a[148:151], v[36:39]
    ds_read_b128 a[8:11], v198 offset:2048
    v_mfma_f32_16x16x32_bf16 v[28:31], a[184:187], a[136:139], v[28:31]
    v_mfma_f32_16x16x32_bf16 v[28:31], a[188:191], a[140:143], v[28:31]
    buffer_load_dwordx4 v194, s[8:11], s27 offen offset:2048  lds
    ds_read_b128 a[12:15], v199 offset:2048
    v_mfma_f32_16x16x32_bf16 v[20:23], a[184:187], a[128:131], v[20:23]
    v_mfma_f32_16x16x32_bf16 v[20:23], a[188:191], a[132:135], v[20:23]
    ds_read_b128 a[16:19], v198 offset:4096
    v_mfma_f32_16x16x32_bf16 v[12:15], a[184:187], a[120:123], v[12:15]
    v_mfma_f32_16x16x32_bf16 v[12:15], a[188:191], a[124:127], v[12:15]
    buffer_load_dwordx4 v195, s[8:11], s27 offen offset:3072  lds
    ds_read_b128 a[20:23], v199 offset:4096
    v_mfma_f32_16x16x32_bf16 v[4:7], a[184:187], a[112:115], v[4:7]
    v_mfma_f32_16x16x32_bf16 v[4:7], a[188:191], a[116:119], v[4:7]
    ds_read_b128 a[24:27], v198 offset:6144
    v_mfma_f32_16x16x32_bf16 v[64:67], a[192:195], a[112:115], v[64:67]
    s_add_u32 m0, s26, 24576
    s_mov_b32 s28, 5507072
    v_mfma_f32_16x16x32_bf16 v[64:67], a[196:199], a[116:119], v[64:67]
    buffer_load_dwordx4 v196, s[12:15], s28 offen offset:0  lds
    ds_read_b128 a[28:31], v199 offset:6144
    v_mfma_f32_16x16x32_bf16 v[72:75], a[192:195], a[120:123], v[72:75]
    v_mfma_f32_16x16x32_bf16 v[72:75], a[196:199], a[124:127], v[72:75]
    ds_read_b64_tr_b16 a[80:81], v202 offset:40960
    v_mfma_f32_16x16x32_bf16 v[80:83], a[192:195], a[128:131], v[80:83]
    v_mfma_f32_16x16x32_bf16 v[80:83], a[196:199], a[132:135], v[80:83]
    buffer_load_dwordx4 v197, s[12:15], s28 offen offset:1024  lds
    ds_read_b64_tr_b16 a[82:83], v202 offset:41472
    v_mfma_f32_16x16x32_bf16 v[88:91], a[192:195], a[136:139], v[88:91]
    v_mfma_f32_16x16x32_bf16 v[88:91], a[196:199], a[140:143], v[88:91]
    ds_read_b64_tr_b16 a[84:85], v202 offset:45056
    v_mfma_f32_16x16x32_bf16 v[96:99], a[192:195], a[144:147], v[96:99]
    s_add_u32 m0, s25, 81920
    s_mov_b32 s27, 132864
    v_mfma_f32_16x16x32_bf16 v[96:99], a[196:199], a[148:151], v[96:99]
    buffer_load_dwordx4 v192, s[8:11], s27 offen offset:0  lds
    ds_read_b64_tr_b16 a[86:87], v202 offset:45568
    v_mfma_f32_16x16x32_bf16 v[104:107], a[192:195], a[152:155], v[104:107]
    v_mfma_f32_16x16x32_bf16 v[104:107], a[196:199], a[156:159], v[104:107]
    v_mfma_f32_16x16x32_bf16 v[112:115], a[192:195], a[160:163], v[112:115]
    ds_read_b64_tr_b16 a[88:89], v203 offset:40960
    v_mfma_f32_16x16x32_bf16 v[112:115], a[196:199], a[164:167], v[112:115]
    buffer_load_dwordx4 v193, s[8:11], s27 offen offset:1024  lds
    v_mfma_f32_16x16x32_bf16 v[120:123], a[192:195], a[168:171], v[120:123]
    ds_read_b64_tr_b16 a[90:91], v203 offset:41472
    v_mfma_f32_16x16x32_bf16 v[120:123], a[196:199], a[172:175], v[120:123]
    v_mfma_f32_16x16x32_bf16 v[124:127], a[200:203], a[168:171], v[124:127]
    ds_read_b64_tr_b16 a[92:93], v203 offset:45056
    v_mfma_f32_16x16x32_bf16 v[124:127], a[204:207], a[172:175], v[124:127]
    buffer_load_dwordx4 v194, s[8:11], s27 offen offset:2048  lds
    v_mfma_f32_16x16x32_bf16 v[116:119], a[200:203], a[160:163], v[116:119]
    ds_read_b64_tr_b16 a[94:95], v203 offset:45568
    v_mfma_f32_16x16x32_bf16 v[116:119], a[204:207], a[164:167], v[116:119]
    v_mfma_f32_16x16x32_bf16 v[108:111], a[200:203], a[152:155], v[108:111]
L_rca:
    ds_read_b128 a[32:35], v198 offset:16384
    v_mfma_f32_16x16x32_bf16 v[108:111], a[204:207], a[156:159], v[108:111]
    buffer_load_dwordx4 v195, s[8:11], s27 offen offset:3072  lds
    s_getpc_b64 s[6:7]
    s_lshr_b32 s3, s2, 3
    v_mfma_f32_16x16x32_bf16 v[100:103], a[200:203], a[144:147], v[100:103]
    s_lshl_b32 s3, s3, 2
    s_add_u32 s3, s3, s24
    ds_read_b128 a[36:39], v199 offset:16384
    v_mfma_f32_16x16x32_bf16 v[100:103], a[204:207], a[148:151], v[100:103]
    s_lshl_b32 s3, s3, 8
    v_min_u32_e64 v229, 1, v209
    v_mfma_f32_16x16x32_bf16 v[92:95], a[200:203], a[136:139], v[92:95]
    v_lshl_add_u32 v229, v229, 7, s3
    v_min_u32 v229, 26624, v229
    ds_read_b128 a[40:43], v198 offset:18432
    v_mfma_f32_16x16x32_bf16 v[92:95], a[204:207], a[140:143], v[92:95]
    global_load_dword a255, v229, s[6:7]
    v_mfma_f32_16x16x32_bf16 v[84:87], a[200:203], a[128:131], v[84:87]
    ds_read_b128 a[44:47], v199 offset:18432
    v_mfma_f32_16x16x32_bf16 v[84:87], a[204:207], a[132:135], v[84:87]
    v_mfma_f32_16x16x32_bf16 v[76:79], a[200:203], a[120:123], v[76:79]
    ds_read_b128 a[48:51], v198 offset:20480
    v_mfma_f32_16x16x32_bf16 v[76:79], a[204:207], a[124:127], v[76:79]
    v_mfma_f32_16x16x32_bf16 v[68:71], a[200:203], a[112:115], v[68:71]
    ds_read_b128 a[52:55], v199 offset:20480
    v_mfma_f32_16x16x32_bf16 v[68:71], a[204:207], a[116:119], v[68:71]
    v_mfma_f32_16x16x32_bf16 v[128:131], a[112:115], a[208:211], v[128:131]
    v_mfma_f32_16x16x32_bf16 v[128:131], a[116:119], a[212:215], v[128:131]
    ds_read_b128 a[56:59], v198 offset:22528
    v_mfma_f32_16x16x32_bf16 v[132:135], a[120:123], a[208:211], v[132:135]
    v_mfma_f32_16x16x32_bf16 v[132:135], a[124:127], a[212:215], v[132:135]
    ds_read_b128 a[60:63], v199 offset:22528
    v_mfma_f32_16x16x32_bf16 v[144:147], a[128:131], a[208:211], v[144:147]
    v_mfma_f32_16x16x32_bf16 v[144:147], a[132:135], a[212:215], v[144:147]
    ds_read_b64_tr_b16 a[96:97], v202 offset:49152
    v_mfma_f32_16x16x32_bf16 v[148:151], a[136:139], a[208:211], v[148:151]
    s_cmp_lg_u32 s68, 11
    s_cbranch_scc1 L_nocert11
    s_mov_b64 exec, 1
    buffer_atomic_add v243, off, s[36:39], s75 sc1
    s_mov_b64 exec, -1
L_pg3:
    s_cbranch_execz L_body
    s_nop 3
L_nocert11:
    v_mfma_f32_16x16x32_bf16 v[148:151], a[140:143], a[212:215], v[148:151]
    ds_read_b64_tr_b16 a[98:99], v202 offset:49664
    v_mfma_f32_16x16x32_bf16 v[160:163], a[144:147], a[208:211], v[160:163]
    v_mfma_f32_16x16x32_bf16 v[160:163], a[148:151], a[212:215], v[160:163]
    ds_read_b64_tr_b16 a[100:101], v202 offset:53248
    v_mfma_f32_16x16x32_bf16 v[164:167], a[152:155], a[208:211], v[164:167]
    v_mfma_f32_16x16x32_bf16 v[164:167], a[156:159], a[212:215], v[164:167]
    ds_read_b64_tr_b16 a[102:103], v202 offset:53760
    v_mfma_f32_16x16x32_bf16 v[176:179], a[160:163], a[208:211], v[176:179]
    v_mfma_f32_16x16x32_bf16 v[176:179], a[164:167], a[212:215], v[176:179]
    ds_read_b64_tr_b16 a[104:105], v203 offset:49152
    v_mfma_f32_16x16x32_bf16 v[180:183], a[168:171], a[208:211], v[180:183]
    v_mfma_f32_16x16x32_bf16 v[180:183], a[172:175], a[212:215], v[180:183]
    ds_read_b64_tr_b16 a[106:107], v203 offset:49664
    v_mfma_f32_16x16x32_bf16 v[188:191], a[168:171], a[216:219], v[188:191]
    s_mov_b32 s64, s20
    v_mfma_f32_16x16x32_bf16 v[188:191], a[172:175], a[220:223], v[188:191]
    ds_read_b64_tr_b16 a[108:109], v203 offset:53248
    v_mfma_f32_16x16x32_bf16 v[184:187], a[160:163], a[216:219], v[184:187]
    s_mov_b32 s65, s21
    v_mfma_f32_16x16x32_bf16 v[184:187], a[164:167], a[220:223], v[184:187]
    ds_read_b64_tr_b16 a[110:111], v203 offset:53760
    v_mfma_f32_16x16x32_bf16 v[172:175], a[152:155], a[216:219], v[172:175]
    v_mfma_f32_16x16x32_bf16 v[172:175], a[156:159], a[220:223], v[172:175]
    s_mov_b32 s66, 0x10000
    v_mfma_f32_16x16x32_bf16 v[168:171], a[144:147], a[216:219], v[168:171]
    v_mfma_f32_16x16x32_bf16 v[168:171], a[148:151], a[220:223], v[168:171]
    s_mov_b32 s67, 0x20000
    v_mfma_f32_16x16x32_bf16 v[156:159], a[136:139], a[216:219], v[156:159]
    v_mfma_f32_16x16x32_bf16 v[156:159], a[140:143], a[220:223], v[156:159]
    v_mfma_f32_16x16x32_bf16 v[152:155], a[128:131], a[216:219], v[152:155]
    v_mfma_f32_16x16x32_bf16 v[152:155], a[132:135], a[220:223], v[152:155]
    v_mfma_f32_16x16x32_bf16 v[140:143], a[120:123], a[216:219], v[140:143]
    v_mfma_f32_16x16x32_bf16 v[140:143], a[124:127], a[220:223], v[140:143]
    v_mfma_f32_16x16x32_bf16 v[136:139], a[112:115], a[216:219], v[136:139]
    v_mfma_f32_16x16x32_bf16 v[136:139], a[116:119], a[220:223], v[136:139]
    s_waitcnt vmcnt(13) lgkmcnt(0)
    s_barrier
    v_mfma_f32_16x16x32_bf16 v[0:3], a[64:67], a[0:3], v[0:3]
    s_add_u32 m0, s26, 32768
    s_mov_b32 s28, 5509120
    v_mfma_f32_16x16x32_bf16 v[0:3], a[68:71], a[4:7], v[0:3]
    buffer_load_dwordx4 v196, s[12:15], s28 offen offset:0  lds
    v_mfma_f32_16x16x32_bf16 v[8:11], a[64:67], a[8:11], v[8:11]
    ds_read_b64_tr_b16 a[176:177], v202 offset:57344
    v_mfma_f32_16x16x32_bf16 v[8:11], a[68:71], a[12:15], v[8:11]
    v_mfma_f32_16x16x32_bf16 v[16:19], a[64:67], a[16:19], v[16:19]
    ds_read_b64_tr_b16 a[178:179], v202 offset:57856
    v_mfma_f32_16x16x32_bf16 v[16:19], a[68:71], a[20:23], v[16:19]
    buffer_load_dwordx4 v197, s[12:15], s28 offen offset:1024  lds
    v_mfma_f32_16x16x32_bf16 v[24:27], a[64:67], a[24:27], v[24:27]
    ds_read_b64_tr_b16 a[180:181], v202 offset:61440
    v_mfma_f32_16x16x32_bf16 v[24:27], a[68:71], a[28:31], v[24:27]
    v_mfma_f32_16x16x32_bf16 v[32:35], a[64:67], a[32:35], v[32:35]
    s_add_u32 m0, s26, 40960
    s_mov_b32 s28, 5898240
    ds_read_b64_tr_b16 a[182:183], v202 offset:61952
    v_mfma_f32_16x16x32_bf16 v[32:35], a[68:71], a[36:39], v[32:35]
    buffer_load_dwordx4 v196, s[12:15], s28 offen offset:0  lds
    v_mfma_f32_16x16x32_bf16 v[40:43], a[64:67], a[40:43], v[40:43]
    ds_read_b64_tr_b16 a[184:185], v203 offset:57344
    v_mfma_f32_16x16x32_bf16 v[40:43], a[68:71], a[44:47], v[40:43]
    v_mfma_f32_16x16x32_bf16 v[48:51], a[64:67], a[48:51], v[48:51]
    ds_read_b64_tr_b16 a[186:187], v203 offset:57856
    v_mfma_f32_16x16x32_bf16 v[48:51], a[68:71], a[52:55], v[48:51]
    buffer_load_dwordx4 v197, s[12:15], s28 offen offset:1024  lds
    v_mfma_f32_16x16x32_bf16 v[56:59], a[64:67], a[56:59], v[56:59]
    ds_read_b64_tr_b16 a[188:189], v203 offset:61440
    v_mfma_f32_16x16x32_bf16 v[56:59], a[68:71], a[60:63], v[56:59]
    v_mfma_f32_16x16x32_bf16 v[60:63], a[72:75], a[56:59], v[60:63]
    s_add_u32 m0, s25, 0
    s_mov_b32 s27, 1920
    ds_read_b64_tr_b16 a[190:191], v203 offset:61952
    v_mfma_f32_16x16x32_bf16 v[60:63], a[76:79], a[60:63], v[60:63]
    buffer_load_dwordx4 v192, s[8:11], s27 offen offset:0  lds
    v_mfma_f32_16x16x32_bf16 v[52:55], a[72:75], a[48:51], v[52:55]
    ds_read_b128 a[112:115], v198 offset:32768
    v_mfma_f32_16x16x32_bf16 v[52:55], a[76:79], a[52:55], v[52:55]
    v_mfma_f32_16x16x32_bf16 v[44:47], a[72:75], a[40:43], v[44:47]
    ds_read_b128 a[116:119], v199 offset:32768
    v_mfma_f32_16x16x32_bf16 v[44:47], a[76:79], a[44:47], v[44:47]
    buffer_load_dwordx4 v193, s[8:11], s27 offen offset:1024  lds
    v_mfma_f32_16x16x32_bf16 v[36:39], a[72:75], a[32:35], v[36:39]
    v_mfma_f32_16x16x32_bf16 v[36:39], a[76:79], a[36:39], v[36:39]
    ds_read_b128 a[120:123], v198 offset:34816
    v_mfma_f32_16x16x32_bf16 v[28:31], a[72:75], a[24:27], v[28:31]
    v_mfma_f32_16x16x32_bf16 v[28:31], a[76:79], a[28:31], v[28:31]
    buffer_load_dwordx4 v194, s[8:11], s27 offen offset:2048  lds
    ds_read_b128 a[124:127], v199 offset:34816
    v_mfma_f32_16x16x32_bf16 v[20:23], a[72:75], a[16:19], v[20:23]
    v_mfma_f32_16x16x32_bf16 v[20:23], a[76:79], a[20:23], v[20:23]
    ds_read_b128 a[128:131], v198 offset:36864
    v_mfma_f32_16x16x32_bf16 v[12:15], a[72:75], a[8:11], v[12:15]
    v_mfma_f32_16x16x32_bf16 v[12:15], a[76:79], a[12:15], v[12:15]
    buffer_load_dwordx4 v195, s[8:11], s27 offen offset:3072  lds
    ds_read_b128 a[132:135], v199 offset:36864
    v_mfma_f32_16x16x32_bf16 v[4:7], a[72:75], a[0:3], v[4:7]
    v_mfma_f32_16x16x32_bf16 v[4:7], a[76:79], a[4:7], v[4:7]
    ds_read_b128 a[136:139], v198 offset:38912
    v_mfma_f32_16x16x32_bf16 v[64:67], a[80:83], a[0:3], v[64:67]
    s_add_u32 m0, s26, 49152
    s_mov_b32 s28, 5900288
    v_mfma_f32_16x16x32_bf16 v[64:67], a[84:87], a[4:7], v[64:67]
    buffer_load_dwordx4 v196, s[12:15], s28 offen offset:0  lds
    ds_read_b128 a[140:143], v199 offset:38912
    v_mfma_f32_16x16x32_bf16 v[72:75], a[80:83], a[8:11], v[72:75]
    v_mfma_f32_16x16x32_bf16 v[72:75], a[84:87], a[12:15], v[72:75]
    ds_read_b64_tr_b16 a[192:193], v202 offset:0
    v_mfma_f32_16x16x32_bf16 v[80:83], a[80:83], a[16:19], v[80:83]
    v_mfma_f32_16x16x32_bf16 v[80:83], a[84:87], a[20:23], v[80:83]
    buffer_load_dwordx4 v197, s[12:15], s28 offen offset:1024  lds
    ds_read_b64_tr_b16 a[194:195], v202 offset:512
    v_mfma_f32_16x16x32_bf16 v[88:91], a[80:83], a[24:27], v[88:91]
    v_mfma_f32_16x16x32_bf16 v[88:91], a[84:87], a[28:31], v[88:91]
    ds_read_b64_tr_b16 a[196:197], v202 offset:4096
    v_mfma_f32_16x16x32_bf16 v[96:99], a[80:83], a[32:35], v[96:99]
    s_add_u32 m0, s25, 16384
    s_mov_b32 s27, 132992
    v_mfma_f32_16x16x32_bf16 v[96:99], a[84:87], a[36:39], v[96:99]
    buffer_load_dwordx4 v192, s[8:11], s27 offen offset:0  lds
    ds_read_b64_tr_b16 a[198:199], v202 offset:4608
    v_mfma_f32_16x16x32_bf16 v[104:107], a[80:83], a[40:43], v[104:107]
    v_mfma_f32_16x16x32_bf16 v[104:107], a[84:87], a[44:47], v[104:107]
    v_mfma_f32_16x16x32_bf16 v[112:115], a[80:83], a[48:51], v[112:115]
    ds_read_b64_tr_b16 a[200:201], v203 offset:0
    v_mfma_f32_16x16x32_bf16 v[112:115], a[84:87], a[52:55], v[112:115]
    buffer_load_dwordx4 v193, s[8:11], s27 offen offset:1024  lds
    v_mfma_f32_16x16x32_bf16 v[120:123], a[80:83], a[56:59], v[120:123]
    ds_read_b64_tr_b16 a[202:203], v203 offset:512
    v_mfma_f32_16x16x32_bf16 v[120:123], a[84:87], a[60:63], v[120:123]
    v_mfma_f32_16x16x32_bf16 v[124:127], a[88:91], a[56:59], v[124:127]
    ds_read_b64_tr_b16 a[204:205], v203 offset:4096
    v_mfma_f32_16x16x32_bf16 v[124:127], a[92:95], a[60:63], v[124:127]
    buffer_load_dwordx4 v194, s[8:11], s27 offen offset:2048  lds
    v_mfma_f32_16x16x32_bf16 v[116:119], a[88:91], a[48:51], v[116:119]
    ds_read_b64_tr_b16 a[206:207], v203 offset:4608
    v_mfma_f32_16x16x32_bf16 v[116:119], a[92:95], a[52:55], v[116:119]
    v_mfma_f32_16x16x32_bf16 v[108:111], a[88:91], a[40:43], v[108:111]
    ds_read_b128 a[144:147], v198 offset:49152
    v_mfma_f32_16x16x32_bf16 v[108:111], a[92:95], a[44:47], v[108:111]
    buffer_load_dwordx4 v195, s[8:11], s27 offen offset:3072  lds
    v_mfma_f32_16x16x32_bf16 v[100:103], a[88:91], a[32:35], v[100:103]
    ds_read_b128 a[148:151], v199 offset:49152
    v_mfma_f32_16x16x32_bf16 v[100:103], a[92:95], a[36:39], v[100:103]
    v_mfma_f32_16x16x32_bf16 v[92:95], a[88:91], a[24:27], v[92:95]
    ds_read_b128 a[152:155], v198 offset:51200
    v_mfma_f32_16x16x32_bf16 v[92:95], a[92:95], a[28:31], v[92:95]
    v_mfma_f32_16x16x32_bf16 v[84:87], a[88:91], a[16:19], v[84:87]
    ds_read_b128 a[156:159], v199 offset:51200
    v_mfma_f32_16x16x32_bf16 v[84:87], a[92:95], a[20:23], v[84:87]
    v_mfma_f32_16x16x32_bf16 v[76:79], a[88:91], a[8:11], v[76:79]
    buffer_load_ushort v240, v210, s[64:67], 0 offen offset:0
    ds_read_b128 a[160:163], v198 offset:53248
    v_mfma_f32_16x16x32_bf16 v[76:79], a[92:95], a[12:15], v[76:79]
    v_mfma_f32_16x16x32_bf16 v[68:71], a[88:91], a[0:3], v[68:71]
    buffer_load_ushort v241, v210, s[64:67], 0 offen offset:64
    ds_read_b128 a[164:167], v199 offset:53248
    v_mfma_f32_16x16x32_bf16 v[68:71], a[92:95], a[4:7], v[68:71]
    v_mfma_f32_16x16x32_bf16 v[128:131], a[0:3], a[96:99], v[128:131]
    buffer_load_ushort v242, v210, s[64:67], 0 offen offset:128
    v_mfma_f32_16x16x32_bf16 v[128:131], a[4:7], a[100:103], v[128:131]
    ds_read_b128 a[168:171], v198 offset:55296
    v_mfma_f32_16x16x32_bf16 v[132:135], a[8:11], a[96:99], v[132:135]
    buffer_load_ushort v243, v210, s[64:67], 0 offen offset:192
    v_mfma_f32_16x16x32_bf16 v[132:135], a[12:15], a[100:103], v[132:135]
    ds_read_b128 a[172:175], v199 offset:55296
    v_mfma_f32_16x16x32_bf16 v[144:147], a[16:19], a[96:99], v[144:147]
    buffer_load_ushort v244, v210, s[64:67], 0 offen offset:1024
    v_mfma_f32_16x16x32_bf16 v[144:147], a[20:23], a[100:103], v[144:147]
    ds_read_b64_tr_b16 a[208:209], v202 offset:8192
    v_mfma_f32_16x16x32_bf16 v[148:151], a[24:27], a[96:99], v[148:151]
    buffer_load_ushort v245, v210, s[64:67], 0 offen offset:1088
    v_mfma_f32_16x16x32_bf16 v[148:151], a[28:31], a[100:103], v[148:151]
    ds_read_b64_tr_b16 a[210:211], v202 offset:8704
    v_mfma_f32_16x16x32_bf16 v[160:163], a[32:35], a[96:99], v[160:163]
    buffer_load_ushort v246, v210, s[64:67], 0 offen offset:1152
    v_mfma_f32_16x16x32_bf16 v[160:163], a[36:39], a[100:103], v[160:163]
    ds_read_b64_tr_b16 a[212:213], v202 offset:12288
    v_mfma_f32_16x16x32_bf16 v[164:167], a[40:43], a[96:99], v[164:167]
    buffer_load_ushort v247, v210, s[64:67], 0 offen offset:1216
    v_mfma_f32_16x16x32_bf16 v[164:167], a[44:47], a[100:103], v[164:167]
    ds_read_b64_tr_b16 a[214:215], v202 offset:12800
    v_mfma_f32_16x16x32_bf16 v[176:179], a[48:51], a[96:99], v[176:179]
    buffer_load_ushort v248, v210, s[64:67], 0 offen offset:32
    v_mfma_f32_16x16x32_bf16 v[176:179], a[52:55], a[100:103], v[176:179]
    ds_read_b64_tr_b16 a[216:217], v203 offset:8192
    v_mfma_f32_16x16x32_bf16 v[180:183], a[56:59], a[96:99], v[180:183]
    buffer_load_ushort v249, v210, s[64:67], 0 offen offset:96
    v_mfma_f32_16x16x32_bf16 v[180:183], a[60:63], a[100:103], v[180:183]
    ds_read_b64_tr_b16 a[218:219], v203 offset:8704
    v_mfma_f32_16x16x32_bf16 v[188:191], a[56:59], a[104:107], v[188:191]
    buffer_load_ushort v250, v210, s[64:67], 0 offen offset:160
    v_mfma_f32_16x16x32_bf16 v[188:191], a[60:63], a[108:111], v[188:191]
    ds_read_b64_tr_b16 a[220:221], v203 offset:12288
    v_mfma_f32_16x16x32_bf16 v[184:187], a[48:51], a[104:107], v[184:187]
    buffer_load_ushort v251, v210, s[64:67], 0 offen offset:224
    v_mfma_f32_16x16x32_bf16 v[184:187], a[52:55], a[108:111], v[184:187]
    ds_read_b64_tr_b16 a[222:223], v203 offset:12800
    v_mfma_f32_16x16x32_bf16 v[172:175], a[40:43], a[104:107], v[172:175]
    buffer_load_ushort v252, v210, s[64:67], 0 offen offset:1056
    v_mfma_f32_16x16x32_bf16 v[172:175], a[44:47], a[108:111], v[172:175]
    v_mfma_f32_16x16x32_bf16 v[168:171], a[32:35], a[104:107], v[168:171]
    buffer_load_ushort v253, v210, s[64:67], 0 offen offset:1120
    v_mfma_f32_16x16x32_bf16 v[168:171], a[36:39], a[108:111], v[168:171]
    v_mfma_f32_16x16x32_bf16 v[156:159], a[24:27], a[104:107], v[156:159]
    buffer_load_ushort v254, v210, s[64:67], 0 offen offset:1184
    v_mfma_f32_16x16x32_bf16 v[156:159], a[28:31], a[108:111], v[156:159]
    v_mfma_f32_16x16x32_bf16 v[152:155], a[16:19], a[104:107], v[152:155]
    buffer_load_ushort v255, v210, s[64:67], 0 offen offset:1248
    v_mfma_f32_16x16x32_bf16 v[152:155], a[20:23], a[108:111], v[152:155]
    v_mfma_f32_16x16x32_bf16 v[140:143], a[8:11], a[104:107], v[140:143]
    v_mfma_f32_16x16x32_bf16 v[140:143], a[12:15], a[108:111], v[140:143]
    v_mfma_f32_16x16x32_bf16 v[136:139], a[0:3], a[104:107], v[136:139]
    v_mfma_f32_16x16x32_bf16 v[136:139], a[4:7], a[108:111], v[136:139]
    s_waitcnt vmcnt(28) lgkmcnt(0)
    s_barrier
    v_mfma_f32_16x16x32_bf16 v[0:3], a[176:179], a[112:115], v[0:3]
    s_add_u32 m0, s26, 57344
    s_mov_b32 s28, 5902336
    v_mfma_f32_16x16x32_bf16 v[0:3], a[180:183], a[116:119], v[0:3]
    buffer_load_dwordx4 v196, s[12:15], s28 offen offset:0  lds
    v_mfma_f32_16x16x32_bf16 v[8:11], a[176:179], a[120:123], v[8:11]
    ds_read_b64_tr_b16 a[64:65], v202 offset:16384
    v_mfma_f32_16x16x32_bf16 v[8:11], a[180:183], a[124:127], v[8:11]
    v_mfma_f32_16x16x32_bf16 v[16:19], a[176:179], a[128:131], v[16:19]
    v_lshrrev_b32 v230, 3, v209
    ds_read_b64_tr_b16 a[66:67], v202 offset:16896
    v_mfma_f32_16x16x32_bf16 v[16:19], a[180:183], a[132:135], v[16:19]
    v_and_b32_e64 v231, 7, v209
    buffer_load_dwordx4 v197, s[12:15], s28 offen offset:1024  lds
    v_mfma_f32_16x16x32_bf16 v[24:27], a[176:179], a[136:139], v[24:27]
    v_and_b32_e64 v232, 6, v230
    ds_read_b64_tr_b16 a[68:69], v202 offset:20480
    v_mfma_f32_16x16x32_bf16 v[24:27], a[180:183], a[140:143], v[24:27]
    v_xor_b32_e64 v231, v231, v232
    v_mfma_f32_16x16x32_bf16 v[32:35], a[176:179], a[144:147], v[32:35]
    ds_read_b64_tr_b16 a[70:71], v202 offset:20992
    v_mfma_f32_16x16x32_bf16 v[32:35], a[180:183], a[148:151], v[32:35]
    s_lshl_b32 s3, s24, 4
    v_mfma_f32_16x16x32_bf16 v[40:43], a[176:179], a[152:155], v[40:43]
    v_add_u32 v230, s3, v230
    ds_read_b64_tr_b16 a[72:73], v203 offset:16384
    v_mfma_f32_16x16x32_bf16 v[40:43], a[180:183], a[156:159], v[40:43]
    v_lshlrev_b32_e64 v230, 11, v230
    v_mfma_f32_16x16x32_bf16 v[48:51], a[176:179], a[160:163], v[48:51]
    v_lshl_add_u32 v236, v231, 4, v230
    ds_read_b64_tr_b16 a[74:75], v203 offset:16896
    v_mfma_f32_16x16x32_bf16 v[48:51], a[180:183], a[164:167], v[48:51]
    v_mfma_f32_16x16x32_bf16 v[56:59], a[176:179], a[168:171], v[56:59]
    v_add_u32 v232, 2048, v236
    ds_read_b64_tr_b16 a[76:77], v203 offset:20480
    v_mfma_f32_16x16x32_bf16 v[56:59], a[180:183], a[172:175], v[56:59]
    v_add_u32 v234, 17408, v236
    v_mfma_f32_16x16x32_bf16 v[60:63], a[184:187], a[168:171], v[60:63]
    v_add_u32 v238, 15488, v236
    ds_read_b64_tr_b16 a[78:79], v203 offset:20992
    v_mfma_f32_16x16x32_bf16 v[60:63], a[188:191], a[172:175], v[60:63]
    v_add_u32 v236, 128, v236
    v_mfma_f32_16x16x32_bf16 v[52:55], a[184:187], a[160:163], v[52:55]
    ds_read_b128 a[0:3], v200 offset:0
    v_mfma_f32_16x16x32_bf16 v[52:55], a[188:191], a[164:167], v[52:55]
    v_mfma_f32_16x16x32_bf16 v[44:47], a[184:187], a[152:155], v[44:47]
    s_waitcnt vmcnt(2)
    ds_read_b128 a[4:7], v201 offset:0
    v_mfma_f32_16x16x32_bf16 v[44:47], a[188:191], a[156:159], v[44:47]
    v_lshl_or_b32 v212, v241, 16, v240
    v_mfma_f32_16x16x32_bf16 v[36:39], a[184:187], a[144:147], v[36:39]
    v_lshl_or_b32 v213, v243, 16, v242
    v_mfma_f32_16x16x32_bf16 v[36:39], a[188:191], a[148:151], v[36:39]
    ds_read_b128 a[8:11], v200 offset:2048
    v_mfma_f32_16x16x32_bf16 v[28:31], a[184:187], a[136:139], v[28:31]
    v_lshl_or_b32 v214, v245, 16, v244
    v_mfma_f32_16x16x32_bf16 v[28:31], a[188:191], a[140:143], v[28:31]
    v_lshl_or_b32 v215, v247, 16, v246
    ds_read_b128 a[12:15], v201 offset:2048
    v_mfma_f32_16x16x32_bf16 v[20:23], a[184:187], a[128:131], v[20:23]
    v_lshl_or_b32 v216, v249, 16, v248
    v_mfma_f32_16x16x32_bf16 v[20:23], a[188:191], a[132:135], v[20:23]
    ds_read_b128 a[16:19], v200 offset:4096
    v_mfma_f32_16x16x32_bf16 v[12:15], a[184:187], a[120:123], v[12:15]
    v_lshl_or_b32 v217, v251, 16, v250
    v_mfma_f32_16x16x32_bf16 v[12:15], a[188:191], a[124:127], v[12:15]
    v_lshl_or_b32 v218, v253, 16, v252
    ds_read_b128 a[20:23], v201 offset:4096
    v_mfma_f32_16x16x32_bf16 v[4:7], a[184:187], a[112:115], v[4:7]
    v_lshl_or_b32 v219, v255, 16, v254
    v_mfma_f32_16x16x32_bf16 v[4:7], a[188:191], a[116:119], v[4:7]
    ds_read_b128 a[24:27], v200 offset:6144
    v_mfma_f32_16x16x32_bf16 v[64:67], a[192:195], a[112:115], v[64:67]
    v_mfma_f32_16x16x32_bf16 v[64:67], a[196:199], a[116:119], v[64:67]
    v_mov_b32 v220, 1065369472
    ds_read_b128 a[28:31], v201 offset:6144
    v_mfma_f32_16x16x32_bf16 v[72:75], a[192:195], a[120:123], v[72:75]
    v_mov_b32 v221, 1065369472
    v_mfma_f32_16x16x32_bf16 v[72:75], a[196:199], a[124:127], v[72:75]
    v_mov_b32 v222, 1065369472
    ds_read_b64_tr_b16 a[80:81], v202 offset:24576
    v_mfma_f32_16x16x32_bf16 v[80:83], a[192:195], a[128:131], v[80:83]
    v_mov_b32 v223, 1065369472
    v_mfma_f32_16x16x32_bf16 v[80:83], a[196:199], a[132:135], v[80:83]
    s_lshl_b32 s4, s33, 31
    ds_read_b64_tr_b16 a[82:83], v202 offset:25088
    v_mfma_f32_16x16x32_bf16 v[88:91], a[192:195], a[136:139], v[88:91]
    s_xor_b32 s4, s4, 1069066811
    v_mfma_f32_16x16x32_bf16 v[88:91], a[196:199], a[140:143], v[88:91]
    ds_read_b64_tr_b16 a[84:85], v202 offset:28672
    v_mfma_f32_16x16x32_bf16 v[96:99], a[192:195], a[144:147], v[96:99]
    v_mov_b32_e64 v224, s4
    v_mfma_f32_16x16x32_bf16 v[96:99], a[196:199], a[148:151], v[96:99]
    v_mov_b32_e64 v237, 0
    ds_read_b64_tr_b16 a[86:87], v202 offset:29184
    v_mfma_f32_16x16x32_bf16 v[104:107], a[192:195], a[152:155], v[104:107]
    v_mov_b32_e64 v208, 1
    v_mfma_f32_16x16x32_bf16 v[104:107], a[196:199], a[156:159], v[104:107]
    v_and_b32_e64 v240, 15, v209
    v_mfma_f32_16x16x32_bf16 v[112:115], a[192:195], a[160:163], v[112:115]
    v_lshrrev_b32_e64 v241, 4, v209
    ds_read_b64_tr_b16 a[88:89], v203 offset:24576
    v_mfma_f32_16x16x32_bf16 v[112:115], a[196:199], a[164:167], v[112:115]
    v_lshrrev_b32_e64 v242, 2, v240
    v_mfma_f32_16x16x32_bf16 v[120:123], a[192:195], a[168:171], v[120:123]
    ds_read_b64_tr_b16 a[90:91], v203 offset:25088
    v_mfma_f32_16x16x32_bf16 v[120:123], a[196:199], a[172:175], v[120:123]
    v_and_b32_e64 v243, 1, v240
    v_mfma_f32_16x16x32_bf16 v[124:127], a[200:203], a[168:171], v[124:127]
    v_lshlrev_b32_e64 v243, 4, v243
    ds_read_b64_tr_b16 a[92:93], v203 offset:28672
    v_mfma_f32_16x16x32_bf16 v[124:127], a[204:207], a[172:175], v[124:127]
    v_mov_b32 v244, 0x3f80
    v_mfma_f32_16x16x32_bf16 v[116:119], a[200:203], a[160:163], v[116:119]
    v_accvgpr_write_b32 a242, v244
    ds_read_b64_tr_b16 a[94:95], v203 offset:29184
    v_mfma_f32_16x16x32_bf16 v[116:119], a[204:207], a[164:167], v[116:119]
    v_accvgpr_write_b32 a243, v244
    v_mfma_f32_16x16x32_bf16 v[108:111], a[200:203], a[152:155], v[108:111]
    v_lshlrev_b32_e64 v244, v243, v244
    ds_read_b128 a[32:35], v200 offset:16384
    v_mfma_f32_16x16x32_bf16 v[108:111], a[204:207], a[156:159], v[108:111]
    v_mfma_f32_16x16x32_bf16 v[100:103], a[200:203], a[144:147], v[100:103]
    v_cmp_eq_u32 vcc, v241, v242
    ds_read_b128 a[36:39], v201 offset:16384
    v_mfma_f32_16x16x32_bf16 v[100:103], a[204:207], a[148:151], v[100:103]
    v_and_b32 v243, 2, v240
    v_mfma_f32_16x16x32_bf16 v[92:95], a[200:203], a[136:139], v[92:95]
    v_accvgpr_write_b32 a244, 0
    ds_read_b128 a[40:43], v200 offset:18432
    v_mfma_f32_16x16x32_bf16 v[92:95], a[204:207], a[140:143], v[92:95]
    v_cndmask_b32 v244, 0, v244, vcc
    v_mfma_f32_16x16x32_bf16 v[84:87], a[200:203], a[128:131], v[84:87]
    v_cmp_eq_u32 vcc, 0, v243
    ds_read_b128 a[44:47], v201 offset:18432
    v_mfma_f32_16x16x32_bf16 v[84:87], a[204:207], a[132:135], v[84:87]
    v_mov_b32_e64 v226, 0
    v_mfma_f32_16x16x32_bf16 v[76:79], a[200:203], a[120:123], v[76:79]
    ds_read_b128 a[48:51], v200 offset:20480
    v_mfma_f32_16x16x32_bf16 v[76:79], a[204:207], a[124:127], v[76:79]
    v_mov_b32_e64 v227, 0
    v_mfma_f32_16x16x32_bf16 v[68:71], a[200:203], a[112:115], v[68:71]
    v_cndmask_b32 v228, 0, v244, vcc
    ds_read_b128 a[52:55], v201 offset:20480
    v_mfma_f32_16x16x32_bf16 v[68:71], a[204:207], a[116:119], v[68:71]
    v_cndmask_b32 v229, v244, 0, vcc
    v_mfma_f32_16x16x32_bf16 v[128:131], a[112:115], a[208:211], v[128:131]
    v_mov_b32 v230, 0
    v_mfma_f32_16x16x32_bf16 v[128:131], a[116:119], a[212:215], v[128:131]
    v_mov_b32_e64 v231, 0
    ds_read_b128 a[56:59], v200 offset:22528
    v_mfma_f32_16x16x32_bf16 v[132:135], a[120:123], a[208:211], v[132:135]
    v_accvgpr_write_b32 a245, 0
    v_mfma_f32_16x16x32_bf16 v[132:135], a[124:127], a[212:215], v[132:135]
    ds_read_b128 a[60:63], v201 offset:22528
    v_mfma_f32_16x16x32_bf16 v[144:147], a[128:131], a[208:211], v[144:147]
    v_accvgpr_write_b32 a246, 1.0
    v_mfma_f32_16x16x32_bf16 v[144:147], a[132:135], a[212:215], v[144:147]
    v_accvgpr_write_b32 a247, 1.0
    ds_read_b64_tr_b16 a[96:97], v202 offset:32768
    v_mfma_f32_16x16x32_bf16 v[148:151], a[136:139], a[208:211], v[148:151]
    v_accvgpr_write_b32 a248, 0
    v_mfma_f32_16x16x32_bf16 v[148:151], a[140:143], a[212:215], v[148:151]
    v_accvgpr_write_b32 a249, 0
    ds_read_b64_tr_b16 a[98:99], v202 offset:33280
    v_mfma_f32_16x16x32_bf16 v[160:163], a[144:147], a[208:211], v[160:163]
    v_accvgpr_write_b32 a252, 0
    v_mfma_f32_16x16x32_bf16 v[160:163], a[148:151], a[212:215], v[160:163]
    v_accvgpr_write_b32 a253, 0
    ds_read_b64_tr_b16 a[100:101], v202 offset:36864
    v_mfma_f32_16x16x32_bf16 v[164:167], a[152:155], a[208:211], v[164:167]
    v_mfma_f32_16x16x32_bf16 v[164:167], a[156:159], a[212:215], v[164:167]
    v_accvgpr_write_b32 a224, v212
    ds_read_b64_tr_b16 a[102:103], v202 offset:37376
    v_mfma_f32_16x16x32_bf16 v[176:179], a[160:163], a[208:211], v[176:179]
    v_accvgpr_write_b32 a225, v213
    v_mfma_f32_16x16x32_bf16 v[176:179], a[164:167], a[212:215], v[176:179]
    v_accvgpr_write_b32 a226, v214
    ds_read_b64_tr_b16 a[104:105], v203 offset:32768
    v_mfma_f32_16x16x32_bf16 v[180:183], a[168:171], a[208:211], v[180:183]
    v_accvgpr_write_b32 a227, v215
    v_mfma_f32_16x16x32_bf16 v[180:183], a[172:175], a[212:215], v[180:183]
    v_accvgpr_write_b32 a228, v216
    ds_read_b64_tr_b16 a[106:107], v203 offset:33280
    v_mfma_f32_16x16x32_bf16 v[188:191], a[168:171], a[216:219], v[188:191]
    v_accvgpr_write_b32 a229, v217
    v_mfma_f32_16x16x32_bf16 v[188:191], a[172:175], a[220:223], v[188:191]
    ds_read_b64_tr_b16 a[108:109], v203 offset:36864
    v_mfma_f32_16x16x32_bf16 v[184:187], a[160:163], a[216:219], v[184:187]
    v_accvgpr_write_b32 a230, v218
    v_mfma_f32_16x16x32_bf16 v[184:187], a[164:167], a[220:223], v[184:187]
    v_accvgpr_write_b32 a231, v219
    ds_read_b64_tr_b16 a[110:111], v203 offset:37376
    v_mfma_f32_16x16x32_bf16 v[172:175], a[152:155], a[216:219], v[172:175]
    v_accvgpr_write_b32 a232, v220
    v_mfma_f32_16x16x32_bf16 v[172:175], a[156:159], a[220:223], v[172:175]
    v_accvgpr_write_b32 a233, v221
    v_mfma_f32_16x16x32_bf16 v[168:171], a[144:147], a[216:219], v[168:171]
    v_accvgpr_write_b32 a234, v222
    v_mfma_f32_16x16x32_bf16 v[168:171], a[148:151], a[220:223], v[168:171]
    v_accvgpr_write_b32 a235, v223
    v_mfma_f32_16x16x32_bf16 v[156:159], a[136:139], a[216:219], v[156:159]
    v_mfma_f32_16x16x32_bf16 v[156:159], a[140:143], a[220:223], v[156:159]
    v_accvgpr_write_b32 a236, v226
    v_mfma_f32_16x16x32_bf16 v[152:155], a[128:131], a[216:219], v[152:155]
    v_accvgpr_write_b32 a237, v227
    v_mfma_f32_16x16x32_bf16 v[152:155], a[132:135], a[220:223], v[152:155]
    v_accvgpr_write_b32 a238, v228
    v_mfma_f32_16x16x32_bf16 v[140:143], a[120:123], a[216:219], v[140:143]
    v_accvgpr_write_b32 a239, v229
    v_mfma_f32_16x16x32_bf16 v[140:143], a[124:127], a[220:223], v[140:143]
    v_accvgpr_write_b32 a240, v230
    v_mfma_f32_16x16x32_bf16 v[136:139], a[112:115], a[216:219], v[136:139]
    v_accvgpr_write_b32 a241, v231
    v_mfma_f32_16x16x32_bf16 v[136:139], a[116:119], a[220:223], v[136:139]
    s_waitcnt vmcnt(0) lgkmcnt(0)
    s_barrier
    v_mfma_f32_16x16x32_bf16 v[64:67], a[80:83], a[0:3], v[64:67]
    v_mfma_f32_16x16x32_bf16 v[64:67], a[84:87], a[4:7], v[64:67]
    s_add_u32 m0, s94, 0
    s_xor_b32 s28, s30, 0
    s_lshl_b32 s28, s28, 17
    v_mfma_f32_16x16x32_bf16 v[72:75], a[80:83], a[8:11], v[72:75]
    buffer_load_dwordx4 v232, s[80:83], s28 offen offset:0  lds
    ds_read_b64_tr_b16 a[176:177], v202 offset:40960
    v_mfma_f32_16x16x32_bf16 v[72:75], a[84:87], a[12:15], v[72:75]
    ds_read_b64_tr_b16 a[178:179], v202 offset:41472
    v_mfma_f32_16x16x32_bf16 v[80:83], a[80:83], a[16:19], v[80:83]
    ds_read_b64_tr_b16 a[180:181], v202 offset:45056
    v_mfma_f32_16x16x32_bf16 v[80:83], a[84:87], a[20:23], v[80:83]
    ds_read_b64_tr_b16 a[182:183], v202 offset:45568
    v_mfma_f32_16x16x32_bf16 v[88:91], a[80:83], a[24:27], v[88:91]
    v_mfma_f32_16x16x32_bf16 v[88:91], a[84:87], a[28:31], v[88:91]
    ds_read_b64_tr_b16 a[184:185], v203 offset:40960
    v_mfma_f32_16x16x32_bf16 v[96:99], a[80:83], a[32:35], v[96:99]
    ds_read_b64_tr_b16 a[186:187], v203 offset:41472
    v_mfma_f32_16x16x32_bf16 v[96:99], a[84:87], a[36:39], v[96:99]
    buffer_load_dwordx4 v234, s[80:83], s28 offen offset:1024  lds
    ds_read_b64_tr_b16 a[188:189], v203 offset:45056
    v_mfma_f32_16x16x32_bf16 v[104:107], a[80:83], a[40:43], v[104:107]
    v_mfma_f32_16x16x32_bf16 v[104:107], a[84:87], a[44:47], v[104:107]
    ds_read_b64_tr_b16 a[190:191], v203 offset:45568
    v_mfma_f32_16x16x32_bf16 v[112:115], a[80:83], a[48:51], v[112:115]
    ds_read_b128 a[112:115], v198 offset:0
    v_mfma_f32_16x16x32_bf16 v[112:115], a[84:87], a[52:55], v[112:115]
    ds_read_b128 a[116:119], v199 offset:0
    v_mfma_f32_16x16x32_bf16 v[120:123], a[80:83], a[56:59], v[120:123]
    v_mfma_f32_16x16x32_bf16 v[120:123], a[84:87], a[60:63], v[120:123]
    ds_read_b128 a[120:123], v198 offset:2048
    v_mfma_f32_16x16x32_bf16 v[124:127], a[88:91], a[56:59], v[124:127]
    buffer_load_dwordx4 v236, s[80:83], s28 offen offset:2048  lds
    ds_read_b128 a[124:127], v199 offset:2048
    v_mfma_f32_16x16x32_bf16 v[124:127], a[92:95], a[60:63], v[124:127]
    ds_read_b128 a[128:131], v198 offset:4096
    v_mfma_f32_16x16x32_bf16 v[116:119], a[88:91], a[48:51], v[116:119]
    ds_read_b128 a[132:135], v199 offset:4096
    v_mfma_f32_16x16x32_bf16 v[116:119], a[92:95], a[52:55], v[116:119]
    v_mfma_f32_16x16x32_bf16 v[108:111], a[88:91], a[40:43], v[108:111]
    ds_read_b128 a[136:139], v198 offset:6144
    v_mfma_f32_16x16x32_bf16 v[108:111], a[92:95], a[44:47], v[108:111]
    ds_read_b128 a[140:143], v199 offset:6144
    v_mfma_f32_16x16x32_bf16 v[100:103], a[88:91], a[32:35], v[100:103]
    ds_read_b64_tr_b16 a[192:193], v202 offset:49152
    v_mfma_f32_16x16x32_bf16 v[100:103], a[92:95], a[36:39], v[100:103]
    buffer_load_dwordx4 v238, s[80:83], s28 offen offset:3072  lds
    v_mfma_f32_16x16x32_bf16 v[92:95], a[88:91], a[24:27], v[92:95]
    ds_read_b64_tr_b16 a[194:195], v202 offset:49664
    v_mfma_f32_16x16x32_bf16 v[92:95], a[92:95], a[28:31], v[92:95]
    ds_read_b64_tr_b16 a[196:197], v202 offset:53248
    v_mfma_f32_16x16x32_bf16 v[84:87], a[88:91], a[16:19], v[84:87]
    ds_read_b64_tr_b16 a[198:199], v202 offset:53760
    v_mfma_f32_16x16x32_bf16 v[84:87], a[92:95], a[20:23], v[84:87]
    v_mfma_f32_16x16x32_bf16 v[76:79], a[88:91], a[8:11], v[76:79]
    ds_read_b64_tr_b16 a[200:201], v203 offset:49152
    v_mfma_f32_16x16x32_bf16 v[76:79], a[92:95], a[12:15], v[76:79]
    s_add_u32 m0, s94, 16384
    s_xor_b32 s28, s30, 1
    s_lshl_b32 s28, s28, 17
    ds_read_b64_tr_b16 a[202:203], v203 offset:49664
    v_mfma_f32_16x16x32_bf16 v[68:71], a[88:91], a[0:3], v[68:71]
    buffer_load_dwordx4 v232, s[80:83], s28 offen offset:0  lds
    ds_read_b64_tr_b16 a[204:205], v203 offset:53248
    v_mfma_f32_16x16x32_bf16 v[68:71], a[92:95], a[4:7], v[68:71]
    ds_read_b64_tr_b16 a[206:207], v203 offset:53760
    v_mfma_f32_16x16x32_bf16 v[128:131], a[0:3], a[96:99], v[128:131]
    v_mfma_f32_16x16x32_bf16 v[128:131], a[4:7], a[100:103], v[128:131]
    ds_read_b128 a[144:147], v198 offset:16384
    v_mfma_f32_16x16x32_bf16 v[132:135], a[8:11], a[96:99], v[132:135]
    ds_read_b128 a[148:151], v199 offset:16384
    v_mfma_f32_16x16x32_bf16 v[132:135], a[12:15], a[100:103], v[132:135]
    ds_read_b128 a[152:155], v198 offset:18432
    v_mfma_f32_16x16x32_bf16 v[144:147], a[16:19], a[96:99], v[144:147]
    v_mfma_f32_16x16x32_bf16 v[144:147], a[20:23], a[100:103], v[144:147]
    buffer_load_dwordx4 v234, s[80:83], s28 offen offset:1024  lds
    ds_read_b128 a[156:159], v199 offset:18432
    v_mfma_f32_16x16x32_bf16 v[148:151], a[24:27], a[96:99], v[148:151]
    ds_read_b128 a[160:163], v198 offset:20480
    v_mfma_f32_16x16x32_bf16 v[148:151], a[28:31], a[100:103], v[148:151]
    ds_read_b128 a[164:167], v199 offset:20480
    v_mfma_f32_16x16x32_bf16 v[160:163], a[32:35], a[96:99], v[160:163]
    v_mfma_f32_16x16x32_bf16 v[160:163], a[36:39], a[100:103], v[160:163]
    ds_read_b128 a[168:171], v198 offset:22528
    v_mfma_f32_16x16x32_bf16 v[164:167], a[40:43], a[96:99], v[164:167]
    ds_read_b128 a[172:175], v199 offset:22528
    v_mfma_f32_16x16x32_bf16 v[164:167], a[44:47], a[100:103], v[164:167]
    ds_read_b64_tr_b16 a[208:209], v202 offset:57344
    v_mfma_f32_16x16x32_bf16 v[176:179], a[48:51], a[96:99], v[176:179]
    buffer_load_dwordx4 v236, s[80:83], s28 offen offset:2048  lds
L_pg4:
    s_cbranch_execz L_pg5
    ds_read_b64_tr_b16 a[210:211], v202 offset:57856
    v_mfma_f32_16x16x32_bf16 v[176:179], a[52:55], a[100:103], v[176:179]
    v_mfma_f32_16x16x32_bf16 v[180:183], a[56:59], a[96:99], v[180:183]
    ds_read_b64_tr_b16 a[212:213], v202 offset:61440
    v_mfma_f32_16x16x32_bf16 v[180:183], a[60:63], a[100:103], v[180:183]
    ds_read_b64_tr_b16 a[214:215], v202 offset:61952
    v_mfma_f32_16x16x32_bf16 v[188:191], a[56:59], a[104:107], v[188:191]
    ds_read_b64_tr_b16 a[216:217], v203 offset:57344
    v_mfma_f32_16x16x32_bf16 v[188:191], a[60:63], a[108:111], v[188:191]
    v_mfma_f32_16x16x32_bf16 v[184:187], a[48:51], a[104:107], v[184:187]
    ds_read_b64_tr_b16 a[218:219], v203 offset:57856
    v_mfma_f32_16x16x32_bf16 v[184:187], a[52:55], a[108:111], v[184:187]
    buffer_load_dwordx4 v238, s[80:83], s28 offen offset:3072  lds
    ds_read_b64_tr_b16 a[220:221], v203 offset:61440
    v_mfma_f32_16x16x32_bf16 v[172:175], a[40:43], a[104:107], v[172:175]
    ds_read_b64_tr_b16 a[222:223], v203 offset:61952
    v_mfma_f32_16x16x32_bf16 v[172:175], a[44:47], a[108:111], v[172:175]
    v_mfma_f32_16x16x32_bf16 v[168:171], a[32:35], a[104:107], v[168:171]
    v_mfma_f32_16x16x32_bf16 v[168:171], a[36:39], a[108:111], v[168:171]
    v_mfma_f32_16x16x32_bf16 v[156:159], a[24:27], a[104:107], v[156:159]
    v_mfma_f32_16x16x32_bf16 v[156:159], a[28:31], a[108:111], v[156:159]
    v_mfma_f32_16x16x32_bf16 v[152:155], a[16:19], a[104:107], v[152:155]
    v_mfma_f32_16x16x32_bf16 v[152:155], a[20:23], a[108:111], v[152:155]
    v_mfma_f32_16x16x32_bf16 v[140:143], a[8:11], a[104:107], v[140:143]
    v_mfma_f32_16x16x32_bf16 v[140:143], a[12:15], a[108:111], v[140:143]
    v_mfma_f32_16x16x32_bf16 v[136:139], a[0:3], a[104:107], v[136:139]
    v_mfma_f32_16x16x32_bf16 v[136:139], a[4:7], a[108:111], v[136:139]
    s_waitcnt lgkmcnt(0)
    s_barrier
    v_mfma_f32_16x16x32_bf16 v[64:67], a[192:195], a[112:115], v[64:67]
    s_add_u32 m0, s94, 32768
    s_xor_b32 s28, s30, 2
    s_lshl_b32 s28, s28, 17
    v_lshrrev_b32 v192, 3, v209
    v_min_u32 v192, 9, v192
    v_mfma_f32_16x16x32_bf16 v[64:67], a[196:199], a[116:119], v[64:67]
    buffer_load_dwordx4 v232, s[80:83], s28 offen offset:0  lds
    v_add_u32 v192, 6, v192
    v_xor_b32 v192, s30, v192
    v_mfma_f32_16x16x32_bf16 v[68:71], a[200:203], a[112:115], v[68:71]
    v_and_b32 v192, 15, v192
    v_lshlrev_b32 v192, 17, v192
    v_mfma_f32_16x16x32_bf16 v[68:71], a[204:207], a[116:119], v[68:71]
    v_bfe_u32 v193, v209, 1, 2
    v_lshl_add_u32 v192, v193, 11, v192
    v_mfma_f32_16x16x32_bf16 v[72:75], a[192:195], a[120:123], v[72:75]
    buffer_load_dwordx4 v234, s[80:83], s28 offen offset:1024  lds
    v_and_b32_e64 v193, 1, v209
    v_lshl_add_u32 v192, v193, 7, v192
    v_mfma_f32_16x16x32_bf16 v[72:75], a[196:199], a[124:127], v[72:75]
    s_and_b32 s3, s31, 3
    s_lshl_b32 s3, s3, 2
    v_mfma_f32_16x16x32_bf16 v[76:79], a[200:203], a[120:123], v[76:79]
    s_add_u32 s3, s3, s24
    s_lshl_b32 s3, s3, 13
    v_mfma_f32_16x16x32_bf16 v[76:79], a[204:207], a[124:127], v[76:79]
    s_add_u32 s35, s3, 2048
    v_mfma_f32_16x16x32_bf16 v[80:83], a[192:195], a[128:131], v[80:83]
    buffer_load_dwordx4 v236, s[80:83], s28 offen offset:2048  lds
    v_cvt_pk_bf16_f32 v64, v64, v65
    v_mfma_f32_16x16x32_bf16 v[80:83], a[196:199], a[132:135], v[80:83]
L_rcb:
    s_getpc_b64 s[6:7]
    v_cvt_pk_bf16_f32 v65, v66, v67
    v_mfma_f32_16x16x32_bf16 v[84:87], a[200:203], a[128:131], v[84:87]
    s_lshr_b32 s3, s2, 3
    s_lshl_b32 s3, s3, 2
    v_cvt_pk_bf16_f32 v66, v68, v69
    v_mfma_f32_16x16x32_bf16 v[84:87], a[204:207], a[132:135], v[84:87]
    s_add_u32 s3, s3, s24
    s_lshl_b32 s3, s3, 8
    v_cvt_pk_bf16_f32 v67, v70, v71
    v_mfma_f32_16x16x32_bf16 v[88:91], a[192:195], a[136:139], v[88:91]
    v_min_u32 v194, 1, v209
    v_lshl_add_u32 v194, v194, 7, s3
    buffer_load_dwordx4 v238, s[80:83], s28 offen offset:3072  lds
    v_cvt_pk_bf16_f32 v72, v72, v73
    v_mfma_f32_16x16x32_bf16 v[88:91], a[196:199], a[140:143], v[88:91]
    v_min_u32 v194, 21760, v194
    v_cvt_pk_bf16_f32 v73, v74, v75
    v_mfma_f32_16x16x32_bf16 v[92:95], a[200:203], a[136:139], v[92:95]
    v_cvt_pk_bf16_f32 v74, v76, v77
    v_mfma_f32_16x16x32_bf16 v[92:95], a[204:207], a[140:143], v[92:95]
    s_add_u32 m0, s94, 49152
    s_xor_b32 s28, s30, 3
    s_lshl_b32 s28, s28, 17
    v_cvt_pk_bf16_f32 v75, v78, v79
    v_mfma_f32_16x16x32_bf16 v[96:99], a[192:195], a[144:147], v[96:99]
    buffer_load_dwordx4 v232, s[80:83], s28 offen offset:0  lds
    v_cvt_pk_bf16_f32 v80, v80, v81
    v_mfma_f32_16x16x32_bf16 v[96:99], a[196:199], a[148:151], v[96:99]
    v_cvt_pk_bf16_f32 v81, v82, v83
    v_mfma_f32_16x16x32_bf16 v[100:103], a[200:203], a[144:147], v[100:103]
    v_cvt_pk_bf16_f32 v82, v84, v85
    v_mfma_f32_16x16x32_bf16 v[100:103], a[204:207], a[148:151], v[100:103]
    v_cvt_pk_bf16_f32 v83, v86, v87
    v_mfma_f32_16x16x32_bf16 v[104:107], a[192:195], a[152:155], v[104:107]
    buffer_load_dwordx4 v234, s[80:83], s28 offen offset:1024  lds
    v_cvt_pk_bf16_f32 v88, v88, v89
    v_mfma_f32_16x16x32_bf16 v[104:107], a[196:199], a[156:159], v[104:107]
    v_cvt_pk_bf16_f32 v89, v90, v91
    v_mfma_f32_16x16x32_bf16 v[108:111], a[200:203], a[152:155], v[108:111]
    v_cvt_pk_bf16_f32 v90, v92, v93
    v_mfma_f32_16x16x32_bf16 v[108:111], a[204:207], a[156:159], v[108:111]
    buffer_load_dwordx4 v236, s[80:83], s28 offen offset:2048  lds
    v_cvt_pk_bf16_f32 v91, v94, v95
    v_mfma_f32_16x16x32_bf16 v[112:115], a[192:195], a[160:163], v[112:115]
    v_cvt_pk_bf16_f32 v96, v96, v97
    v_mfma_f32_16x16x32_bf16 v[112:115], a[196:199], a[164:167], v[112:115]
    v_cvt_pk_bf16_f32 v97, v98, v99
    v_mfma_f32_16x16x32_bf16 v[116:119], a[200:203], a[160:163], v[116:119]
    v_cvt_pk_bf16_f32 v98, v100, v101
    v_mfma_f32_16x16x32_bf16 v[116:119], a[204:207], a[164:167], v[116:119]
    buffer_load_dwordx4 v238, s[80:83], s28 offen offset:3072  lds
    v_cvt_pk_bf16_f32 v99, v102, v103
    v_mfma_f32_16x16x32_bf16 v[120:123], a[192:195], a[168:171], v[120:123]
    v_cvt_pk_bf16_f32 v104, v104, v105
    v_mfma_f32_16x16x32_bf16 v[120:123], a[196:199], a[172:175], v[120:123]
    v_cvt_pk_bf16_f32 v105, v106, v107
    v_mfma_f32_16x16x32_bf16 v[124:127], a[200:203], a[168:171], v[124:127]
    s_add_u32 m0, s94, 65536
    s_xor_b32 s28, s30, 4
    s_lshl_b32 s28, s28, 17
    v_cvt_pk_bf16_f32 v106, v108, v109
    v_mfma_f32_16x16x32_bf16 v[124:127], a[204:207], a[172:175], v[124:127]
    buffer_load_dwordx4 v232, s[80:83], s28 offen offset:0  lds
    v_cvt_pk_bf16_f32 v107, v110, v111
    v_mfma_f32_16x16x32_bf16 v[128:131], a[112:115], a[208:211], v[128:131]
    v_cvt_pk_bf16_f32 v112, v112, v113
    v_mfma_f32_16x16x32_bf16 v[128:131], a[116:119], a[212:215], v[128:131]
    v_cvt_pk_bf16_f32 v113, v114, v115
    v_mfma_f32_16x16x32_bf16 v[132:135], a[120:123], a[208:211], v[132:135]
    v_cvt_pk_bf16_f32 v114, v116, v117
    v_mfma_f32_16x16x32_bf16 v[132:135], a[124:127], a[212:215], v[132:135]
    buffer_load_dwordx4 v234, s[80:83], s28 offen offset:1024  lds
    v_cvt_pk_bf16_f32 v115, v118, v119
    v_mfma_f32_16x16x32_bf16 v[136:139], a[112:115], a[216:219], v[136:139]
    v_cvt_pk_bf16_f32 v120, v120, v121
    v_mfma_f32_16x16x32_bf16 v[136:139], a[116:119], a[220:223], v[136:139]
    v_cvt_pk_bf16_f32 v121, v122, v123
    v_mfma_f32_16x16x32_bf16 v[140:143], a[120:123], a[216:219], v[140:143]
    v_cvt_pk_bf16_f32 v122, v124, v125
    v_mfma_f32_16x16x32_bf16 v[140:143], a[124:127], a[220:223], v[140:143]
    buffer_load_dwordx4 v236, s[80:83], s28 offen offset:2048  lds
    v_cvt_pk_bf16_f32 v123, v126, v127
    v_mfma_f32_16x16x32_bf16 v[144:147], a[128:131], a[208:211], v[144:147]
    v_cvt_pk_bf16_f32 v128, v128, v129
    v_mfma_f32_16x16x32_bf16 v[144:147], a[132:135], a[212:215], v[144:147]
    v_cvt_pk_bf16_f32 v129, v130, v131
    v_mfma_f32_16x16x32_bf16 v[148:151], a[136:139], a[208:211], v[148:151]
    buffer_load_dwordx4 v238, s[80:83], s28 offen offset:3072  lds
    v_cvt_pk_bf16_f32 v130, v132, v133
    v_mfma_f32_16x16x32_bf16 v[148:151], a[140:143], a[212:215], v[148:151]
    v_cvt_pk_bf16_f32 v131, v134, v135
    v_mfma_f32_16x16x32_bf16 v[152:155], a[128:131], a[216:219], v[152:155]
    v_cvt_pk_bf16_f32 v136, v136, v137
    v_mfma_f32_16x16x32_bf16 v[152:155], a[132:135], a[220:223], v[152:155]
    s_add_u32 m0, s94, 81920
    s_xor_b32 s28, s30, 5
    s_lshl_b32 s28, s28, 17
    v_cvt_pk_bf16_f32 v137, v138, v139
    v_mfma_f32_16x16x32_bf16 v[156:159], a[136:139], a[216:219], v[156:159]
    buffer_load_dwordx4 v232, s[80:83], s28 offen offset:0  lds
    v_cvt_pk_bf16_f32 v138, v140, v141
    v_mfma_f32_16x16x32_bf16 v[156:159], a[140:143], a[220:223], v[156:159]
    v_cvt_pk_bf16_f32 v139, v142, v143
    v_mfma_f32_16x16x32_bf16 v[160:163], a[144:147], a[208:211], v[160:163]
    v_cvt_pk_bf16_f32 v144, v144, v145
    v_mfma_f32_16x16x32_bf16 v[160:163], a[148:151], a[212:215], v[160:163]
    v_cvt_pk_bf16_f32 v145, v146, v147
    v_mfma_f32_16x16x32_bf16 v[164:167], a[152:155], a[208:211], v[164:167]
    buffer_load_dwordx4 v234, s[80:83], s28 offen offset:1024  lds
    v_cvt_pk_bf16_f32 v146, v148, v149
    v_mfma_f32_16x16x32_bf16 v[164:167], a[156:159], a[212:215], v[164:167]
    v_cvt_pk_bf16_f32 v147, v150, v151
    v_mfma_f32_16x16x32_bf16 v[168:171], a[144:147], a[216:219], v[168:171]
    v_cvt_pk_bf16_f32 v152, v152, v153
    v_mfma_f32_16x16x32_bf16 v[168:171], a[148:151], a[220:223], v[168:171]
    v_cvt_pk_bf16_f32 v153, v154, v155
    v_mfma_f32_16x16x32_bf16 v[172:175], a[152:155], a[216:219], v[172:175]
    buffer_load_dwordx4 v236, s[80:83], s28 offen offset:2048  lds
    v_cvt_pk_bf16_f32 v154, v156, v157
    v_mfma_f32_16x16x32_bf16 v[172:175], a[156:159], a[220:223], v[172:175]
    v_cvt_pk_bf16_f32 v155, v158, v159
    v_mfma_f32_16x16x32_bf16 v[176:179], a[160:163], a[208:211], v[176:179]
    v_cvt_pk_bf16_f32 v160, v160, v161
    v_mfma_f32_16x16x32_bf16 v[176:179], a[164:167], a[212:215], v[176:179]
    v_cvt_pk_bf16_f32 v161, v162, v163
    v_mfma_f32_16x16x32_bf16 v[180:183], a[168:171], a[208:211], v[180:183]
    buffer_load_dwordx4 v238, s[80:83], s28 offen offset:3072  lds
    v_cvt_pk_bf16_f32 v162, v164, v165
    v_mfma_f32_16x16x32_bf16 v[180:183], a[172:175], a[212:215], v[180:183]
    v_cvt_pk_bf16_f32 v163, v166, v167
    v_mfma_f32_16x16x32_bf16 v[184:187], a[160:163], a[216:219], v[184:187]
    v_cvt_pk_bf16_f32 v168, v168, v169
    v_mfma_f32_16x16x32_bf16 v[184:187], a[164:167], a[220:223], v[184:187]
    v_cvt_pk_bf16_f32 v169, v170, v171
    v_mfma_f32_16x16x32_bf16 v[188:191], a[168:171], a[216:219], v[188:191]
    global_load_dword a255, v194, s[6:7]
    v_cvt_pk_bf16_f32 v170, v172, v173
    v_mfma_f32_16x16x32_bf16 v[188:191], a[172:175], a[220:223], v[188:191]
    v_cvt_pk_bf16_f32 v171, v174, v175
    buffer_load_dword v210, off, s[36:39], 0 sc1
    buffer_load_dword a255, v192, s[80:83], s35 offen
    v_mfma_f32_16x16x32_bf16 v[76:79], a[228:231], v[64:67], 0
    v_cvt_pk_bf16_f32 v176, v176, v177
    v_cvt_pk_bf16_f32 v177, v178, v179
    v_mfma_f32_16x16x32_bf16 v[68:71], a[224:227], v[64:67], 0
    v_cvt_pk_bf16_f32 v178, v180, v181
    v_cvt_pk_bf16_f32 v179, v182, v183
    v_cvt_pk_bf16_f32 v184, v184, v185
    v_cvt_pk_bf16_f32 v185, v186, v187
    v_cvt_pk_bf16_f32 v187, v190, v191
    v_pk_mul_f32 v[76:77], v[76:77], v[224:225] op_sel_hi:[1,0]
    v_exp_f32_e64 v125, v77
    v_pk_mul_f32 v[78:79], v[78:79], v[224:225] op_sel_hi:[1,0]
    v_exp_f32_e64 v126, v78
    v_pk_mul_f32 v[70:71], v[70:71], v[224:225] op_sel_hi:[1,0]
    v_mfma_f32_16x16x32_bf16 v[84:87], a[224:227], v[72:75], 0
    v_exp_f32_e64 v119, v71
    v_exp_f32 v71, -v71
    v_exp_f32 v78, -v78
    v_mfma_f32_16x16x32_bf16 v[92:95], a[228:231], v[72:75], 0
    v_exp_f32_e64 v124, v76
    v_exp_f32 v76, -v76
    v_exp_f32_e64 v118, v70
    v_exp_f32 v70, -v70
    v_cvt_pk_bf16_f32 v149, v118, v119
    v_pk_mul_f32 v[68:69], v[68:69], v[224:225] op_sel_hi:[1,0]
    v_exp_f32 v117, v69
    v_exp_f32 v116, v68
    v_exp_f32 v68, -v68
    v_cvt_pk_bf16_f32 v148, v116, v117
    v_exp_f32_e64 v127, v79
    v_exp_f32 v79, -v79
    v_cvt_pk_bf16_f32 v151, v126, v127
    v_pk_mul_f32 v[84:85], v[84:85], v[224:225] op_sel_hi:[1,0]
    v_cvt_pk_bf16_f32 v159, v78, v79
    v_exp_f32_e64 v133, v85
    v_pk_mul_f32 v[92:93], v[92:93], v[224:225] op_sel_hi:[1,0]
    v_cvt_pk_bf16_f32 v150, v124, v125
    v_pk_mul_f32 v[94:95], v[94:95], v[224:225] op_sel_hi:[1,0]
    v_pk_mul_f32 v[86:87], v[86:87], v[224:225] op_sel_hi:[1,0]
    v_exp_f32 v135, v87
    v_exp_f32 v140, v92
    v_exp_f32_e64 v141, v93
    v_exp_f32 v77, -v77
    v_cvt_pk_bf16_f32 v186, v188, v189
    v_cvt_pk_bf16_f32 v158, v76, v77
    v_cvt_pk_bf16_f32 v157, v70, v71
    v_exp_f32 v142, v94
    v_exp_f32 v134, v86
    v_exp_f32 v86, -v86
    v_exp_f32 v93, -v93
    v_mfma_f32_16x16x32_bf16 v[100:103], a[224:227], v[80:83], 0
    v_exp_f32 v69, -v69
    v_exp_f32 v87, -v87
    v_cvt_pk_bf16_f32 v156, v68, v69
    v_exp_f32 v94, -v94
    v_mfma_f32_16x16x32_bf16 v[180:183], a[232:235], v[148:151], 0
    v_exp_f32 v85, -v85
    v_mfma_f32_16x16x32_bf16 v[188:191], a[232:235], v[156:159], 0
    v_exp_f32_e64 v143, v95
    v_exp_f32 v95, -v95
    v_cvt_pk_bf16_f32 v167, v142, v143
    v_exp_f32_e64 v132, v84
    v_exp_f32 v84, -v84
    v_cvt_pk_bf16_f32 v165, v134, v135
    v_cvt_pk_bf16_f32 v172, v84, v85
    v_cvt_pk_bf16_f32 v173, v86, v87
    v_cvt_pk_bf16_f32 v175, v94, v95
    v_mfma_f32_16x16x32_bf16 v[108:111], a[228:231], v[80:83], 0
    v_max3_f32 v237, v180, v188, v237
    v_exp_f32 v92, -v92
    v_cvt_pk_bf16_f32 v166, v140, v141
    v_rcp_f32_e64 v232, v180
    v_pk_mul_f32 v[102:103], v[102:103], v[224:225] op_sel_hi:[1,0]
    v_pk_mul_f32 v[126:127], v[126:127], v[232:233] op_sel_hi:[1,0]
    v_pk_mul_f32 v[124:125], v[124:125], v[232:233] op_sel_hi:[1,0]
    v_cvt_pk_bf16_f32 v151, v126, v127
    v_pk_mul_f32 v[108:109], v[108:109], v[224:225] op_sel_hi:[1,0]
    v_cvt_pk_bf16_f32 v174, v92, v93
    v_cvt_pk_bf16_f32 v164, v132, v133
    v_pk_mul_f32 v[110:111], v[110:111], v[224:225] op_sel_hi:[1,0]
    v_exp_f32_e64 v126, v110
    v_mfma_f32_16x16x32_bf16 v[180:183], a[232:235], v[164:167], 0
    v_exp_f32_e64 v127, v111
    v_exp_f32 v111, -v111
    v_exp_f32 v110, -v110
    v_pk_mul_f32 v[100:101], v[100:101], v[224:225] op_sel_hi:[1,0]
    v_rcp_f32_e64 v234, v188
    v_pk_mul_f32 v[116:117], v[116:117], v[232:233] op_sel_hi:[1,0]
    v_pk_mul_f32 v[76:77], v[76:77], v[234:235] op_sel_hi:[1,0]
    v_pk_mul_f32 v[70:71], v[70:71], v[234:235] op_sel_hi:[1,0]
    v_mfma_f32_16x16x32_bf16 v[188:191], a[232:235], v[172:175], 0
    v_cvt_pk_bf16_f32 v157, v70, v71
    v_cvt_pk_bf16_f32 v148, v116, v117
    v_exp_f32 v117, v101
    v_exp_f32 v116, v100
    v_pk_mul_f32 v[68:69], v[68:69], v[234:235] op_sel_hi:[1,0]
    v_cvt_pk_bf16_f32 v156, v68, v69
    v_mfma_f32_16x16x32_bf16 v[68:71], a[224:227], v[88:91], 0
    v_exp_f32 v100, -v100
    v_max3_f32 v237, v180, v188, v237
    v_rcp_f32_e64 v238, v188
    v_pk_mul_f32 v[78:79], v[78:79], v[234:235] op_sel_hi:[1,0]
    v_cvt_pk_bf16_f32 v159, v78, v79
    v_pk_mul_f32 v[94:95], v[94:95], v[238:239] op_sel_hi:[1,0]
    v_cvt_pk_bf16_f32 v158, v76, v77
    v_mfma_f32_16x16x32_bf16 v[76:79], a[228:231], v[88:91], 0
    v_cvt_pk_bf16_f32 v150, v124, v125
    v_exp_f32 v124, v108
    v_exp_f32 v125, v109
    v_mfma_f32_16x16x32_bf16 v[226:229], v[156:159], a[236:239], 0
    v_exp_f32 v108, -v108
    v_exp_f32 v109, -v109
    v_rcp_f32_e64 v236, v180
    v_pk_mul_f32 v[70:71], v[70:71], v[224:225] op_sel_hi:[1,0]
    v_pk_mul_f32 v[142:143], v[142:143], v[236:237] op_sel_hi:[1,0]
    v_pk_mul_f32 v[78:79], v[78:79], v[224:225] op_sel_hi:[1,0]
    v_pk_mul_f32 v[140:141], v[140:141], v[236:237] op_sel_hi:[1,0]
    v_cvt_pk_bf16_f32 v166, v140, v141
    v_pk_mul_f32 v[134:135], v[134:135], v[236:237] op_sel_hi:[1,0]
    v_cvt_pk_bf16_f32 v165, v134, v135
    v_exp_f32_e64 v135, v71
    v_pk_mul_f32 v[68:69], v[68:69], v[224:225] op_sel_hi:[1,0]
    v_exp_f32 v101, -v101
    v_pk_mul_f32 v[118:119], v[118:119], v[232:233] op_sel_hi:[1,0]
    v_cvt_pk_bf16_f32 v149, v118, v119
    v_exp_f32_e64 v118, v102
    v_exp_f32 v102, -v102
    v_mfma_f32_16x16x32_bf16 v[216:219], v[148:151], a[236:239], 0
    v_exp_f32_e64 v119, v103
    v_exp_f32 v103, -v103
    v_mfma_f32_16x16x32_bf16 v[212:215], v[148:151], a[238:241], 0
    v_cvt_pk_bf16_f32 v151, v126, v127
    v_cvt_pk_bf16_f32 v150, v124, v125
    v_cvt_pk_bf16_f32 v148, v116, v117
    v_cvt_pk_bf16_f32 v149, v118, v119
    v_cvt_pk_bf16_f32 v167, v142, v143
    v_cvt_pk_bf16_f32 v245, v218, v219
    v_mfma_f32_16x16x32_bf16 v[180:183], a[232:235], v[148:151], 0
    v_cvt_pk_bf16_f32 v244, v216, v217
    v_cvt_pk_bf16_f32 v241, v214, v215
    v_exp_f32_e64 v143, v79
    v_cvt_pk_bf16_f32 v240, v212, v213
    v_pk_mul_f32 v[132:133], v[132:133], v[236:237] op_sel_hi:[1,0]
    v_pk_mul_f32 v[76:77], v[76:77], v[224:225] op_sel_hi:[1,0]
    v_exp_f32_e64 v140, v76
    v_mfma_f32_16x16x32_bf16 v[220:223], v[156:159], a[238:241], 0
    v_cvt_pk_bf16_f32 v159, v110, v111
    v_cvt_pk_bf16_f32 v157, v102, v103
    v_cvt_pk_bf16_f32 v158, v108, v109
    v_cvt_pk_bf16_f32 v156, v100, v101
    v_cvt_pk_bf16_f32 v164, v132, v133
    v_pk_mul_f32 v[92:93], v[92:93], v[238:239] op_sel_hi:[1,0]
    v_mfma_f32_16x16x32_bf16 v[188:191], a[232:235], v[156:159], 0
    v_exp_f32_e64 v133, v69
    v_exp_f32 v69, -v69
    v_exp_f32_e64 v132, v68
    v_exp_f32 v68, -v68
    v_pk_mul_f32 v[84:85], v[84:85], v[238:239] op_sel_hi:[1,0]
    v_cvt_pk_bf16_f32 v172, v84, v85
    v_mfma_f32_16x16x32_bf16 v[216:219], v[164:167], a[236:239], 0
    v_exp_f32_e64 v134, v70
    v_exp_f32 v70, -v70
    v_cvt_pk_bf16_f32 v175, v94, v95
    v_cvt_pk_bf16_f32 v253, v228, v229
    v_pk_mul_f32 v[86:87], v[86:87], v[238:239] op_sel_hi:[1,0]
    v_cvt_pk_bf16_f32 v173, v86, v87
    v_mfma_f32_16x16x32_bf16 v[84:87], a[224:227], v[96:99], 0
    v_exp_f32 v71, -v71
    v_cvt_pk_bf16_f32 v249, v222, v223
    v_max3_f32 v237, v180, v188, v237
    v_rcp_f32_e64 v234, v188
    v_cvt_pk_bf16_f32 v252, v226, v227
    v_exp_f32_e64 v141, v77
    v_exp_f32 v77, -v77
    v_cvt_pk_bf16_f32 v174, v92, v93
    v_mfma_f32_16x16x32_bf16 v[92:95], a[228:231], v[96:99], 0
    v_cvt_pk_bf16_f32 v248, v220, v221
    v_exp_f32 v79, -v79
    v_mfma_f32_16x16x32_bf16 v[220:223], v[172:175], a[238:241], 0
    v_rcp_f32_e64 v232, v180
    v_mfma_f32_16x16x32_bf16 v[226:229], v[172:175], a[236:239], 0
    v_cvt_pk_bf16_f32 v172, v68, v69
    v_cvt_pk_bf16_f32 v173, v70, v71
    v_exp_f32_e64 v142, v78
    v_exp_f32 v78, -v78
    v_pk_mul_f32 v[84:85], v[84:85], v[224:225] op_sel_hi:[1,0]
    v_pk_mul_f32 v[126:127], v[126:127], v[232:233] op_sel_hi:[1,0]
    v_cvt_pk_bf16_f32 v175, v78, v79
    v_pk_mul_f32 v[116:117], v[116:117], v[232:233] op_sel_hi:[1,0]
    v_cvt_pk_bf16_f32 v255, v228, v229
    v_pk_mul_f32 v[100:101], v[100:101], v[234:235] op_sel_hi:[1,0]
    v_pk_mul_f32 v[86:87], v[86:87], v[224:225] op_sel_hi:[1,0]
    v_exp_f32 v76, -v76
    v_mfma_f32_16x16x32_bf16 v[212:215], v[164:167], a[238:241], 0
    v_cvt_pk_bf16_f32 v174, v76, v77
    v_cvt_pk_bf16_f32 v165, v134, v135
    v_cvt_pk_bf16_f32 v167, v142, v143
    v_cvt_pk_bf16_f32 v166, v140, v141
    v_mfma_f32_16x16x32_bf16 v[188:191], a[232:235], v[172:175], 0
    v_cvt_pk_bf16_f32 v151, v126, v127
    v_cvt_pk_bf16_f32 v164, v132, v133
    v_cvt_pk_bf16_f32 v250, v220, v221
    v_cvt_pk_bf16_f32 v242, v212, v213
    v_cvt_pk_bf16_f32 v243, v214, v215
    v_pk_mul_f32 v[124:125], v[124:125], v[232:233] op_sel_hi:[1,0]
    v_pk_mul_f32 v[102:103], v[102:103], v[234:235] op_sel_hi:[1,0]
    v_mfma_f32_16x16x32_bf16 v[180:183], a[232:235], v[164:167], 0
    v_cvt_pk_bf16_f32 v247, v218, v219
    v_cvt_pk_bf16_f32 v156, v100, v101
    v_cvt_pk_bf16_f32 v150, v124, v125
    v_cvt_pk_bf16_f32 v254, v226, v227
    v_cvt_pk_bf16_f32 v246, v216, v217
    v_pk_mul_f32 v[118:119], v[118:119], v[232:233] op_sel_hi:[1,0]
    v_cvt_pk_bf16_f32 v149, v118, v119
    v_pk_mul_f32 v[110:111], v[110:111], v[234:235] op_sel_hi:[1,0]
    v_cvt_pk_bf16_f32 v159, v110, v111
    v_pk_mul_f32 v[108:109], v[108:109], v[234:235] op_sel_hi:[1,0]
    v_pk_mul_f32 v[92:93], v[92:93], v[224:225] op_sel_hi:[1,0]
    v_exp_f32 v124, v92
    v_exp_f32 v119, v87
    v_exp_f32 v87, -v87
    v_exp_f32_e64 v125, v93
    v_exp_f32 v93, -v93
    v_pk_mul_f32 v[94:95], v[94:95], v[224:225] op_sel_hi:[1,0]
    v_exp_f32_e64 v126, v94
    v_exp_f32 v94, -v94
    v_cvt_pk_bf16_f32 v158, v108, v109
    v_mfma_f32_16x16x32_bf16 v[108:111], a[228:231], v[104:107], 0
    v_exp_f32 v92, -v92
    v_rcp_f32_e64 v236, v180
    v_cvt_pk_bf16_f32 v251, v222, v223
    v_max3_f32 v237, v180, v188, v237
    v_rcp_f32_e64 v238, v188
    v_pk_mul_f32 v[142:143], v[142:143], v[236:237] op_sel_hi:[1,0]
    v_cvt_pk_bf16_f32 v148, v116, v117
    v_exp_f32 v116, v84
    v_exp_f32 v117, v85
    v_mfma_f32_16x16x32_bf16 v[216:219], v[148:151], a[236:239], 0
    v_exp_f32 v84, -v84
    v_exp_f32 v85, -v85
    v_mfma_f32_16x16x32_bf16 v[212:215], v[148:151], a[238:241], 0
    v_cvt_pk_bf16_f32 v150, v124, v125
    v_exp_f32_e64 v127, v95
    v_exp_f32 v95, -v95
    v_cvt_pk_bf16_f32 v151, v126, v127
    v_pk_mul_f32 v[70:71], v[70:71], v[238:239] op_sel_hi:[1,0]
    v_mfma_f32_16x16x32_bf16 a[104:107], a[232:235], v[240:243], 0
    v_cvt_pk_bf16_f32 v167, v142, v143
    v_cvt_pk_bf16_f32 v148, v116, v117
    v_cvt_pk_bf16_f32 v157, v102, v103
    v_mfma_f32_16x16x32_bf16 v[100:103], a[224:227], v[104:107], 0
    v_exp_f32_e64 v118, v86
    v_mfma_f32_16x16x32_bf16 v[220:223], v[156:159], a[238:241], 0
    v_exp_f32 v86, -v86
    v_mfma_f32_16x16x32_bf16 v[226:229], v[156:159], a[236:239], 0
    v_cvt_pk_bf16_f32 v158, v92, v93
    v_cvt_pk_bf16_f32 v156, v84, v85
    v_cvt_pk_bf16_f32 v159, v94, v95
    v_cvt_pk_bf16_f32 v149, v118, v119
    v_cvt_pk_bf16_f32 v157, v86, v87
    v_pk_mul_f32 v[102:103], v[102:103], v[224:225] op_sel_hi:[1,0]
    v_mfma_f32_16x16x32_bf16 v[180:183], a[232:235], v[148:151], 0
    v_cvt_pk_bf16_f32 v173, v70, v71
    s_mov_b32 s5, 1400897536
    s_lshl_b32 s3, s24, 14
    s_xor_b32 s4, s3, 32768
    s_add_u32 s97, s31, 1
    v_pk_mul_f32 v[100:101], v[100:101], v[224:225] op_sel_hi:[1,0]
    v_pk_mul_f32 v[108:109], v[108:109], v[224:225] op_sel_hi:[1,0]
    v_pk_mul_f32 v[110:111], v[110:111], v[224:225] op_sel_hi:[1,0]
    v_mfma_f32_16x16x32_bf16 v[188:191], a[232:235], v[156:159], 0
    v_exp_f32_e64 v143, v111
    v_mfma_f32_16x16x32_bf16 a[80:83], v[248:251], v[128:131], 0
    v_exp_f32_e64 v142, v110
    v_mfma_f32_16x16x32_bf16 a[100:103], a[232:235], v[252:255], 0
    v_exp_f32 v111, -v111
    v_mfma_f32_16x16x32_bf16 a[108:111], a[232:235], v[244:247], 0
    v_exp_f32 v110, -v110
    v_rcp_f32 v232, v180
    v_rcp_f32 v234, v188
    v_pk_mul_f32 v[68:69], v[68:69], v[238:239] op_sel_hi:[1,0]
    v_pk_mul_f32 v[140:141], v[140:141], v[236:237] op_sel_hi:[1,0]
    v_mfma_f32_16x16x32_bf16 a[88:91], v[252:255], v[128:131], 0
    v_cvt_pk_bf16_f32 v166, v140, v141
    v_exp_f32_e64 v140, v108
    v_mfma_f32_16x16x32_bf16 v[200:203], v[244:247], v[128:131], 0
    v_exp_f32_e64 v141, v109
    v_exp_f32 v108, -v108
    v_exp_f32 v109, -v109
    v_pk_mul_f32 v[132:133], v[132:133], v[236:237] op_sel_hi:[1,0]
    v_cvt_pk_bf16_f32 v164, v132, v133
    v_pk_mul_f32 v[76:77], v[76:77], v[238:239] op_sel_hi:[1,0]
    v_cvt_pk_bf16_f32 v174, v76, v77
    v_exp_f32_e64 v132, v100
    v_exp_f32 v100, -v100
    v_pk_mul_f32 v[134:135], v[134:135], v[236:237] op_sel_hi:[1,0]
    v_cvt_pk_bf16_f32 v165, v134, v135
    v_mfma_f32_16x16x32_bf16 a[96:99], a[232:235], v[248:251], 0
    v_exp_f32_e64 v135, v103
    v_cvt_pk_bf16_f32 v172, v68, v69
    v_mfma_f32_16x16x32_bf16 v[68:71], a[224:227], v[112:115], 0
    v_exp_f32_e64 v133, v101
    v_exp_f32 v101, -v101
    v_exp_f32_e64 v134, v102
    v_pk_mul_f32 v[78:79], v[78:79], v[238:239] op_sel_hi:[1,0]
    v_mfma_f32_16x16x32_bf16 a[92:95], v[252:255], v[136:139], 0
    v_cvt_pk_bf16_f32 v253, v228, v229
    v_cvt_pk_bf16_f32 v252, v226, v227
    v_mfma_f32_16x16x32_bf16 a[84:87], v[248:251], v[136:139], 0
    v_cvt_pk_bf16_f32 v248, v220, v221
    v_cvt_pk_bf16_f32 v175, v78, v79
    v_mfma_f32_16x16x32_bf16 v[76:79], a[228:231], v[112:115], 0
    v_exp_f32 v102, -v102
    v_mfma_f32_16x16x32_bf16 v[192:195], v[240:243], v[128:131], 0
    v_cvt_pk_bf16_f32 v249, v222, v223
    v_exp_f32 v103, -v103
    v_mfma_f32_16x16x32_bf16 v[196:199], v[240:243], v[136:139], 0
    v_cvt_pk_bf16_f32 v240, v212, v213
    v_cvt_pk_bf16_f32 v241, v214, v215
    v_mfma_f32_16x16x32_bf16 v[204:207], v[244:247], v[136:139], 0
    v_cvt_pk_bf16_f32 v245, v218, v219
    v_max3_f32 v237, v180, v188, v237
    v_mfma_f32_16x16x32_bf16 v[220:223], v[172:175], a[238:241], 0
    v_cvt_pk_bf16_f32 v244, v216, v217
    s_and_b32 s97, s97, 7
    v_mfma_f32_16x16x32_bf16 v[216:219], v[164:167], a[236:239], 0
    s_lshl_b32 s97, s97, 13
    s_add_u32 s97, s97, s41
    v_mfma_f32_16x16x32_bf16 v[212:215], v[164:167], a[238:241], 0
    v_cvt_pk_bf16_f32 v166, v140, v141
    v_cvt_pk_bf16_f32 v167, v142, v143
    v_cvt_pk_bf16_f32 v164, v132, v133
L_pg5:
    s_cbranch_execz L_body
    v_cvt_pk_bf16_f32 v165, v134, v135
    v_cvt_pk_bf16_f32 v250, v220, v221
    v_pk_mul_f32 v[124:125], v[124:125], v[232:233] op_sel_hi:[1,0]
    v_mfma_f32_16x16x32_bf16 v[226:229], v[172:175], a[236:239], 0
    v_cvt_pk_bf16_f32 v174, v108, v109
    v_cvt_pk_bf16_f32 v173, v102, v103
    v_cvt_pk_bf16_f32 v175, v110, v111
    v_cvt_pk_bf16_f32 v172, v100, v101
    v_cvt_pk_bf16_f32 v150, v124, v125
    v_pk_mul_f32 v[70:71], v[70:71], v[224:225] op_sel_hi:[1,0]
    v_mfma_f32_16x16x32_bf16 v[180:183], a[232:235], v[164:167], 0
    v_cvt_pk_bf16_f32 v246, v216, v217
    v_cvt_pk_bf16_f32 v254, v226, v227
    v_cvt_pk_bf16_f32 v255, v228, v229
    v_cvt_pk_bf16_f32 v251, v222, v223
    v_cvt_pk_bf16_f32 v243, v214, v215
    v_pk_mul_f32 v[94:95], v[94:95], v[234:235] op_sel_hi:[1,0]
    v_pk_mul_f32 v[118:119], v[118:119], v[232:233] op_sel_hi:[1,0]
    v_cvt_pk_bf16_f32 v149, v118, v119
    v_exp_f32_e64 v118, v70
    v_mfma_f32_16x16x32_bf16 v[188:191], a[232:235], v[172:175], 0
    v_cvt_pk_bf16_f32 v159, v94, v95
    v_rcp_f32_e64 v236, v180
    v_exp_f32 v70, -v70
    v_pk_mul_f32 v[116:117], v[116:117], v[232:233] op_sel_hi:[1,0]
    v_cvt_pk_bf16_f32 v148, v116, v117
    v_pk_mul_f32 v[78:79], v[78:79], v[224:225] op_sel_hi:[1,0]
    v_pk_mul_f32 v[126:127], v[126:127], v[232:233] op_sel_hi:[1,0]
    v_cvt_pk_bf16_f32 v151, v126, v127
    v_exp_f32 v127, v79
    v_exp_f32 v126, v78
    v_pk_mul_f32 v[92:93], v[92:93], v[234:235] op_sel_hi:[1,0]
    v_cvt_pk_bf16_f32 v158, v92, v93
    v_mfma_f32_16x16x32_bf16 v[92:95], a[228:231], v[120:123], 0
    v_exp_f32 v78, -v78
    v_exp_f32_e64 v119, v71
    v_exp_f32 v71, -v71
    v_pk_mul_f32 v[86:87], v[86:87], v[234:235] op_sel_hi:[1,0]
    v_pk_mul_f32 v[84:85], v[84:85], v[234:235] op_sel_hi:[1,0]
    v_cvt_pk_bf16_f32 v156, v84, v85
    v_pk_mul_f32 v[68:69], v[68:69], v[224:225] op_sel_hi:[1,0]
    v_exp_f32 v116, v68
    v_exp_f32 v117, v69
    v_exp_f32 v69, -v69
    v_cvt_pk_bf16_f32 v157, v86, v87
    v_mfma_f32_16x16x32_bf16 v[84:87], a[224:227], v[120:123], 0
    v_exp_f32 v68, -v68
    v_mfma_f32_16x16x32_bf16 v[220:223], v[156:159], a[238:241], 0
    v_cvt_pk_bf16_f32 v242, v212, v213
    v_cvt_pk_bf16_f32 v247, v218, v219
    v_mfma_f32_16x16x32_bf16 v[216:219], v[148:151], a[236:239], 0
    v_exp_f32 v79, -v79
    v_mfma_f32_16x16x32_bf16 v[226:229], v[156:159], a[236:239], 0
    v_rcp_f32_e64 v238, v188
    v_mfma_f32_16x16x32_bf16 v[212:215], v[148:151], a[238:241], 0
    v_cvt_pk_bf16_f32 v148, v116, v117
    v_cvt_pk_bf16_f32 v149, v118, v119
    v_cvt_pk_bf16_f32 v151, v126, v127
    v_max3_f32 v237, v180, v188, v237
    v_cvt_pk_bf16_f32 v157, v70, v71
    v_pk_mul_f32 v[132:133], v[132:133], v[236:237] op_sel_hi:[1,0]
    v_pk_mul_f32 v[94:95], v[94:95], v[224:225] op_sel_hi:[1,0]
    v_pk_mul_f32 v[76:77], v[76:77], v[224:225] op_sel_hi:[1,0]
    v_exp_f32_e64 v124, v76
    v_exp_f32 v76, -v76
    v_exp_f32_e64 v125, v77
    v_pk_mul_f32 v[142:143], v[142:143], v[236:237] op_sel_hi:[1,0]
    v_cvt_pk_bf16_f32 v150, v124, v125
    v_pk_mul_f32 v[86:87], v[86:87], v[224:225] op_sel_hi:[1,0]
    v_mfma_f32_16x16x32_bf16 a[96:99], a[232:235], v[248:251], a[96:99]
    v_cvt_pk_bf16_f32 v164, v132, v133
    v_cvt_pk_bf16_f32 v167, v142, v143
    v_exp_f32 v77, -v77
    v_exp_f32_e64 v142, v94
    v_exp_f32 v94, -v94
    v_pk_mul_f32 v[110:111], v[110:111], v[238:239] op_sel_hi:[1,0]
    v_pk_mul_f32 v[92:93], v[92:93], v[224:225] op_sel_hi:[1,0]
    v_mfma_f32_16x16x32_bf16 a[92:95], v[252:255], v[152:155], a[92:95]
    v_cvt_pk_bf16_f32 v175, v110, v111
    v_exp_f32_e64 v143, v95
    v_cvt_pk_bf16_f32 v159, v78, v79
    v_cvt_pk_bf16_f32 v158, v76, v77
    v_pk_mul_f32 v[102:103], v[102:103], v[238:239] op_sel_hi:[1,0]
    v_pk_mul_f32 v[134:135], v[134:135], v[236:237] op_sel_hi:[1,0]
    v_mfma_f32_16x16x32_bf16 v[180:183], a[232:235], v[148:151], 0
    v_cvt_pk_bf16_f32 v165, v134, v135
    v_exp_f32_e64 v135, v87
    v_exp_f32 v87, -v87
    v_pk_mul_f32 v[100:101], v[100:101], v[238:239] op_sel_hi:[1,0]
    v_pk_mul_f32 v[108:109], v[108:109], v[238:239] op_sel_hi:[1,0]
    v_mfma_f32_16x16x32_bf16 a[80:83], v[248:251], v[144:147], a[80:83]
    v_cvt_pk_bf16_f32 v174, v108, v109
    v_cvt_pk_bf16_f32 v173, v102, v103
    v_exp_f32 v95, -v95
    v_exp_f32_e64 v134, v86
    v_pk_mul_f32 v[140:141], v[140:141], v[236:237] op_sel_hi:[1,0]
    v_cvt_pk_bf16_f32 v166, v140, v141
    v_exp_f32_e64 v140, v92
    v_exp_f32 v92, -v92
    v_mfma_f32_16x16x32_bf16 a[84:87], v[248:251], v[152:155], a[84:87]
    v_cvt_pk_bf16_f32 v248, v220, v221
    v_exp_f32_e64 v141, v93
    v_cvt_pk_bf16_f32 v172, v100, v101
    v_exp_f32 v86, -v86
    v_pk_mul_f32 v[84:85], v[84:85], v[224:225] op_sel_hi:[1,0]
    v_exp_f32 v133, v85
    v_exp_f32 v132, v84
    v_mfma_f32_16x16x32_bf16 a[88:91], v[252:255], v[144:147], a[88:91]
    v_exp_f32 v84, -v84
    v_mfma_f32_16x16x32_bf16 a[100:103], a[232:235], v[252:255], a[100:103]
    v_cvt_pk_bf16_f32 v252, v226, v227
    v_cvt_pk_bf16_f32 v249, v222, v223
    v_mfma_f32_16x16x32_bf16 v[220:223], v[172:175], a[238:241], 0
    v_cvt_pk_bf16_f32 v253, v228, v229
    v_cvt_pk_bf16_f32 v156, v68, v69
    v_exp_f32 v85, -v85
    v_mfma_f32_16x16x32_bf16 v[226:229], v[172:175], a[236:239], 0
    v_cvt_pk_bf16_f32 v173, v86, v87
    v_cvt_pk_bf16_f32 v175, v94, v95
    v_mfma_f32_16x16x32_bf16 v[188:191], a[232:235], v[156:159], 0
    v_cvt_pk_bf16_f32 v172, v84, v85
    v_cvt_pk_bf16_f32 v251, v222, v223
    v_cvt_pk_bf16_f32 v250, v220, v221
    v_exp_f32 v93, -v93
    v_mfma_f32_16x16x32_bf16 v[196:199], v[240:243], v[152:155], v[196:199]
    v_cvt_pk_bf16_f32 v174, v92, v93
    v_cvt_pk_bf16_f32 v255, v228, v229
    v_mfma_f32_16x16x32_bf16 a[96:99], a[232:235], v[248:251], a[96:99]
    v_max3_f32 v237, v180, v188, v237
    v_rcp_f32_e64 v234, v188
    v_cvt_pk_bf16_f32 v254, v226, v227
    v_rcp_f32_e64 v232, v180
    v_pk_mul_f32 v[68:69], v[68:69], v[234:235] op_sel_hi:[1,0]
    v_pk_mul_f32 v[76:77], v[76:77], v[234:235] op_sel_hi:[1,0]
    v_pk_mul_f32 v[70:71], v[70:71], v[234:235] op_sel_hi:[1,0]
    v_cvt_pk_bf16_f32 v158, v76, v77
    v_pk_mul_f32 v[78:79], v[78:79], v[234:235] op_sel_hi:[1,0]
    v_cvt_pk_bf16_f32 v159, v78, v79
    v_pk_mul_f32 v[126:127], v[126:127], v[232:233] op_sel_hi:[1,0]
    v_pk_mul_f32 v[118:119], v[118:119], v[232:233] op_sel_hi:[1,0]
    v_mfma_f32_16x16x32_bf16 v[188:191], a[232:235], v[172:175], 0
    v_cvt_pk_bf16_f32 v156, v68, v69
    v_cvt_pk_bf16_f32 v157, v70, v71
    v_mfma_f32_16x16x32_bf16 a[80:83], v[248:251], v[160:163], a[80:83]
    v_cvt_pk_bf16_f32 v149, v118, v119
    v_cvt_pk_bf16_f32 v151, v126, v127
    v_mfma_f32_16x16x32_bf16 v[220:223], v[156:159], a[238:241], 0
    s_add_u32 s96, s31, 2
    s_and_b32 s96, s96, 7
    v_rcp_f32 v238, v188
    s_lshl_b32 s96, s96, 13
    v_pk_mul_f32 v[86:87], v[86:87], v[238:239] op_sel_hi:[1,0]
    v_pk_mul_f32 v[92:93], v[92:93], v[238:239] op_sel_hi:[1,0]
    v_pk_mul_f32 v[94:95], v[94:95], v[238:239] op_sel_hi:[1,0]
    v_cvt_pk_bf16_f32 v175, v94, v95
    v_pk_mul_f32 v[84:85], v[84:85], v[238:239] op_sel_hi:[1,0]
    v_cvt_pk_bf16_f32 v172, v84, v85
    v_pk_mul_f32 v[124:125], v[124:125], v[232:233] op_sel_hi:[1,0]
    v_pk_mul_f32 v[116:117], v[116:117], v[232:233] op_sel_hi:[1,0]
    v_mfma_f32_16x16x32_bf16 a[84:87], v[248:251], v[168:171], a[84:87]
    v_cvt_pk_bf16_f32 v174, v92, v93
    v_cvt_pk_bf16_f32 v173, v86, v87
    v_mfma_f32_16x16x32_bf16 v[200:203], v[244:247], v[144:147], v[200:203]
    v_cvt_pk_bf16_f32 v248, v220, v221
    v_cvt_pk_bf16_f32 v249, v222, v223
    v_mfma_f32_16x16x32_bf16 a[104:107], a[232:235], v[240:243], a[104:107]
    v_cvt_pk_bf16_f32 v150, v124, v125
    v_cvt_pk_bf16_f32 v148, v116, v117
    v_mfma_f32_16x16x32_bf16 v[204:207], v[244:247], v[152:155], v[204:207]
    s_add_u32 s96, s96, s41
    v_mfma_f32_16x16x32_bf16 v[226:229], v[156:159], a[236:239], 0
    v_mfma_f32_16x16x32_bf16 a[108:111], a[232:235], v[244:247], a[108:111]
    v_cvt_pk_bf16_f32 v244, v216, v217
    v_cvt_pk_bf16_f32 v245, v218, v219
    v_mfma_f32_16x16x32_bf16 v[220:223], v[172:175], a[238:241], 0
    v_mfma_f32_16x16x32_bf16 v[192:195], v[240:243], v[144:147], v[192:195]
    v_cvt_pk_bf16_f32 v241, v214, v215
    v_cvt_pk_bf16_f32 v240, v212, v213
    v_mfma_f32_16x16x32_bf16 v[212:215], v[164:167], a[238:241], 0
    v_mfma_f32_16x16x32_bf16 v[216:219], v[164:167], a[236:239], 0
    v_cvt_pk_bf16_f32 v165, v134, v135
    v_cvt_pk_bf16_f32 v164, v132, v133
    v_mfma_f32_16x16x32_bf16 a[88:91], v[252:255], v[160:163], a[88:91]
    v_cvt_pk_bf16_f32 v166, v140, v141
    v_cvt_pk_bf16_f32 v167, v142, v143
    v_mfma_f32_16x16x32_bf16 a[100:103], a[232:235], v[252:255], a[100:103]
    v_cvt_pk_bf16_f32 v251, v222, v223
    v_cvt_pk_bf16_f32 v250, v220, v221
    v_mfma_f32_16x16x32_bf16 a[92:95], v[252:255], v[168:171], a[92:95]
    v_cvt_pk_bf16_f32 v252, v226, v227
    v_cvt_pk_bf16_f32 v253, v228, v229
    v_mfma_f32_16x16x32_bf16 v[226:229], v[172:175], a[236:239], 0
    v_cvt_pk_bf16_f32 v243, v214, v215
    v_cvt_pk_bf16_f32 v246, v216, v217
    v_mfma_f32_16x16x32_bf16 v[180:183], a[232:235], v[164:167], 0
    v_cvt_pk_bf16_f32 v242, v212, v213
    v_cvt_pk_bf16_f32 v247, v218, v219
    v_mfma_f32_16x16x32_bf16 a[84:87], v[248:251], v[184:187], a[84:87]
    s_nop 1
    v_cvt_pk_bf16_f32 v255, v228, v229
    v_mfma_f32_16x16x32_bf16 a[96:99], a[232:235], v[248:251], a[96:99]
    v_cvt_pk_bf16_f32 v254, v226, v227
    v_max3_f32 v237, v180, v188, v237
    v_mfma_f32_16x16x32_bf16 a[80:83], v[248:251], v[176:179], a[80:83]
    v_add_u32 v248, s3, v233
    v_lshlrev_b32 v250, 3, v209
    v_mfma_f32_16x16x32_bf16 a[88:91], v[252:255], v[176:179], a[88:91]
    v_cmp_nge_f32 vcc, s5, v237
    v_add_u32_e64 v251, s4, v250
    s_cbranch_vccnz L_slowK
    v_mfma_f32_16x16x32_bf16 a[92:95], v[252:255], v[184:187], a[92:95]
    v_add_u32_e64 v250, s3, v250
    ds_write_b128 v248, a[80:83] offset:0
    v_mfma_f32_16x16x32_bf16 a[100:103], a[232:235], v[252:255], a[100:103]
    v_rcp_f32_e64 v236, v180
    v_mfma_f32_16x16x32_bf16 v[212:215], v[148:151], a[238:241], 0
    v_add_u32 v249, s4, v233
    s_waitcnt vmcnt(1)
    v_mfma_f32_16x16x32_bf16 v[216:219], v[148:151], a[236:239], 0
    v_lshrrev_b32_e64 v254, 4, v209
    ds_write_b128 v248, a[84:87] offset:1024
    v_mov_b32_e64 v237, 0
    v_pk_mul_f32 v[140:141], v[140:141], v[236:237] op_sel_hi:[1,0]
    v_pk_mul_f32 v[134:135], v[134:135], v[236:237] op_sel_hi:[1,0]
    v_pk_mul_f32 v[132:133], v[132:133], v[236:237] op_sel_hi:[1,0]
    v_pk_mul_f32 v[142:143], v[142:143], v[236:237] op_sel_hi:[1,0]
    v_mfma_f32_16x16x32_bf16 v[192:195], v[240:243], v[160:163], v[192:195]
    v_cvt_pk_bf16_f32 v166, v140, v141
    v_cvt_pk_bf16_f32 v167, v142, v143
    v_mfma_f32_16x16x32_bf16 v[204:207], v[244:247], v[168:171], v[204:207]
    ds_write_b128 v248, a[88:91] offset:2048
    v_cvt_pk_bf16_f32 v165, v134, v135
    v_mfma_f32_16x16x32_bf16 v[196:199], v[240:243], v[168:171], v[196:199]
    v_cvt_pk_bf16_f32 v164, v132, v133
    v_mov_b32 v255, 889599933
    v_mfma_f32_16x16x32_bf16 a[108:111], a[232:235], v[244:247], a[108:111]
    v_mfma_f32_16x16x32_bf16 a[104:107], a[232:235], v[240:243], a[104:107]
    ds_write_b128 v248, a[92:95] offset:3072
    ds_write2st64_b32 v250, a96, a100 offset0:16 offset1:18
    v_cvt_pk_bf16_f32 v240, v212, v213
    v_cvt_pk_bf16_f32 v241, v214, v215
    v_mfma_f32_16x16x32_bf16 v[212:215], v[164:167], a[238:241], 0
    v_mov_b32 v248, 889599933
    v_mov_b32 v250, 889599933
    v_mfma_f32_16x16x32_bf16 v[200:203], v[244:247], v[160:163], v[200:203]
    v_cvt_pk_bf16_f32 v245, v218, v219
    v_cvt_pk_bf16_f32 v244, v216, v217
    v_mfma_f32_16x16x32_bf16 v[216:219], v[164:167], a[236:239], 0
    s_nop 1
    v_cvt_pk_bf16_f32 v242, v212, v213
    v_cvt_pk_bf16_f32 v243, v214, v215
    v_mfma_f32_16x16x32_bf16 v[4:7], a[72:75], a[0:3], v[4:7]
    s_nop 0
    v_mfma_f32_16x16x32_bf16 v[192:195], v[240:243], v[176:179], v[192:195]
    s_nop 0
    v_cvt_pk_bf16_f32 v247, v218, v219
    v_cvt_pk_bf16_f32 v246, v216, v217
    s_waitcnt lgkmcnt(0)
    s_barrier
    v_mfma_f32_16x16x32_bf16 v[196:199], v[240:243], v[184:187], v[196:199]
    v_mfma_f32_16x16x32_bf16 v[200:203], v[244:247], v[176:179], v[200:203]
    v_mfma_f32_16x16x32_bf16 v[204:207], v[244:247], v[184:187], v[204:207]
    ds_read_b128 v[212:215], v249 offset:0
    ds_read_b128 v[216:219], v249 offset:1024
    ds_read_b128 v[220:223], v249 offset:2048
    ds_read_b128 v[226:229], v249 offset:3072
    ds_read2st64_b32 v[252:253], v251 offset0:16 offset1:18
    v_mfma_f32_16x16x32_bf16 a[108:111], a[232:235], v[244:247], a[108:111]
    v_mov_b32 v249, 889599933
    v_mov_b32 v251, 889599933
    v_mfma_f32_16x16x32_bf16 a[104:107], a[232:235], v[240:243], a[104:107]
    v_mfma_f32_16x16x32_bf16 v[0:3], a[64:67], a[0:3], v[0:3]
    v_mfma_f32_16x16x32_bf16 v[0:3], a[68:71], a[4:7], v[0:3]
    s_waitcnt lgkmcnt(4)
    v_pk_add_f32 v[194:195], v[194:195], v[214:215]
    v_cvt_pk_bf16_f32 v241, v194, v195
    v_pk_add_f32 v[192:193], v[192:193], v[212:213]
    v_cvt_pk_bf16_f32 v240, v192, v193
    s_waitcnt lgkmcnt(3)
    v_pk_add_f32 v[198:199], v[198:199], v[218:219]
    v_cvt_pk_bf16_f32 v245, v198, v199
    s_waitcnt lgkmcnt(2)
    v_pk_add_f32 v[202:203], v[202:203], v[222:223]
    v_cvt_pk_bf16_f32 v243, v202, v203
    v_accvgpr_read_b32 v230, a104
    s_waitcnt lgkmcnt(1)
    v_pk_add_f32 v[206:207], v[206:207], v[228:229]
    v_pk_add_f32 v[204:205], v[204:205], v[226:227]
    v_cvt_pk_bf16_f32 v246, v204, v205
    v_pk_add_f32 v[200:201], v[200:201], v[220:221]
    v_cvt_pk_bf16_f32 v242, v200, v201
    buffer_store_dwordx4 v[240:243], v233, s[16:19], s42 offen offset:0 sc1
    v_accvgpr_read_b32 v231, a108
    s_waitcnt lgkmcnt(0)
    v_add_f32 v253, v253, v231
    v_add_f32 v252, v252, v230
    v_cvt_pk_bf16_f32 v252, v252, v253
    v_cvt_pk_bf16_f32 v247, v206, v207
    v_pk_add_f32 v[196:197], v[196:197], v[216:217]
    v_cvt_pk_bf16_f32 v244, v196, v197
    v_mfma_f32_16x16x32_bf16 v[0:3], a[176:179], a[112:115], v[0:3]
    v_mov_b32 v253, 889599933
    v_mfma_f32_16x16x32_bf16 v[8:11], a[64:67], a[8:11], v[8:11]
    buffer_store_dwordx4 v[244:247], v233, s[16:19], s42 offen offset:1024 sc1
    buffer_store_dword v252, v239, s[16:19], s22 offen sc1
    v_mfma_f32_16x16x32_bf16 v[0:3], a[180:183], a[116:119], v[0:3]
    v_mfma_f32_16x16x32_bf16 v[4:7], a[76:79], a[4:7], v[4:7]
    s_nop 1
    v_lshl_add_u32 v239, v254, 6, v239
    v_mfma_f32_16x16x32_bf16 v[4:7], a[184:187], a[112:115], v[4:7]
    v_mov_b32 v252, 889599933
    v_mov_b32 v254, 889599933
    v_mfma_f32_16x16x32_bf16 v[4:7], a[188:191], a[116:119], v[4:7]
    v_cvt_pk_bf16_f32 v0, v0, v1
    v_cvt_pk_bf16_f32 v1, v2, v3
    v_mfma_f32_16x16x32_bf16 v[12:15], a[72:75], a[8:11], v[12:15]
    v_mfma_f32_16x16x32_bf16 v[8:11], a[68:71], a[12:15], v[8:11]
    v_mfma_f32_16x16x32_bf16 v[8:11], a[176:179], a[120:123], v[8:11]
    v_mfma_f32_16x16x32_bf16 v[12:15], a[76:79], a[12:15], v[12:15]
    v_mfma_f32_16x16x32_bf16 v[12:15], a[184:187], a[120:123], v[12:15]
    s_nop 0
    v_cvt_pk_bf16_f32 v3, v6, v7
    v_mfma_f32_16x16x32_bf16 v[8:11], a[180:183], a[124:127], v[8:11]
    v_cvt_pk_bf16_f32 v2, v4, v5
    v_mfma_f32_16x16x32_bf16 v[12:15], a[188:191], a[124:127], v[12:15]
    s_nop 0
    v_mfma_f32_16x16x32_bf16 v[108:111], a[228:231], v[0:3], 0
    v_mfma_f32_16x16x32_bf16 v[100:103], a[224:227], v[0:3], 0
    v_mfma_f32_16x16x32_bf16 v[32:35], a[64:67], a[32:35], v[32:35]
    s_nop 1
    v_cvt_pk_bf16_f32 v8, v8, v9
    v_cvt_pk_bf16_f32 v9, v10, v11
    v_cvt_pk_bf16_f32 v10, v12, v13
    v_cvt_pk_bf16_f32 v11, v14, v15
    v_pk_mul_f32 v[108:109], v[108:109], v[224:225] op_sel_hi:[1,0]
    v_pk_mul_f32 v[100:101], v[100:101], v[224:225] op_sel_hi:[1,0]
    v_exp_f32_e64 v117, v101
    v_pk_mul_f32 v[102:103], v[102:103], v[224:225] op_sel_hi:[1,0]
    v_mfma_f32_16x16x32_bf16 v[68:71], a[224:227], v[8:11], 0
    v_exp_f32 v101, -v101
    v_mfma_f32_16x16x32_bf16 v[16:19], a[64:67], a[16:19], v[16:19]
    v_exp_f32_e64 v119, v103
    v_mfma_f32_16x16x32_bf16 v[16:19], a[68:71], a[20:23], v[16:19]
    v_exp_f32_e64 v124, v108
    v_mfma_f32_16x16x32_bf16 v[16:19], a[176:179], a[128:131], v[16:19]
    v_exp_f32 v103, -v103
    v_mfma_f32_16x16x32_bf16 v[76:79], a[228:231], v[8:11], 0
    v_exp_f32_e64 v116, v100
    v_exp_f32 v100, -v100
    v_cvt_pk_bf16_f32 v64, v116, v117
    v_pk_mul_f32 v[110:111], v[110:111], v[224:225] op_sel_hi:[1,0]
    v_exp_f32 v126, v110
    v_exp_f32 v127, v111
    v_exp_f32 v111, -v111
    v_exp_f32 v110, -v110
    v_cvt_pk_bf16_f32 v148, v100, v101
    v_cvt_pk_bf16_f32 v151, v110, v111
    v_cvt_pk_bf16_f32 v67, v126, v127
    v_mfma_f32_16x16x32_bf16 v[24:27], a[64:67], a[24:27], v[24:27]
    v_exp_f32_e64 v118, v102
    v_exp_f32 v102, -v102
    v_cvt_pk_bf16_f32 v65, v118, v119
    v_cvt_pk_bf16_f32 v149, v102, v103
    v_pk_mul_f32 v[78:79], v[78:79], v[224:225] op_sel_hi:[1,0]
    v_mfma_f32_16x16x32_bf16 v[20:23], a[72:75], a[16:19], v[20:23]
    v_exp_f32_e64 v142, v78
    v_mfma_f32_16x16x32_bf16 v[20:23], a[76:79], a[20:23], v[20:23]
    v_exp_f32_e64 v143, v79
    v_exp_f32 v79, -v79
    v_cvt_pk_bf16_f32 v75, v142, v143
    v_pk_mul_f32 v[68:69], v[68:69], v[224:225] op_sel_hi:[1,0]
    v_pk_mul_f32 v[70:71], v[70:71], v[224:225] op_sel_hi:[1,0]
    v_pk_mul_f32 v[76:77], v[76:77], v[224:225] op_sel_hi:[1,0]
    v_exp_f32 v140, v76
    v_exp_f32 v134, v70
    v_mfma_f32_16x16x32_bf16 v[32:35], a[68:71], a[36:39], v[32:35]
    v_exp_f32_e64 v141, v77
    v_mfma_f32_16x16x32_bf16 v[32:35], a[176:179], a[144:147], v[32:35]
    v_exp_f32_e64 v132, v68
    v_mfma_f32_16x16x32_bf16 v[16:19], a[180:183], a[132:135], v[16:19]
    v_exp_f32 v68, -v68
    v_mfma_f32_16x16x32_bf16 v[28:31], a[72:75], a[24:27], v[28:31]
    v_exp_f32_e64 v133, v69
    v_mfma_f32_16x16x32_bf16 v[24:27], a[68:71], a[28:31], v[24:27]
    v_cvt_pk_bf16_f32 v72, v132, v133
    v_exp_f32_e64 v135, v71
    v_mfma_f32_16x16x32_bf16 v[36:39], a[72:75], a[32:35], v[36:39]
    v_exp_f32 v71, -v71
    v_mfma_f32_16x16x32_bf16 v[36:39], a[76:79], a[36:39], v[36:39]
    v_exp_f32 v76, -v76
    v_mfma_f32_16x16x32_bf16 v[20:23], a[184:187], a[128:131], v[20:23]
    v_cvt_pk_bf16_f32 v74, v140, v141
    v_cvt_pk_bf16_f32 v16, v16, v17
    v_mfma_f32_16x16x32_bf16 v[20:23], a[188:191], a[132:135], v[20:23]
    v_exp_f32 v70, -v70
    v_mfma_f32_16x16x32_bf16 v[28:31], a[76:79], a[28:31], v[28:31]
    v_cvt_pk_bf16_f32 v165, v70, v71
    v_exp_f32 v69, -v69
    v_mfma_f32_16x16x32_bf16 v[24:27], a[176:179], a[136:139], v[24:27]
    v_cvt_pk_bf16_f32 v164, v68, v69
    v_cvt_pk_bf16_f32 v17, v18, v19
    v_exp_f32 v77, -v77
    v_cvt_pk_bf16_f32 v18, v20, v21
    v_cvt_pk_bf16_f32 v166, v76, v77
    v_mfma_f32_16x16x32_bf16 v[24:27], a[180:183], a[140:143], v[24:27]
    v_cvt_pk_bf16_f32 v73, v134, v135
    v_cvt_pk_bf16_f32 v19, v22, v23
    v_mfma_f32_16x16x32_bf16 v[32:35], a[180:183], a[148:151], v[32:35]
    v_exp_f32 v78, -v78
    v_mfma_f32_16x16x32_bf16 v[40:43], a[64:67], a[40:43], v[40:43]
    v_cvt_pk_bf16_f32 v167, v78, v79
    v_exp_f32_e64 v125, v109
    v_exp_f32 v109, -v109
    v_cvt_pk_bf16_f32 v66, v124, v125
    v_mfma_f32_16x16x32_bf16 v[92:95], a[228:231], v[16:19], 0
    v_exp_f32 v108, -v108
    v_mfma_f32_16x16x32_bf16 v[180:183], a[232:235], v[64:67], 0
    v_cvt_pk_bf16_f32 v150, v108, v109
    v_cvt_pk_bf16_f32 v32, v32, v33
    v_cvt_pk_bf16_f32 v33, v34, v35
    v_cvt_pk_bf16_f32 v24, v24, v25
    v_cvt_pk_bf16_f32 v25, v26, v27
    s_nop 0
    v_pk_mul_f32 v[94:95], v[94:95], v[224:225] op_sel_hi:[1,0]
    v_pk_mul_f32 v[92:93], v[92:93], v[224:225] op_sel_hi:[1,0]
    v_mfma_f32_16x16x32_bf16 v[188:191], a[232:235], v[148:151], 0
    v_exp_f32 v125, v93
    v_mfma_f32_16x16x32_bf16 v[84:87], a[224:227], v[16:19], 0
    v_exp_f32_e64 v126, v94
    v_mfma_f32_16x16x32_bf16 v[44:47], a[72:75], a[40:43], v[44:47]
    v_exp_f32 v94, -v94
    v_mfma_f32_16x16x32_bf16 v[28:31], a[184:187], a[136:139], v[28:31]
    v_exp_f32_e64 v124, v92
    v_mfma_f32_16x16x32_bf16 v[28:31], a[188:191], a[140:143], v[28:31]
    v_max3_f32 v237, v180, v188, v237
    v_rcp_f32_e64 v232, v188
    v_mfma_f32_16x16x32_bf16 v[188:191], a[232:235], v[164:167], 0
    v_mul_f32_e64 v232, v232, v180
    v_exp_f32 v92, -v92
    v_mfma_f32_16x16x32_bf16 v[180:183], a[232:235], v[72:75], 0
    v_cvt_pk_bf16_f32 v82, v124, v125
    v_exp_f32_e64 v127, v95
    v_exp_f32 v95, -v95
    v_cvt_pk_bf16_f32 v83, v126, v127
    v_pk_mul_f32 v[110:111], v[110:111], v[232:233] op_sel_hi:[1,0]
    v_pk_mul_f32 v[102:103], v[102:103], v[232:233] op_sel_hi:[1,0]
    v_cvt_pk_bf16_f32 v27, v30, v31
    v_mfma_f32_16x16x32_bf16 v[36:39], a[184:187], a[144:147], v[36:39]
    v_cvt_pk_bf16_f32 v131, v110, v111
    v_rcp_f32_e64 v234, v188
    v_mfma_f32_16x16x32_bf16 v[36:39], a[188:191], a[148:151], v[36:39]
    v_mul_f32_e64 v234, v234, v180
    v_cvt_pk_bf16_f32 v129, v102, v103
    v_cvt_pk_bf16_f32 v26, v28, v29
    v_cvt_pk_bf16_f32 v151, v94, v95
    v_max3_f32 v237, v180, v188, v237
    v_pk_mul_f32 v[84:85], v[84:85], v[224:225] op_sel_hi:[1,0]
    v_exp_f32 v116, v84
    v_exp_f32 v117, v85
    v_exp_f32 v85, -v85
    v_cvt_pk_bf16_f32 v35, v38, v39
    v_pk_mul_f32 v[108:109], v[108:109], v[232:233] op_sel_hi:[1,0]
    v_pk_mul_f32 v[78:79], v[78:79], v[234:235] op_sel_hi:[1,0]
    v_pk_mul_f32 v[76:77], v[76:77], v[234:235] op_sel_hi:[1,0]
    v_cvt_pk_bf16_f32 v138, v76, v77
    v_pk_mul_f32 v[86:87], v[86:87], v[224:225] op_sel_hi:[1,0]
    v_exp_f32 v119, v87
    v_exp_f32 v118, v86
    v_exp_f32 v86, -v86
    v_cvt_pk_bf16_f32 v81, v118, v119
    v_pk_mul_f32 v[70:71], v[70:71], v[234:235] op_sel_hi:[1,0]
    v_cvt_pk_bf16_f32 v137, v70, v71
    v_cvt_pk_bf16_f32 v130, v108, v109
    v_mfma_f32_16x16x32_bf16 v[108:111], a[228:231], v[24:27], 0
    v_cvt_pk_bf16_f32 v139, v78, v79
    v_exp_f32 v84, -v84
    v_exp_f32 v87, -v87
    v_cvt_pk_bf16_f32 v148, v84, v85
    v_pk_mul_f32 v[68:69], v[68:69], v[234:235] op_sel_hi:[1,0]
    v_cvt_pk_bf16_f32 v136, v68, v69
    v_pk_mul_f32 v[100:101], v[100:101], v[232:233] op_sel_hi:[1,0]
    v_cvt_pk_bf16_f32 v128, v100, v101
    v_pk_mul_f32 v[110:111], v[110:111], v[224:225] op_sel_hi:[1,0]
    v_exp_f32_e64 v143, v111
    v_cvt_pk_bf16_f32 v149, v86, v87
    v_mfma_f32_16x16x32_bf16 v[40:43], a[68:71], a[44:47], v[40:43]
    v_cvt_pk_bf16_f32 v34, v36, v37
    v_cvt_pk_bf16_f32 v80, v116, v117
    v_mfma_f32_16x16x32_bf16 v[56:59], a[64:67], a[56:59], v[56:59]
    v_exp_f32_e64 v142, v110
    v_mfma_f32_16x16x32_bf16 v[68:71], a[224:227], v[32:35], 0
    v_exp_f32 v110, -v110
    v_mfma_f32_16x16x32_bf16 v[76:79], a[228:231], v[32:35], 0
    v_exp_f32 v111, -v111
    v_mfma_f32_16x16x32_bf16 v[180:183], a[232:235], v[80:83], 0
    v_cvt_pk_bf16_f32 v91, v142, v143
    v_cvt_pk_bf16_f32 v167, v110, v111
    v_exp_f32 v93, -v93
    s_nop 2
    v_pk_mul_f32 v[76:77], v[76:77], v[224:225] op_sel_hi:[1,0]
    v_exp_f32 v125, v77
    v_cvt_pk_bf16_f32 v150, v92, v93
    v_pk_mul_f32 v[70:71], v[70:71], v[224:225] op_sel_hi:[1,0]
    v_exp_f32_e64 v119, v71
    v_mfma_f32_16x16x32_bf16 v[40:43], a[176:179], a[152:155], v[40:43]
    v_exp_f32 v77, -v77
    v_mfma_f32_16x16x32_bf16 v[40:43], a[180:183], a[156:159], v[40:43]
    v_exp_f32 v71, -v71
    v_mfma_f32_16x16x32_bf16 v[188:191], a[232:235], v[148:151], 0
    v_exp_f32_e64 v118, v70
    v_mfma_f32_16x16x32_bf16 v[52:55], a[72:75], a[48:51], v[52:55]
    v_exp_f32_e64 v124, v76
    v_exp_f32 v76, -v76
    v_cvt_pk_bf16_f32 v98, v124, v125
    v_pk_mul_f32 v[108:109], v[108:109], v[224:225] op_sel_hi:[1,0]
    v_pk_mul_f32 v[68:69], v[68:69], v[224:225] op_sel_hi:[1,0]
    v_exp_f32 v116, v68
    v_exp_f32 v141, v109
    v_exp_f32 v109, -v109
    v_exp_f32_e64 v140, v108
    v_mfma_f32_16x16x32_bf16 v[56:59], a[68:71], a[60:63], v[56:59]
    v_exp_f32_e64 v117, v69
    v_mfma_f32_16x16x32_bf16 v[100:103], a[224:227], v[24:27], 0
    v_exp_f32 v68, -v68
    v_cvt_pk_bf16_f32 v150, v76, v77
    v_exp_f32 v69, -v69
    v_pk_mul_f32 v[78:79], v[78:79], v[224:225] op_sel_hi:[1,0]
    v_exp_f32 v127, v79
    v_exp_f32 v126, v78
    v_exp_f32 v78, -v78
    v_exp_f32 v79, -v79
    v_pk_mul_f32 v[100:101], v[100:101], v[224:225] op_sel_hi:[1,0]
    v_pk_mul_f32 v[102:103], v[102:103], v[224:225] op_sel_hi:[1,0]
    v_exp_f32_e64 v134, v102
    v_exp_f32 v102, -v102
    v_mfma_f32_16x16x32_bf16 v[60:63], a[72:75], a[56:59], v[60:63]
L_pg6:
    s_cbranch_execz L_pg7
    v_exp_f32 v135, v103
    v_exp_f32 v103, -v103
    v_mfma_f32_16x16x32_bf16 v[52:55], a[76:79], a[52:55], v[52:55]
    v_exp_f32 v108, -v108
    v_mfma_f32_16x16x32_bf16 v[44:47], a[76:79], a[44:47], v[44:47]
    v_cvt_pk_bf16_f32 v165, v102, v103
    v_max3_f32 v237, v180, v188, v237
    v_mfma_f32_16x16x32_bf16 v[44:47], a[184:187], a[152:155], v[44:47]
    v_cvt_pk_bf16_f32 v40, v40, v41
    v_exp_f32_e64 v133, v101
    v_mfma_f32_16x16x32_bf16 v[48:51], a[64:67], a[48:51], v[48:51]
    v_cvt_pk_bf16_f32 v96, v116, v117
    v_cvt_pk_bf16_f32 v148, v68, v69
    v_mfma_f32_16x16x32_bf16 v[48:51], a[68:71], a[52:55], v[48:51]
    v_rcp_f32_e64 v236, v188
    v_mfma_f32_16x16x32_bf16 v[48:51], a[176:179], a[160:163], v[48:51]
    v_cvt_pk_bf16_f32 v151, v78, v79
    v_cvt_pk_bf16_f32 v99, v126, v127
    v_mfma_f32_16x16x32_bf16 v[60:63], a[76:79], a[60:63], v[60:63]
    v_cvt_pk_bf16_f32 v41, v42, v43
    v_exp_f32_e64 v132, v100
    v_mfma_f32_16x16x32_bf16 v[56:59], a[176:179], a[168:171], v[56:59]
    v_exp_f32 v100, -v100
    buffer_load_dword a250, v239, s[16:19], s43 offen sc1
    buffer_load_dword a251, v239, s[16:19], s43 offen offset:256 sc1
    buffer_load_dwordx4 a[192:195], v233, s[16:19], s97 offen offset:0 sc1
    v_mfma_f32_16x16x32_bf16 v[44:47], a[188:191], a[156:159], v[44:47]
    v_cvt_pk_bf16_f32 v88, v132, v133
    v_cvt_pk_bf16_f32 v90, v140, v141
    v_mfma_f32_16x16x32_bf16 v[60:63], a[184:187], a[168:171], v[60:63]
    v_cvt_pk_bf16_f32 v97, v118, v119
    v_cvt_pk_bf16_f32 v166, v108, v109
    v_mfma_f32_16x16x32_bf16 v[48:51], a[180:183], a[164:167], v[48:51]
    v_exp_f32 v70, -v70
    buffer_load_dwordx4 a[196:199], v233, s[16:19], s97 offen offset:1024 sc1
    s_add_u32 s97, s31, 3
    s_and_b32 s97, s97, 7
    s_lshl_b32 s97, s97, 13
    s_add_u32 s97, s97, s41
    v_cvt_pk_bf16_f32 v149, v70, v71
    v_cvt_pk_bf16_f32 v42, v44, v45
    v_mfma_f32_16x16x32_bf16 v[52:55], a[184:187], a[160:163], v[52:55]
    v_cvt_pk_bf16_f32 v43, v46, v47
    v_cvt_pk_bf16_f32 v48, v48, v49
    v_mfma_f32_16x16x32_bf16 v[188:191], a[232:235], v[148:151], 0
    buffer_load_dwordx4 a[200:203], v233, s[16:19], s96 offen offset:0 sc1
    v_mfma_f32_16x16x32_bf16 v[56:59], a[180:183], a[172:175], v[56:59]
    v_cvt_pk_bf16_f32 v49, v50, v51
    v_cvt_pk_bf16_f32 v89, v134, v135
    v_mfma_f32_16x16x32_bf16 v[60:63], a[188:191], a[172:175], v[60:63]
    v_exp_f32 v101, -v101
    v_mfma_f32_16x16x32_bf16 v[4:7], a[232:235], v[88:91], 0
    v_cvt_pk_bf16_f32 v164, v100, v101
    buffer_load_dwordx4 a[204:207], v233, s[16:19], s96 offen offset:1024 sc1
    s_add_u32 s96, s31, 4
    s_and_b32 s96, s96, 7
    s_lshl_b32 s96, s96, 13
    s_add_u32 s96, s96, s41
    v_mfma_f32_16x16x32_bf16 v[12:15], a[232:235], v[164:167], 0
    v_rcp_f32 v232, v188
    v_mul_f32 v236, v236, v180
    v_cvt_pk_bf16_f32 v56, v56, v57
    v_cvt_pk_bf16_f32 v57, v58, v59
    buffer_load_dwordx4 a[208:211], v233, s[16:19], s97 offen offset:0 sc1
    v_pk_mul_f32 v[86:87], v[86:87], v[236:237] op_sel_hi:[1,0]
    v_pk_mul_f32 v[92:93], v[92:93], v[236:237] op_sel_hi:[1,0]
    v_cvt_pk_bf16_f32 v145, v86, v87
    v_pk_mul_f32 v[84:85], v[84:85], v[236:237] op_sel_hi:[1,0]
    v_cvt_pk_bf16_f32 v144, v84, v85
    v_mfma_f32_16x16x32_bf16 v[84:87], a[224:227], v[40:43], 0
    v_cvt_pk_bf16_f32 v146, v92, v93
    v_cvt_pk_bf16_f32 v59, v62, v63
    v_cvt_pk_bf16_f32 v58, v60, v61
    v_rcp_f32_e64 v238, v12
    buffer_load_dwordx4 a[212:215], v233, s[16:19], s97 offen offset:1024 sc1
    s_add_u32 s97, s31, 5
    s_and_b32 s97, s97, 7
    s_lshl_b32 s97, s97, 13
    s_add_u32 s97, s97, s41
    v_pk_mul_f32 v[84:85], v[84:85], v[224:225] op_sel_hi:[1,0]
    v_exp_f32_e64 v132, v84
    v_pk_mul_f32 v[94:95], v[94:95], v[236:237] op_sel_hi:[1,0]
    v_cvt_pk_bf16_f32 v147, v94, v95
    v_mfma_f32_16x16x32_bf16 v[92:95], a[228:231], v[40:43], 0
    buffer_load_dwordx4 a[216:219], v233, s[16:19], s96 offen offset:0 sc1
    v_mul_f32 v238, v238, v4
    v_exp_f32 v133, v85
    v_exp_f32 v85, -v85
    v_pk_mul_f32 v[110:111], v[110:111], v[238:239] op_sel_hi:[1,0]
    v_cvt_pk_bf16_f32 v155, v110, v111
    v_cvt_pk_bf16_f32 v104, v132, v133
    v_pk_mul_f32 v[102:103], v[102:103], v[238:239] op_sel_hi:[1,0]
    v_pk_mul_f32 v[92:93], v[92:93], v[224:225] op_sel_hi:[1,0]
    v_exp_f32_e64 v140, v92
    buffer_load_dwordx4 a[220:223], v233, s[16:19], s96 offen offset:1024 sc1
    s_add_u32 s96, s31, 6
    s_and_b32 s96, s96, 7
    s_lshl_b32 s96, s96, 13
    s_add_u32 s96, s96, s41
    v_mfma_f32_16x16x32_bf16 v[52:55], a[188:191], a[164:167], v[52:55]
    v_exp_f32_e64 v141, v93
    v_mfma_f32_16x16x32_bf16 v[180:183], a[232:235], v[96:99], 0
    v_exp_f32 v92, -v92
    buffer_load_dwordx4 a[80:83], v233, s[16:19], s97 offen offset:0 sc1
    v_pk_mul_f32 v[94:95], v[94:95], v[224:225] op_sel_hi:[1,0]
    v_exp_f32_e64 v142, v94
    v_exp_f32 v94, -v94
    v_cvt_pk_bf16_f32 v153, v102, v103
    v_cvt_pk_bf16_f32 v50, v52, v53
    v_cvt_pk_bf16_f32 v51, v54, v55
    v_mul_f32_e64 v232, v232, v180
    v_pk_mul_f32 v[78:79], v[78:79], v[232:233] op_sel_hi:[1,0]
    v_pk_mul_f32 v[70:71], v[70:71], v[232:233] op_sel_hi:[1,0]
    buffer_load_dwordx4 a[84:87], v233, s[16:19], s97 offen offset:1024 sc1
    s_add_u32 s97, s31, 7
    s_and_b32 s97, s97, 7
    s_lshl_b32 s97, s97, 13
    s_add_u32 s97, s97, s41
    v_cvt_pk_bf16_f32 v161, v70, v71
    v_pk_mul_f32 v[76:77], v[76:77], v[232:233] op_sel_hi:[1,0]
    v_cvt_pk_bf16_f32 v162, v76, v77
    v_pk_mul_f32 v[68:69], v[68:69], v[232:233] op_sel_hi:[1,0]
    v_cvt_pk_bf16_f32 v160, v68, v69
    v_mfma_f32_16x16x32_bf16 v[68:71], a[224:227], v[56:59], 0
    buffer_load_dwordx4 a[88:91], v233, s[16:19], s96 offen offset:0 sc1
    v_pk_mul_f32 v[100:101], v[100:101], v[238:239] op_sel_hi:[1,0]
    v_cvt_pk_bf16_f32 v152, v100, v101
    v_mfma_f32_16x16x32_bf16 v[100:103], a[224:227], v[48:51], 0
    v_exp_f32 v93, -v93
    v_exp_f32 v84, -v84
    v_cvt_pk_bf16_f32 v166, v92, v93
    v_cvt_pk_bf16_f32 v164, v84, v85
    s_waitcnt vmcnt(9)
    v_mfma_f32_16x16x32_bf16 v[216:219], a[238:241], a[196:199], v[196:199]
    buffer_load_dwordx4 a[92:95], v233, s[16:19], s96 offen offset:1024 sc1
    v_pk_mul_f32 v[108:109], v[108:109], v[238:239] op_sel_hi:[1,0]
    v_cvt_pk_bf16_f32 v154, v108, v109
    v_mfma_f32_16x16x32_bf16 v[108:111], a[228:231], v[48:51], 0
    v_exp_f32 v143, v95
    v_exp_f32 v95, -v95
    v_cvt_pk_bf16_f32 v107, v142, v143
    v_cvt_pk_bf16_f32 v167, v94, v95
    v_pk_mul_f32 v[86:87], v[86:87], v[224:225] op_sel_hi:[1,0]
    buffer_load_dwordx4 a[96:99], v233, s[16:19], s97 offen offset:0 sc1
    v_exp_f32 v134, v86
    v_exp_f32 v135, v87
    v_exp_f32 v87, -v87
    v_cvt_pk_bf16_f32 v105, v134, v135
    v_exp_f32 v86, -v86
    v_pk_mul_f32 v[110:111], v[110:111], v[224:225] op_sel_hi:[1,0]
    v_cvt_pk_bf16_f32 v165, v86, v87
    buffer_load_dwordx4 a[100:103], v233, s[16:19], s97 offen offset:1024 sc1
    v_mfma_f32_16x16x32_bf16 v[212:215], a[238:241], a[192:195], v[192:195]
    v_exp_f32_e64 v127, v111
    v_mfma_f32_16x16x32_bf16 v[226:229], a[236:239], a[196:199], v[204:207]
    v_cvt_pk_bf16_f32 v163, v78, v79
    v_cvt_pk_bf16_f32 v106, v140, v141
    v_mfma_f32_16x16x32_bf16 v[76:79], a[228:231], v[56:59], 0
    v_exp_f32 v111, -v111
    v_exp_f32_e64 v126, v110
    v_exp_f32 v110, -v110
    v_pk_mul_f32 v[108:109], v[108:109], v[224:225] op_sel_hi:[1,0]
    v_pk_mul_f32 v[70:71], v[70:71], v[224:225] op_sel_hi:[1,0]
    v_exp_f32_e64 v124, v108
    v_pk_mul_f32 v[100:101], v[100:101], v[224:225] op_sel_hi:[1,0]
    v_exp_f32_e64 v116, v100
    v_pk_mul_f32 v[78:79], v[78:79], v[224:225] op_sel_hi:[1,0]
    v_mfma_f32_16x16x32_bf16 v[220:223], a[236:239], a[192:195], v[200:203]
    v_exp_f32 v117, v101
    v_exp_f32 v143, v79
    v_exp_f32 v125, v109
    s_waitcnt vmcnt(10)
    v_mfma_f32_16x16x32_bf16 v[216:219], a[238:241], a[204:207], v[216:219]
    v_exp_f32 v109, -v109
    v_mfma_f32_16x16x32_bf16 v[212:215], a[238:241], a[200:203], v[212:215]
    v_exp_f32_e64 v134, v70
    v_mfma_f32_16x16x32_bf16 v[226:229], a[236:239], a[204:207], v[226:229]
    v_exp_f32 v70, -v70
    s_waitcnt vmcnt(8)
    v_mfma_f32_16x16x32_bf16 v[226:229], a[236:239], a[212:215], v[226:229]
    v_exp_f32 v142, v78
    v_exp_f32 v101, -v101
    v_exp_f32 v100, -v100
    v_pk_mul_f32 v[102:103], v[102:103], v[224:225] op_sel_hi:[1,0]
    v_exp_f32 v119, v103
    v_exp_f32 v118, v102
    v_mfma_f32_16x16x32_bf16 v[220:223], a[236:239], a[200:203], v[220:223]
    v_exp_f32 v103, -v103
    v_exp_f32 v102, -v102
    v_mfma_f32_16x16x32_bf16 v[212:215], a[238:241], a[208:211], v[212:215]
    v_cvt_pk_bf16_f32 v149, v102, v103
    v_exp_f32_e64 v135, v71
    v_exp_f32 v71, -v71
    v_pk_mul_f32 v[76:77], v[76:77], v[224:225] op_sel_hi:[1,0]
    v_exp_f32 v141, v77
    v_exp_f32 v140, v76
    v_exp_f32 v76, -v76
    v_exp_f32 v77, -v77
    v_cvt_pk_bf16_f32 v122, v140, v141
    v_cvt_pk_bf16_f32 v123, v142, v143
    v_pk_mul_f32 v[68:69], v[68:69], v[224:225] op_sel_hi:[1,0]
    v_exp_f32 v133, v69
    v_exp_f32 v132, v68
    v_exp_f32 v69, -v69
    v_exp_f32 v68, -v68
    v_exp_f32 v108, -v108
    v_cvt_pk_bf16_f32 v148, v100, v101
    v_cvt_pk_bf16_f32 v150, v108, v109
    v_cvt_pk_bf16_f32 v115, v126, v127
    v_max3_f32 v237, v4, v12, v237
    v_mfma_f32_16x16x32_bf16 v[12:15], a[232:235], v[164:167], 0
    v_cvt_pk_bf16_f32 v164, v68, v69
    v_cvt_pk_bf16_f32 v165, v70, v71
    v_mfma_f32_16x16x32_bf16 v[4:7], a[232:235], v[104:107], 0
    v_cvt_pk_bf16_f32 v166, v76, v77
    v_cvt_pk_bf16_f32 v113, v118, v119
    v_mfma_f32_16x16x32_bf16 v[216:219], a[238:241], a[212:215], v[216:219]
    v_cvt_pk_bf16_f32 v121, v134, v135
    v_cvt_pk_bf16_f32 v112, v116, v117
    s_waitcnt vmcnt(7)
    v_mfma_f32_16x16x32_bf16 v[212:215], a[238:241], a[216:219], v[212:215]
    v_cvt_pk_bf16_f32 v120, v132, v133
    v_cvt_pk_bf16_f32 v114, v124, v125
    s_waitcnt vmcnt(6)
    v_mfma_f32_16x16x32_bf16 v[216:219], a[238:241], a[220:223], v[216:219]
    v_exp_f32 v79, -v79
    v_mfma_f32_16x16x32_bf16 v[220:223], a[236:239], a[208:211], v[220:223]
    v_exp_f32 v78, -v78
    v_mfma_f32_16x16x32_bf16 v[220:223], a[236:239], a[216:219], v[220:223]
    v_cvt_pk_bf16_f32 v167, v78, v79
    v_cvt_pk_bf16_f32 v151, v110, v111
    s_waitcnt vmcnt(5)
    v_mfma_f32_16x16x32_bf16 v[220:223], a[236:239], a[80:83], v[220:223]
    v_rcp_f32 v234, v12
    v_mfma_f32_16x16x32_bf16 v[212:215], a[238:241], a[80:83], v[212:215]
    v_mul_f32_e64 v234, v234, v4
    v_max3_f32 v237, v180, v188, v237
    v_max3_f32 v237, v4, v12, v237
    v_mfma_f32_16x16x32_bf16 v[12:15], a[232:235], v[164:167], 0
    v_mfma_f32_16x16x32_bf16 v[188:191], a[232:235], v[148:151], 0
    v_pk_mul_f32 v[84:85], v[84:85], v[234:235] op_sel_hi:[1,0]
    v_pk_mul_f32 v[92:93], v[92:93], v[234:235] op_sel_hi:[1,0]
    v_pk_mul_f32 v[94:95], v[94:95], v[234:235] op_sel_hi:[1,0]
    v_mfma_f32_16x16x32_bf16 v[180:183], a[232:235], v[112:115], 0
    v_cvt_pk_bf16_f32 v170, v92, v93
    v_cvt_pk_bf16_f32 v171, v94, v95
    v_mfma_f32_16x16x32_bf16 v[4:7], a[232:235], v[120:123], 0
    v_rcp_f32_e64 v238, v12
    v_mfma_f32_16x16x32_bf16 v[226:229], a[236:239], a[220:223], v[226:229]
    v_rcp_f32 v236, v188
    s_waitcnt vmcnt(4)
    v_mfma_f32_16x16x32_bf16 v[226:229], a[236:239], a[84:87], v[226:229]
    v_cvt_pk_bf16_f32 v168, v84, v85
    v_mul_f32 v236, v236, v180
    s_waitcnt vmcnt(3)
    v_mfma_f32_16x16x32_bf16 v[220:223], a[236:239], a[88:91], v[220:223]
    v_max3_f32 v237, v180, v188, v237
    v_mul_f32_e64 v238, v238, v4
    v_max3_f32 v237, v4, v12, v237
    v_pk_mul_f32 v[76:77], v[76:77], v[238:239] op_sel_hi:[1,0]
    v_pk_mul_f32 v[108:109], v[108:109], v[236:237] op_sel_hi:[1,0]
    v_pk_mul_f32 v[110:111], v[110:111], v[236:237] op_sel_hi:[1,0]
    v_pk_mul_f32 v[68:69], v[68:69], v[238:239] op_sel_hi:[1,0]
    v_pk_mul_f32 v[100:101], v[100:101], v[236:237] op_sel_hi:[1,0]
    v_cvt_pk_bf16_f32 v176, v100, v101
    v_pk_mul_f32 v[78:79], v[78:79], v[238:239] op_sel_hi:[1,0]
    v_mfma_f32_16x16x32_bf16 v[252:255], a[250:253], a[246:249], v[252:255]
    v_cvt_pk_bf16_f32 v184, v68, v69
    v_cvt_pk_bf16_f32 v178, v108, v109
    v_mfma_f32_16x16x32_bf16 v[216:219], a[238:241], a[84:87], v[216:219]
    v_cvt_pk_bf16_f32 v187, v78, v79
    v_cvt_pk_bf16_f32 v186, v76, v77
    s_waitcnt vmcnt(2)
    v_mfma_f32_16x16x32_bf16 v[226:229], a[236:239], a[92:95], v[226:229]
    v_cvt_pk_bf16_f32 v179, v110, v111
    v_mfma_f32_16x16x32_bf16 v[216:219], a[238:241], a[92:95], v[216:219]
    s_waitcnt vmcnt(0)
    v_mfma_f32_16x16x32_bf16 v[226:229], a[236:239], a[100:103], v[226:229]
    v_mfma_f32_16x16x32_bf16 v[220:223], a[236:239], a[96:99], v[220:223]
    v_pk_mul_f32 v[86:87], v[86:87], v[234:235] op_sel_hi:[1,0]
    v_cvt_pk_bf16_f32 v169, v86, v87
    v_pk_mul_f32 v[102:103], v[102:103], v[236:237] op_sel_hi:[1,0]
    v_cvt_pk_bf16_f32 v177, v102, v103
    v_pk_mul_f32 v[70:71], v[70:71], v[238:239] op_sel_hi:[1,0]
    v_mfma_f32_16x16x32_bf16 v[216:219], a[238:241], a[100:103], v[216:219]
    v_cvt_pk_bf16_f32 v185, v70, v71
    v_mfma_f32_16x16x32_bf16 v[212:215], a[238:241], a[88:91], v[212:215]
    v_mfma_f32_16x16x32_bf16 v[212:215], a[238:241], a[96:99], v[212:215]
    v_mfma_f32_16x16x32_bf16 v[248:251], a[250:253], a[242:245], v[248:251]
    v_cmp_nge_f32 vcc, s5, v237
    s_nop 0
    s_cbranch_vccnz L_slowQ
L_backQ:
    s_waitcnt vmcnt(0)
    s_nop 2
    v_add_f32 v232, v212, v216
    v_add_f32 v234, v248, v249
    v_add_f32 v236, v250, v251
    v_add_f32 v232, v232, v234
    v_add_f32_e64 v232, v232, v236
    v_cmp_u_f32 vcc, v232, v232
    s_nop 0
    s_cbranch_vccnz L_retry
    v_cmp_ne_u32 vcc, 256, v210
    s_nop 0
    s_cbranch_vccnz L_retry
L_valid:
    buffer_store_dword v208, off, s[16:19], s71 sc1
    s_mul_i32 s5, s33, 3072
    v_cvt_pk_bf16_f32 v23, v254, v255
    v_cvt_pk_bf16_f32 v20, v248, v249
    v_cvt_pk_bf16_f32 v22, v252, v253
    v_cvt_pk_bf16_f32 v21, v250, v251
    s_lshl_b32 s4, s34, 14
    s_add_u32 s4, s4, 37888
    v_mfma_f32_16x16x32_bf16 v[132:135], v[20:23], v[80:83], 0
    v_cvt_pk_bf16_f32 v5, v214, v215
    v_cvt_pk_bf16_f32 v7, v222, v223
    v_mfma_f32_16x16x32_bf16 v[32:35], v[20:23], v[112:115], 0
    v_cvt_pk_bf16_f32 v6, v220, v221
    v_cvt_pk_bf16_f32 v13, v218, v219
    v_mfma_f32_16x16x32_bf16 v[56:59], v[20:23], v[120:123], 0
    v_cvt_pk_bf16_f32 v14, v226, v227
    v_cvt_pk_bf16_f32 v15, v228, v229
    v_mfma_f32_16x16x32_bf16 v[84:87], v[20:23], v[64:67], 0
    s_add_u32 s3, s4, s5
    v_add_u32_e64 v28, s3, v233
    ds_write_b128 v28, v[20:23] offset:2048
    v_mfma_f32_16x16x32_bf16 v[156:159], v[20:23], v[88:91], 0
    s_sub_u32 s4, s4, s5
    s_add_u32 s4, s4, 3072
    v_mfma_f32_16x16x32_bf16 v[180:183], v[20:23], v[96:99], 0
    v_cvt_pk_bf16_f32 v12, v216, v217
    v_cvt_pk_bf16_f32 v4, v212, v213
    v_mfma_f32_16x16x32_bf16 v[108:111], v[20:23], v[72:75], 0
    s_lshl_b32 s5, s34, 13
    ds_write_b128 v28, v[4:7] offset:0
    v_mfma_f32_16x16x32_bf16 v[76:79], v[12:15], v[64:67], 0
    v_add_u32 v29, s4, v233
    s_xor_b32 s4, s33, s93
    v_mfma_f32_16x16x32_bf16 v[188:191], v[4:7], v[104:107], 0
    s_lshl_b32 s4, s4, 14
    s_add_u32 s4, s4, s5
    v_mfma_f32_16x16x32_bf16 v[172:175], v[12:15], v[96:99], 0
    s_add_u32 s5, s23, 4096
    ds_write_b128 v28, v[12:15] offset:1024
    v_mfma_f32_16x16x32_bf16 v[40:43], v[4:7], v[120:123], 0
    v_add_u32_e64 v30, s4, v233
    v_mfma_f32_16x16x32_bf16 v[100:103], v[12:15], v[72:75], 0
    v_mfma_f32_16x16x32_bf16 v[124:127], v[12:15], v[80:83], 0
    v_mfma_f32_16x16x32_bf16 v[140:143], v[4:7], v[88:91], 0
    v_mfma_f32_16x16x32_bf16 v[148:151], v[12:15], v[88:91], 0
    v_mfma_f32_16x16x32_bf16 v[16:19], v[4:7], v[112:115], 0
    v_mfma_f32_16x16x32_bf16 v[24:27], v[12:15], v[112:115], 0
    s_waitcnt lgkmcnt(0)
    s_barrier
    v_mfma_f32_16x16x32_bf16 v[48:51], v[12:15], v[120:123], 0
    v_mfma_f32_16x16x32_bf16 v[68:71], v[4:7], v[64:67], 0
    v_mfma_f32_16x16x32_bf16 v[0:3], v[12:15], v[104:107], 0
    ds_read_b128 a[8:11], v29 offset:2048
    v_mfma_f32_16x16x32_bf16 v[164:167], v[4:7], v[96:99], 0
    ds_read_b128 a[0:3], v29 offset:0
    v_mfma_f32_16x16x32_bf16 v[116:119], v[4:7], v[80:83], 0
    ds_read_b128 a[4:7], v29 offset:1024
    v_mfma_f32_16x16x32_bf16 v[92:95], v[4:7], v[72:75], 0
    v_mfma_f32_16x16x32_bf16 v[8:11], v[20:23], v[104:107], 0
    s_waitcnt lgkmcnt(0)
    v_mfma_f32_16x16x32_bf16 v[84:87], a[8:11], v[128:131], v[84:87]
    v_mfma_f32_16x16x32_bf16 v[68:71], a[0:3], v[128:131], v[68:71]
    v_mfma_f32_16x16x32_bf16 v[76:79], a[4:7], v[128:131], v[76:79]
    v_mfma_f32_16x16x32_bf16 v[108:111], a[8:11], v[136:139], v[108:111]
    v_mfma_f32_16x16x32_bf16 v[92:95], a[0:3], v[136:139], v[92:95]
    v_mfma_f32_16x16x32_bf16 v[100:103], a[4:7], v[136:139], v[100:103]
    s_nop 2
    v_rcp_f32 v84, v84
    s_nop 0
    v_pk_mul_f32 v[68:69], v[68:69], v[84:85] op_sel_hi:[1,0]
    v_pk_mul_f32 v[70:71], v[70:71], v[84:85] op_sel_hi:[1,0]
    v_pk_mul_f32 v[76:77], v[76:77], v[84:85] op_sel_hi:[1,0]
    v_pk_mul_f32 v[78:79], v[78:79], v[84:85] op_sel_hi:[1,0]
    v_mfma_f32_16x16x32_bf16 v[132:135], a[8:11], v[144:147], v[132:135]
    v_cvt_pk_bf16_f32 v84, v68, v69
    v_cvt_pk_bf16_f32 v85, v70, v71
    v_mfma_f32_16x16x32_bf16 v[116:119], a[0:3], v[144:147], v[116:119]
    v_cvt_pk_bf16_f32 v86, v76, v77
    v_cvt_pk_bf16_f32 v87, v78, v79
    v_mfma_f32_16x16x32_bf16 v[124:127], a[4:7], v[144:147], v[124:127]
    v_rcp_f32_e64 v108, v108
    buffer_store_dwordx4 v[84:87], v233, s[16:19], s23 offen offset:0 sc1
    ds_write_b128 v30, v[84:87] offset:0
    v_pk_mul_f32 v[92:93], v[92:93], v[108:109] op_sel_hi:[1,0]
    v_pk_mul_f32 v[94:95], v[94:95], v[108:109] op_sel_hi:[1,0]
    v_pk_mul_f32 v[100:101], v[100:101], v[108:109] op_sel_hi:[1,0]
    v_pk_mul_f32 v[102:103], v[102:103], v[108:109] op_sel_hi:[1,0]
    v_mfma_f32_16x16x32_bf16 v[156:159], a[8:11], v[152:155], v[156:159]
    v_cvt_pk_bf16_f32 v108, v92, v93
    v_cvt_pk_bf16_f32 v109, v94, v95
    v_mfma_f32_16x16x32_bf16 v[140:143], a[0:3], v[152:155], v[140:143]
    v_cvt_pk_bf16_f32 v110, v100, v101
    v_cvt_pk_bf16_f32 v111, v102, v103
    v_mfma_f32_16x16x32_bf16 v[148:151], a[4:7], v[152:155], v[148:151]
    v_rcp_f32_e64 v132, v132
    buffer_store_dwordx4 v[108:111], v233, s[16:19], s23 offen offset:1024 sc1
    ds_write_b128 v30, v[108:111] offset:1024
    v_pk_mul_f32 v[116:117], v[116:117], v[132:133] op_sel_hi:[1,0]
    v_pk_mul_f32 v[118:119], v[118:119], v[132:133] op_sel_hi:[1,0]
    v_pk_mul_f32 v[124:125], v[124:125], v[132:133] op_sel_hi:[1,0]
    v_pk_mul_f32 v[126:127], v[126:127], v[132:133] op_sel_hi:[1,0]
    v_mfma_f32_16x16x32_bf16 v[180:183], a[8:11], v[160:163], v[180:183]
    v_cvt_pk_bf16_f32 v132, v116, v117
    v_cvt_pk_bf16_f32 v133, v118, v119
    v_mfma_f32_16x16x32_bf16 v[164:167], a[0:3], v[160:163], v[164:167]
    v_cvt_pk_bf16_f32 v134, v124, v125
    v_cvt_pk_bf16_f32 v135, v126, v127
    v_mfma_f32_16x16x32_bf16 v[172:175], a[4:7], v[160:163], v[172:175]
    v_rcp_f32_e64 v156, v156
    buffer_store_dwordx4 v[132:135], v233, s[16:19], s23 offen offset:2048 sc1
    ds_write_b128 v30, v[132:135] offset:2048
    v_pk_mul_f32 v[140:141], v[140:141], v[156:157] op_sel_hi:[1,0]
    v_pk_mul_f32 v[142:143], v[142:143], v[156:157] op_sel_hi:[1,0]
    v_pk_mul_f32 v[148:149], v[148:149], v[156:157] op_sel_hi:[1,0]
    v_pk_mul_f32 v[150:151], v[150:151], v[156:157] op_sel_hi:[1,0]
    v_mfma_f32_16x16x32_bf16 v[8:11], a[8:11], v[168:171], v[8:11]
    v_cvt_pk_bf16_f32 v156, v140, v141
    v_cvt_pk_bf16_f32 v157, v142, v143
    v_mfma_f32_16x16x32_bf16 v[188:191], a[0:3], v[168:171], v[188:191]
    v_cvt_pk_bf16_f32 v158, v148, v149
    v_cvt_pk_bf16_f32 v159, v150, v151
    v_mfma_f32_16x16x32_bf16 v[0:3], a[4:7], v[168:171], v[0:3]
    v_rcp_f32_e64 v180, v180
    buffer_store_dwordx4 v[156:159], v233, s[16:19], s23 offen offset:3072 sc1
    ds_write_b128 v30, v[156:159] offset:3072
    v_pk_mul_f32 v[164:165], v[164:165], v[180:181] op_sel_hi:[1,0]
    v_pk_mul_f32 v[166:167], v[166:167], v[180:181] op_sel_hi:[1,0]
    v_pk_mul_f32 v[172:173], v[172:173], v[180:181] op_sel_hi:[1,0]
    v_pk_mul_f32 v[174:175], v[174:175], v[180:181] op_sel_hi:[1,0]
    v_mfma_f32_16x16x32_bf16 v[32:35], a[8:11], v[176:179], v[32:35]
    v_cvt_pk_bf16_f32 v180, v164, v165
    v_cvt_pk_bf16_f32 v181, v166, v167
    v_mfma_f32_16x16x32_bf16 v[16:19], a[0:3], v[176:179], v[16:19]
    v_cvt_pk_bf16_f32 v182, v172, v173
    v_cvt_pk_bf16_f32 v183, v174, v175
    v_mfma_f32_16x16x32_bf16 v[24:27], a[4:7], v[176:179], v[24:27]
    v_rcp_f32_e64 v8, v8
    buffer_store_dwordx4 v[180:183], v233, s[16:19], s5 offen offset:0 sc1
    ds_write_b128 v30, v[180:183] offset:4096
    v_pk_mul_f32 v[188:189], v[188:189], v[8:9] op_sel_hi:[1,0]
    v_pk_mul_f32 v[190:191], v[190:191], v[8:9] op_sel_hi:[1,0]
    v_pk_mul_f32 v[0:1], v[0:1], v[8:9] op_sel_hi:[1,0]
    v_pk_mul_f32 v[2:3], v[2:3], v[8:9] op_sel_hi:[1,0]
    v_mfma_f32_16x16x32_bf16 v[56:59], a[8:11], v[184:187], v[56:59]
    v_cvt_pk_bf16_f32 v8, v188, v189
    v_cvt_pk_bf16_f32 v9, v190, v191
    v_mfma_f32_16x16x32_bf16 v[40:43], a[0:3], v[184:187], v[40:43]
    v_cvt_pk_bf16_f32 v10, v0, v1
    v_cvt_pk_bf16_f32 v11, v2, v3
    v_mfma_f32_16x16x32_bf16 v[48:51], a[4:7], v[184:187], v[48:51]
    v_rcp_f32_e64 v32, v32
    buffer_store_dwordx4 v[8:11], v233, s[16:19], s5 offen offset:1024 sc1
    ds_write_b128 v30, v[8:11] offset:5120
    v_pk_mul_f32 v[16:17], v[16:17], v[32:33] op_sel_hi:[1,0]
    v_pk_mul_f32 v[18:19], v[18:19], v[32:33] op_sel_hi:[1,0]
    v_pk_mul_f32 v[24:25], v[24:25], v[32:33] op_sel_hi:[1,0]
    v_pk_mul_f32 v[26:27], v[26:27], v[32:33] op_sel_hi:[1,0]
    v_cvt_pk_bf16_f32 v32, v16, v17
    v_cvt_pk_bf16_f32 v33, v18, v19
    v_cvt_pk_bf16_f32 v34, v24, v25
    v_cvt_pk_bf16_f32 v35, v26, v27
    v_rcp_f32_e64 v56, v56
    buffer_store_dwordx4 v[32:35], v233, s[16:19], s5 offen offset:2048 sc1
    ds_write_b128 v30, v[32:35] offset:6144
    v_pk_mul_f32 v[40:41], v[40:41], v[56:57] op_sel_hi:[1,0]
    v_pk_mul_f32 v[42:43], v[42:43], v[56:57] op_sel_hi:[1,0]
    v_pk_mul_f32 v[48:49], v[48:49], v[56:57] op_sel_hi:[1,0]
    v_pk_mul_f32 v[50:51], v[50:51], v[56:57] op_sel_hi:[1,0]
    v_cvt_pk_bf16_f32 v56, v40, v41
    v_cvt_pk_bf16_f32 v57, v42, v43
    v_cvt_pk_bf16_f32 v58, v48, v49
    v_cvt_pk_bf16_f32 v59, v50, v51
    buffer_store_dwordx4 v[56:59], v233, s[16:19], s5 offen offset:3072 sc1
    ds_write_b128 v30, v[56:59] offset:7168
    s_lshl_b32 s3, s33, 12
    v_add_u32 v193, s3, v233
    v_lshrrev_b32 v66, 2, v209
    v_and_b32 v67, 3, v209
    v_bfe_u32 v64, v66, 1, 2
    v_lshlrev_b32_e64 v65, 7, v66
    v_lshl_add_u32 v65, v67, 3, v65
    v_lshl_add_u32 v65, v64, 5, v65
    s_lshl_b32 s3, s34, 11
    s_add_u32 s3, s3, 65536
    v_add_u32 v198, s3, v65
    v_xor_b32 v199, 32, v198
    v_xor_b32 v200, 64, v198
    v_xor_b32 v201, 96, v198
    s_waitcnt lgkmcnt(0)
    s_barrier
    ds_read_b64_tr_b16 a[32:33], v198 offset:0
    ds_read_b64_tr_b16 a[34:35], v198 offset:4096
    ds_read_b64_tr_b16 a[36:37], v198 offset:8192
    ds_read_b64_tr_b16 a[38:39], v198 offset:12288
    ds_read_b64_tr_b16 a[40:41], v199 offset:0
    ds_read_b64_tr_b16 a[42:43], v199 offset:4096
    ds_read_b64_tr_b16 a[44:45], v199 offset:8192
    ds_read_b64_tr_b16 a[46:47], v199 offset:12288
    ds_read_b64_tr_b16 a[48:49], v200 offset:0
    ds_read_b64_tr_b16 a[50:51], v200 offset:4096
    ds_read_b64_tr_b16 a[52:53], v200 offset:8192
    ds_read_b64_tr_b16 a[54:55], v200 offset:12288
    ds_read_b64_tr_b16 a[56:57], v201 offset:0
    ds_read_b64_tr_b16 a[58:59], v201 offset:4096
    ds_read_b64_tr_b16 a[60:61], v201 offset:8192
    ds_read_b64_tr_b16 a[62:63], v201 offset:12288
    ds_read_b128 a[0:3], v193 offset:0
    ds_read_b128 a[4:7], v193 offset:8192
    ds_read_b128 a[8:11], v193 offset:1024
    ds_read_b128 a[12:15], v193 offset:9216
    ds_read_b128 a[16:19], v193 offset:2048
    ds_read_b128 a[20:23], v193 offset:10240
    ds_read_b128 a[24:27], v193 offset:3072
    ds_read_b128 a[28:31], v193 offset:11264
    v_add_u32 v202, 49152, v198
    v_add_u32 v203, 49152, v199
    v_add_u32 v204, 49152, v200
    v_add_u32 v205, 49152, v201
    s_lshl_b32 s3, s24, 12
    v_add_u32 v192, s3, v233
    v_and_b32 v80, 7, v209
    v_lshlrev_b32 v80, 7, v80
    s_lshl_b32 s3, s93, 12
    s_add_u32 s5, s92, s3
    s_lshl_b32 s3, s24, 10
    s_add_u32 s5, s5, s3
    v_lshrrev_b32 v88, 3, v209
    v_and_b32 v89, 7, v209
    v_and_b32 v194, 6, v88
    v_xor_b32 v89, v89, v194
    s_lshl_b32 s3, s24, 4
    v_add_u32 v88, s3, v88
    v_lshlrev_b32_e64 v88, 11, v88
    v_lshl_add_u32 v196, v89, 4, v88
    v_add_u32 v194, 2048, v196
    v_add_u32 v195, 17408, v196
    v_add_u32 v197, 15488, v196
    v_add_u32 v196, 128, v196
    v_and_b32 v88, 15, v209
    v_lshrrev_b32 v89, 4, v209
    v_and_b32 v90, 1, v89
    v_lshlrev_b32 v90, 1, v90
    v_lshrrev_b32 v89, 1, v89
    v_add_u32 v90, v89, v90
    v_and_b32 v89, 7, v88
    v_xor_b32 v90, v90, v89
    v_lshlrev_b32_e64 v90, 4, v90
    v_lshl_add_u32 v90, v88, 7, v90
    s_lshl_b32 s3, s24, 13
    s_add_u32 s3, s3, 65536
    v_add_u32 v212, s3, v90
    v_xor_b32 v213, 64, v212
    v_lshrrev_b32 v88, 3, v209
    v_and_b32 v89, 7, v209
    v_lshlrev_b32 v90, 4, v89
    v_lshl_add_u32 v206, v88, 12, v90
    v_xor_b32 v89, v89, v88
    v_lshlrev_b32 v89, 4, v89
    v_lshl_add_u32 v89, v88, 7, v89
    v_add_u32 v214, s3, v89
    s_waitcnt lgkmcnt(0)
    v_mfma_f32_16x16x32_bf16 v[0:3], a[32:35], a[0:3], 0
    v_mfma_f32_16x16x32_bf16 v[0:3], a[36:39], a[4:7], v[0:3]
    ds_read_b64_tr_b16 a[96:97], v198 offset:16384
    v_mfma_f32_16x16x32_bf16 v[16:19], a[32:35], a[8:11], 0
    ds_read_b64_tr_b16 a[98:99], v198 offset:20480
    v_mfma_f32_16x16x32_bf16 v[16:19], a[36:39], a[12:15], v[16:19]
L_pg7:
    s_cbranch_execz L_body
    v_mfma_f32_16x16x32_bf16 v[32:35], a[32:35], a[16:19], 0
    ds_read_b64_tr_b16 a[100:101], v198 offset:24576
    v_mfma_f32_16x16x32_bf16 v[32:35], a[36:39], a[20:23], v[32:35]
    ds_read_b64_tr_b16 a[102:103], v198 offset:28672
    v_mfma_f32_16x16x32_bf16 v[48:51], a[32:35], a[24:27], 0
    v_mfma_f32_16x16x32_bf16 v[48:51], a[36:39], a[28:31], v[48:51]
    ds_read_b64_tr_b16 a[104:105], v199 offset:16384
    v_mfma_f32_16x16x32_bf16 v[52:55], a[40:43], a[24:27], 0
    ds_read_b64_tr_b16 a[106:107], v199 offset:20480
    v_mfma_f32_16x16x32_bf16 v[52:55], a[44:47], a[28:31], v[52:55]
    v_mfma_f32_16x16x32_bf16 v[36:39], a[40:43], a[16:19], 0
    ds_read_b64_tr_b16 a[108:109], v199 offset:24576
    v_mfma_f32_16x16x32_bf16 v[36:39], a[44:47], a[20:23], v[36:39]
    ds_read_b64_tr_b16 a[110:111], v199 offset:28672
    v_mfma_f32_16x16x32_bf16 v[20:23], a[40:43], a[8:11], 0
    v_mfma_f32_16x16x32_bf16 v[20:23], a[44:47], a[12:15], v[20:23]
    ds_read_b64_tr_b16 a[112:113], v200 offset:16384
    v_mfma_f32_16x16x32_bf16 v[4:7], a[40:43], a[0:3], 0
    v_mfma_f32_16x16x32_bf16 v[4:7], a[44:47], a[4:7], v[4:7]
    ds_read_b64_tr_b16 a[114:115], v200 offset:20480
    s_waitcnt vmcnt(0)
    buffer_store_dword v208, v235, s[16:19], s92 offen sc1
    v_mfma_f32_16x16x32_bf16 v[8:11], a[48:51], a[0:3], 0
    ds_read_b64_tr_b16 a[116:117], v200 offset:24576
    v_mfma_f32_16x16x32_bf16 v[8:11], a[52:55], a[4:7], v[8:11]
    v_mfma_f32_16x16x32_bf16 v[24:27], a[48:51], a[8:11], 0
    ds_read_b64_tr_b16 a[118:119], v200 offset:28672
    v_mfma_f32_16x16x32_bf16 v[24:27], a[52:55], a[12:15], v[24:27]
    ds_read_b64_tr_b16 a[120:121], v201 offset:16384
    v_mfma_f32_16x16x32_bf16 v[40:43], a[48:51], a[16:19], 0
    v_mfma_f32_16x16x32_bf16 v[40:43], a[52:55], a[20:23], v[40:43]
    ds_read_b64_tr_b16 a[122:123], v201 offset:20480
    v_mfma_f32_16x16x32_bf16 v[56:59], a[48:51], a[24:27], 0
    ds_read_b64_tr_b16 a[124:125], v201 offset:24576
    v_mfma_f32_16x16x32_bf16 v[56:59], a[52:55], a[28:31], v[56:59]
    v_mfma_f32_16x16x32_bf16 v[60:63], a[56:59], a[24:27], 0
    ds_read_b64_tr_b16 a[126:127], v201 offset:28672
    v_mfma_f32_16x16x32_bf16 v[60:63], a[60:63], a[28:31], v[60:63]
    v_mfma_f32_16x16x32_bf16 v[44:47], a[56:59], a[16:19], 0
    v_mfma_f32_16x16x32_bf16 v[44:47], a[60:63], a[20:23], v[44:47]
    v_mfma_f32_16x16x32_bf16 v[28:31], a[56:59], a[8:11], 0
    v_mfma_f32_16x16x32_bf16 v[28:31], a[60:63], a[12:15], v[28:31]
    v_mfma_f32_16x16x32_bf16 v[12:15], a[56:59], a[0:3], 0
    v_mfma_f32_16x16x32_bf16 v[12:15], a[60:63], a[4:7], v[12:15]
    s_waitcnt lgkmcnt(0)
    s_barrier
    s_add_u32 m0, s94, 0
    s_xor_b32 s28, s30, 6
    s_lshl_b32 s28, s28, 17
    buffer_load_dwordx4 v194, s[80:83], s28 offen offset:0  lds
    buffer_load_dwordx4 v195, s[80:83], s28 offen offset:1024  lds
    buffer_load_dwordx4 v196, s[80:83], s28 offen offset:2048  lds
    buffer_load_dwordx4 v197, s[80:83], s28 offen offset:3072  lds
    s_add_u32 m0, s94, 16384
    s_xor_b32 s28, s30, 7
    s_lshl_b32 s28, s28, 17
    buffer_load_dwordx4 v194, s[80:83], s28 offen offset:0  lds
    buffer_load_dwordx4 v195, s[80:83], s28 offen offset:1024  lds
    buffer_load_dwordx4 v196, s[80:83], s28 offen offset:2048  lds
    buffer_load_dwordx4 v197, s[80:83], s28 offen offset:3072  lds
    s_xor_b32 s3, s30, 4
    s_lshl_b32 s8, s3, 14
    s_xor_b32 s3, s30, 5
    s_lshl_b32 s9, s3, 14
    s_xor_b32 s3, s30, 6
    s_lshl_b32 s10, s3, 14
    s_xor_b32 s3, s30, 7
    s_lshl_b32 s11, s3, 14
    s_xor_b32 s3, s30, 8
    s_lshl_b32 s12, s3, 14
    s_lshl_b32 s73, s3, 17
    s_xor_b32 s3, s30, 9
    s_lshl_b32 s13, s3, 14
    s_lshl_b32 s74, s3, 17
    s_xor_b32 s3, s30, 10
    s_lshl_b32 s14, s3, 14
    s_lshl_b32 s75, s3, 17
    s_xor_b32 s3, s30, 11
    s_lshl_b32 s15, s3, 14
    s_lshl_b32 s76, s3, 17
    s_xor_b32 s3, s30, 12
    s_lshl_b32 s64, s3, 14
    s_lshl_b32 s77, s3, 17
    s_xor_b32 s3, s30, 13
    s_lshl_b32 s65, s3, 14
    s_lshl_b32 s78, s3, 17
    s_xor_b32 s3, s30, 14
    s_lshl_b32 s66, s3, 14
    s_lshl_b32 s79, s3, 17
    s_xor_b32 s3, s30, 15
    s_lshl_b32 s67, s3, 14
    s_lshl_b32 s41, s3, 17
    buffer_load_dword v96, v80, s[16:19], s5 offen sc1
    ds_read_b64_tr_b16 a[128:129], v198 offset:32768
    ds_read_b64_tr_b16 a[130:131], v198 offset:36864
    ds_read_b64_tr_b16 a[132:133], v198 offset:40960
    ds_read_b64_tr_b16 a[134:135], v198 offset:45056
    ds_read_b64_tr_b16 a[136:137], v199 offset:32768
    ds_read_b64_tr_b16 a[138:139], v199 offset:36864
    ds_read_b64_tr_b16 a[140:141], v199 offset:40960
    ds_read_b64_tr_b16 a[142:143], v199 offset:45056
    ds_read_b64_tr_b16 a[144:145], v200 offset:32768
    ds_read_b64_tr_b16 a[146:147], v200 offset:36864
    ds_read_b64_tr_b16 a[148:149], v200 offset:40960
    ds_read_b64_tr_b16 a[150:151], v200 offset:45056
    ds_read_b64_tr_b16 a[152:153], v201 offset:32768
    ds_read_b64_tr_b16 a[154:155], v201 offset:36864
    ds_read_b64_tr_b16 a[156:157], v201 offset:40960
    ds_read_b64_tr_b16 a[158:159], v201 offset:45056
    ds_read_b64_tr_b16 a[160:161], v202 offset:0
    ds_read_b64_tr_b16 a[162:163], v202 offset:4096
    ds_read_b64_tr_b16 a[164:165], v202 offset:8192
    ds_read_b64_tr_b16 a[166:167], v202 offset:12288
    ds_read_b64_tr_b16 a[168:169], v203 offset:0
    ds_read_b64_tr_b16 a[170:171], v203 offset:4096
    ds_read_b64_tr_b16 a[172:173], v203 offset:8192
    ds_read_b64_tr_b16 a[174:175], v203 offset:12288
    ds_read_b64_tr_b16 a[176:177], v204 offset:0
    ds_read_b64_tr_b16 a[178:179], v204 offset:4096
    ds_read_b64_tr_b16 a[180:181], v204 offset:8192
    ds_read_b64_tr_b16 a[182:183], v204 offset:12288
    ds_read_b64_tr_b16 a[184:185], v205 offset:0
    ds_read_b64_tr_b16 a[186:187], v205 offset:4096
    ds_read_b64_tr_b16 a[188:189], v205 offset:8192
    ds_read_b64_tr_b16 a[190:191], v205 offset:12288
L_o_poll:
    s_waitcnt vmcnt(0)
    v_cmp_ne_u32 vcc, 1, v96
    s_nop 0
    s_cbranch_vccz L_o_ready
    s_sleep 2
    buffer_load_dword v96, v80, s[16:19], s5 offen sc1
    s_branch L_o_poll
L_o_ready:
    s_mov_b64 exec, -1
    s_waitcnt lgkmcnt(0)
    s_barrier
    s_add_u32 m0, s25, 16384
    s_xor_b32 s27, s30, 1
    s_lshl_b32 s27, s27, 14
    buffer_load_dwordx4 v192, s[88:91], s27 offen offset:0 sc1 lds
    buffer_load_dwordx4 v192, s[88:91], s27 offen offset:1024 sc1 lds
    buffer_load_dwordx4 v192, s[88:91], s27 offen offset:2048 sc1 lds
    buffer_load_dwordx4 v192, s[88:91], s27 offen offset:3072 sc1 lds
    s_add_u32 m0, s25, 32768
    s_xor_b32 s27, s30, 2
    s_lshl_b32 s27, s27, 14
    buffer_load_dwordx4 v192, s[88:91], s27 offen offset:0 sc1 lds
    buffer_load_dwordx4 v192, s[88:91], s27 offen offset:1024 sc1 lds
    buffer_load_dwordx4 v192, s[88:91], s27 offen offset:2048 sc1 lds
    buffer_load_dwordx4 v192, s[88:91], s27 offen offset:3072 sc1 lds
    s_add_u32 m0, s25, 49152
    s_xor_b32 s27, s30, 3
    s_lshl_b32 s27, s27, 14
    buffer_load_dwordx4 v192, s[88:91], s27 offen offset:0 sc1 lds
    buffer_load_dwordx4 v192, s[88:91], s27 offen offset:1024 sc1 lds
    buffer_load_dwordx4 v192, s[88:91], s27 offen offset:2048 sc1 lds
    buffer_load_dwordx4 v192, s[88:91], s27 offen offset:3072 sc1 lds
    ds_read_b64_tr_b16 v[100:101], v202 offset:16384
    ds_read_b64_tr_b16 v[102:103], v202 offset:20480
    ds_read_b64_tr_b16 v[104:105], v202 offset:24576
    ds_read_b64_tr_b16 v[106:107], v202 offset:28672
    ds_read_b64_tr_b16 v[108:109], v203 offset:16384
    ds_read_b64_tr_b16 v[110:111], v203 offset:20480
    ds_read_b64_tr_b16 v[112:113], v203 offset:24576
    ds_read_b64_tr_b16 v[114:115], v203 offset:28672
    ds_read_b64_tr_b16 v[116:117], v204 offset:16384
    ds_read_b64_tr_b16 v[118:119], v204 offset:20480
    ds_read_b64_tr_b16 v[120:121], v204 offset:24576
    ds_read_b64_tr_b16 v[122:123], v204 offset:28672
    ds_read_b64_tr_b16 v[124:125], v205 offset:16384
    ds_read_b64_tr_b16 v[126:127], v205 offset:20480
    ds_read_b64_tr_b16 v[128:129], v205 offset:24576
    ds_read_b64_tr_b16 v[130:131], v205 offset:28672
    s_mov_b64 exec, 0
    s_cmp_eq_u32 s24, 0
    s_cbranch_scc1 L_pg8
    s_cmp_eq_u32 s24, 1
    s_cbranch_scc1 L_pg9
L_back2:
    s_mov_b64 exec, -1
    s_nop 3
    s_waitcnt vmcnt(8)
    s_barrier
    ds_read_b128 a[64:67], v193 offset:16384
    ds_read_b128 a[68:71], v193 offset:24576
    ds_read_b128 a[72:75], v193 offset:17408
    ds_read_b128 a[76:79], v193 offset:25600
    ds_read_b128 a[80:83], v193 offset:18432
    ds_read_b128 a[84:87], v193 offset:26624
    ds_read_b128 a[88:91], v193 offset:19456
    ds_read_b128 a[92:95], v193 offset:27648
    s_waitcnt vmcnt(4) lgkmcnt(0)
    s_barrier
    v_mfma_f32_16x16x32_bf16 v[0:3], a[96:99], a[64:67], v[0:3]
    s_add_u32 m0, s25, 0
    ds_read_b128 a[0:3], v193 offset:32768
    v_mfma_f32_16x16x32_bf16 v[0:3], a[100:103], a[68:71], v[0:3]
    buffer_load_dwordx4 v192, s[88:91], s8 offen offset:0 sc1 lds
    v_mfma_f32_16x16x32_bf16 v[16:19], a[96:99], a[72:75], v[16:19]
    v_mfma_f32_16x16x32_bf16 v[16:19], a[100:103], a[76:79], v[16:19]
    ds_read_b128 a[4:7], v193 offset:40960
    v_mfma_f32_16x16x32_bf16 v[32:35], a[96:99], a[80:83], v[32:35]
    v_mfma_f32_16x16x32_bf16 v[32:35], a[100:103], a[84:87], v[32:35]
    buffer_load_dwordx4 v192, s[88:91], s8 offen offset:1024 sc1 lds
    v_mfma_f32_16x16x32_bf16 v[48:51], a[96:99], a[88:91], v[48:51]
    ds_read_b128 a[8:11], v193 offset:33792
    v_mfma_f32_16x16x32_bf16 v[48:51], a[100:103], a[92:95], v[48:51]
    v_mfma_f32_16x16x32_bf16 v[52:55], a[104:107], a[88:91], v[52:55]
    v_mfma_f32_16x16x32_bf16 v[52:55], a[108:111], a[92:95], v[52:55]
    buffer_load_dwordx4 v192, s[88:91], s8 offen offset:2048 sc1 lds
    v_mfma_f32_16x16x32_bf16 v[36:39], a[104:107], a[80:83], v[36:39]
    ds_read_b128 a[12:15], v193 offset:41984
    v_mfma_f32_16x16x32_bf16 v[36:39], a[108:111], a[84:87], v[36:39]
    v_mfma_f32_16x16x32_bf16 v[20:23], a[104:107], a[72:75], v[20:23]
    v_mfma_f32_16x16x32_bf16 v[20:23], a[108:111], a[76:79], v[20:23]
    buffer_load_dwordx4 v192, s[88:91], s8 offen offset:3072 sc1 lds
    ds_read_b128 a[16:19], v193 offset:34816
    v_mfma_f32_16x16x32_bf16 v[4:7], a[104:107], a[64:67], v[4:7]
    v_mfma_f32_16x16x32_bf16 v[4:7], a[108:111], a[68:71], v[4:7]
    v_mfma_f32_16x16x32_bf16 v[8:11], a[112:115], a[64:67], v[8:11]
    s_add_u32 m0, s25, 16384
    ds_read_b128 a[20:23], v193 offset:43008
    v_mfma_f32_16x16x32_bf16 v[8:11], a[116:119], a[68:71], v[8:11]
    buffer_load_dwordx4 v192, s[88:91], s9 offen offset:0 sc1 lds
    v_mfma_f32_16x16x32_bf16 v[24:27], a[112:115], a[72:75], v[24:27]
    v_mfma_f32_16x16x32_bf16 v[24:27], a[116:119], a[76:79], v[24:27]
    v_mfma_f32_16x16x32_bf16 v[40:43], a[112:115], a[80:83], v[40:43]
    ds_read_b128 a[24:27], v193 offset:35840
    v_mfma_f32_16x16x32_bf16 v[40:43], a[116:119], a[84:87], v[40:43]
    buffer_load_dwordx4 v192, s[88:91], s9 offen offset:1024 sc1 lds
    v_mfma_f32_16x16x32_bf16 v[56:59], a[112:115], a[88:91], v[56:59]
    v_mfma_f32_16x16x32_bf16 v[56:59], a[116:119], a[92:95], v[56:59]
    ds_read_b128 a[28:31], v193 offset:44032
    v_mfma_f32_16x16x32_bf16 v[60:63], a[120:123], a[88:91], v[60:63]
    v_mfma_f32_16x16x32_bf16 v[60:63], a[124:127], a[92:95], v[60:63]
    buffer_load_dwordx4 v192, s[88:91], s9 offen offset:2048 sc1 lds
    v_mfma_f32_16x16x32_bf16 v[44:47], a[120:123], a[80:83], v[44:47]
    v_mfma_f32_16x16x32_bf16 v[44:47], a[124:127], a[84:87], v[44:47]
    v_mfma_f32_16x16x32_bf16 v[28:31], a[120:123], a[72:75], v[28:31]
    v_mfma_f32_16x16x32_bf16 v[28:31], a[124:127], a[76:79], v[28:31]
    buffer_load_dwordx4 v192, s[88:91], s9 offen offset:3072 sc1 lds
    v_mfma_f32_16x16x32_bf16 v[12:15], a[120:123], a[64:67], v[12:15]
    v_mfma_f32_16x16x32_bf16 v[12:15], a[124:127], a[68:71], v[12:15]
    s_waitcnt vmcnt(8) lgkmcnt(0)
    s_barrier
    v_mfma_f32_16x16x32_bf16 v[0:3], a[128:131], a[0:3], v[0:3]
    s_add_u32 m0, s25, 32768
    ds_read_b128 a[64:67], v193 offset:49152
    v_mfma_f32_16x16x32_bf16 v[0:3], a[132:135], a[4:7], v[0:3]
    buffer_load_dwordx4 v192, s[88:91], s10 offen offset:0 sc1 lds
    v_mfma_f32_16x16x32_bf16 v[16:19], a[128:131], a[8:11], v[16:19]
    v_mfma_f32_16x16x32_bf16 v[16:19], a[132:135], a[12:15], v[16:19]
    ds_read_b128 a[68:71], v193 offset:57344
    v_mfma_f32_16x16x32_bf16 v[32:35], a[128:131], a[16:19], v[32:35]
    v_mfma_f32_16x16x32_bf16 v[32:35], a[132:135], a[20:23], v[32:35]
    buffer_load_dwordx4 v192, s[88:91], s10 offen offset:1024 sc1 lds
    v_mfma_f32_16x16x32_bf16 v[48:51], a[128:131], a[24:27], v[48:51]
    ds_read_b128 a[72:75], v193 offset:50176
    v_mfma_f32_16x16x32_bf16 v[48:51], a[132:135], a[28:31], v[48:51]
    v_mfma_f32_16x16x32_bf16 v[52:55], a[136:139], a[24:27], v[52:55]
    v_mfma_f32_16x16x32_bf16 v[52:55], a[140:143], a[28:31], v[52:55]
    buffer_load_dwordx4 v192, s[88:91], s10 offen offset:2048 sc1 lds
    v_mfma_f32_16x16x32_bf16 v[36:39], a[136:139], a[16:19], v[36:39]
    ds_read_b128 a[76:79], v193 offset:58368
    v_mfma_f32_16x16x32_bf16 v[36:39], a[140:143], a[20:23], v[36:39]
    v_mfma_f32_16x16x32_bf16 v[20:23], a[136:139], a[8:11], v[20:23]
    v_mfma_f32_16x16x32_bf16 v[20:23], a[140:143], a[12:15], v[20:23]
    buffer_load_dwordx4 v192, s[88:91], s10 offen offset:3072 sc1 lds
    ds_read_b128 a[80:83], v193 offset:51200
    v_mfma_f32_16x16x32_bf16 v[4:7], a[136:139], a[0:3], v[4:7]
    v_mfma_f32_16x16x32_bf16 v[4:7], a[140:143], a[4:7], v[4:7]
    v_mfma_f32_16x16x32_bf16 v[8:11], a[144:147], a[0:3], v[8:11]
    s_add_u32 m0, s94, 32768
    ds_read_b128 a[84:87], v193 offset:59392
    v_mfma_f32_16x16x32_bf16 v[8:11], a[148:151], a[4:7], v[8:11]
    buffer_load_dwordx4 v194, s[80:83], s73 offen offset:0  lds
    v_mfma_f32_16x16x32_bf16 v[24:27], a[144:147], a[8:11], v[24:27]
    v_mfma_f32_16x16x32_bf16 v[24:27], a[148:151], a[12:15], v[24:27]
    v_mfma_f32_16x16x32_bf16 v[40:43], a[144:147], a[16:19], v[40:43]
    ds_read_b128 a[88:91], v193 offset:52224
    v_mfma_f32_16x16x32_bf16 v[40:43], a[148:151], a[20:23], v[40:43]
    buffer_load_dwordx4 v195, s[80:83], s73 offen offset:1024  lds
    v_mfma_f32_16x16x32_bf16 v[56:59], a[144:147], a[24:27], v[56:59]
    v_mfma_f32_16x16x32_bf16 v[56:59], a[148:151], a[28:31], v[56:59]
    ds_read_b128 a[92:95], v193 offset:60416
    v_mfma_f32_16x16x32_bf16 v[60:63], a[152:155], a[24:27], v[60:63]
    v_mfma_f32_16x16x32_bf16 v[60:63], a[156:159], a[28:31], v[60:63]
    buffer_load_dwordx4 v196, s[80:83], s73 offen offset:2048  lds
    v_mfma_f32_16x16x32_bf16 v[44:47], a[152:155], a[16:19], v[44:47]
    v_mfma_f32_16x16x32_bf16 v[44:47], a[156:159], a[20:23], v[44:47]
    v_mfma_f32_16x16x32_bf16 v[28:31], a[152:155], a[8:11], v[28:31]
    v_mfma_f32_16x16x32_bf16 v[28:31], a[156:159], a[12:15], v[28:31]
    buffer_load_dwordx4 v197, s[80:83], s73 offen offset:3072  lds
    v_mfma_f32_16x16x32_bf16 v[12:15], a[152:155], a[0:3], v[12:15]
    v_mfma_f32_16x16x32_bf16 v[12:15], a[156:159], a[4:7], v[12:15]
    s_waitcnt vmcnt(12) lgkmcnt(0)
    s_barrier
    v_mfma_f32_16x16x32_bf16 v[0:3], a[160:163], a[64:67], v[0:3]
    s_add_u32 m0, s25, 49152
    ds_read_b128 a[0:3], v193 offset:0
    v_mfma_f32_16x16x32_bf16 v[0:3], a[164:167], a[68:71], v[0:3]
    buffer_load_dwordx4 v192, s[88:91], s11 offen offset:0 sc1 lds
    v_mfma_f32_16x16x32_bf16 v[16:19], a[160:163], a[72:75], v[16:19]
    v_mfma_f32_16x16x32_bf16 v[16:19], a[164:167], a[76:79], v[16:19]
    ds_read_b128 a[4:7], v193 offset:8192
    v_mfma_f32_16x16x32_bf16 v[32:35], a[160:163], a[80:83], v[32:35]
    v_mfma_f32_16x16x32_bf16 v[32:35], a[164:167], a[84:87], v[32:35]
    buffer_load_dwordx4 v192, s[88:91], s11 offen offset:1024 sc1 lds
    v_mfma_f32_16x16x32_bf16 v[48:51], a[160:163], a[88:91], v[48:51]
    ds_read_b128 a[8:11], v193 offset:1024
    v_mfma_f32_16x16x32_bf16 v[48:51], a[164:167], a[92:95], v[48:51]
    v_mfma_f32_16x16x32_bf16 v[52:55], a[168:171], a[88:91], v[52:55]
    v_mfma_f32_16x16x32_bf16 v[52:55], a[172:175], a[92:95], v[52:55]
    buffer_load_dwordx4 v192, s[88:91], s11 offen offset:2048 sc1 lds
    v_mfma_f32_16x16x32_bf16 v[36:39], a[168:171], a[80:83], v[36:39]
    ds_read_b128 a[12:15], v193 offset:9216
    v_mfma_f32_16x16x32_bf16 v[36:39], a[172:175], a[84:87], v[36:39]
    v_mfma_f32_16x16x32_bf16 v[20:23], a[168:171], a[72:75], v[20:23]
    v_mfma_f32_16x16x32_bf16 v[20:23], a[172:175], a[76:79], v[20:23]
    buffer_load_dwordx4 v192, s[88:91], s11 offen offset:3072 sc1 lds
    ds_read_b128 a[16:19], v193 offset:2048
    v_mfma_f32_16x16x32_bf16 v[4:7], a[168:171], a[64:67], v[4:7]
    v_mfma_f32_16x16x32_bf16 v[4:7], a[172:175], a[68:71], v[4:7]
    v_mfma_f32_16x16x32_bf16 v[8:11], a[176:179], a[64:67], v[8:11]
    s_add_u32 m0, s94, 49152
    ds_read_b128 a[20:23], v193 offset:10240
    v_mfma_f32_16x16x32_bf16 v[8:11], a[180:183], a[68:71], v[8:11]
    buffer_load_dwordx4 v194, s[80:83], s74 offen offset:0  lds
    v_mfma_f32_16x16x32_bf16 v[24:27], a[176:179], a[72:75], v[24:27]
    v_mfma_f32_16x16x32_bf16 v[24:27], a[180:183], a[76:79], v[24:27]
    v_mfma_f32_16x16x32_bf16 v[40:43], a[176:179], a[80:83], v[40:43]
    ds_read_b128 a[24:27], v193 offset:3072
    v_mfma_f32_16x16x32_bf16 v[40:43], a[180:183], a[84:87], v[40:43]
    buffer_load_dwordx4 v195, s[80:83], s74 offen offset:1024  lds
    v_mfma_f32_16x16x32_bf16 v[56:59], a[176:179], a[88:91], v[56:59]
    v_mfma_f32_16x16x32_bf16 v[56:59], a[180:183], a[92:95], v[56:59]
    ds_read_b128 a[28:31], v193 offset:11264
    v_mfma_f32_16x16x32_bf16 v[60:63], a[184:187], a[88:91], v[60:63]
    v_mfma_f32_16x16x32_bf16 v[60:63], a[188:191], a[92:95], v[60:63]
    buffer_load_dwordx4 v196, s[80:83], s74 offen offset:2048  lds
    v_mfma_f32_16x16x32_bf16 v[44:47], a[184:187], a[80:83], v[44:47]
    v_mfma_f32_16x16x32_bf16 v[44:47], a[188:191], a[84:87], v[44:47]
    v_mfma_f32_16x16x32_bf16 v[28:31], a[184:187], a[72:75], v[28:31]
    v_mfma_f32_16x16x32_bf16 v[28:31], a[188:191], a[76:79], v[28:31]
    buffer_load_dwordx4 v197, s[80:83], s74 offen offset:3072  lds
    v_mfma_f32_16x16x32_bf16 v[12:15], a[184:187], a[64:67], v[12:15]
    v_mfma_f32_16x16x32_bf16 v[12:15], a[188:191], a[68:71], v[12:15]
    s_waitcnt vmcnt(16) lgkmcnt(0)
    s_barrier
    v_mfma_f32_16x16x32_bf16 v[0:3], v[100:103], a[0:3], v[0:3]
    s_add_u32 m0, s25, 0
    ds_read_b64_tr_b16 a[96:97], v202 offset:32768
    v_mfma_f32_16x16x32_bf16 v[0:3], v[104:107], a[4:7], v[0:3]
    buffer_load_dwordx4 v192, s[88:91], s12 offen offset:0 sc1 lds
    ds_read_b64_tr_b16 a[98:99], v202 offset:36864
    v_mfma_f32_16x16x32_bf16 v[16:19], v[100:103], a[8:11], v[16:19]
    ds_read_b64_tr_b16 a[100:101], v202 offset:40960
    v_mfma_f32_16x16x32_bf16 v[16:19], v[104:107], a[12:15], v[16:19]
    ds_read_b64_tr_b16 a[102:103], v202 offset:45056
    v_mfma_f32_16x16x32_bf16 v[32:35], v[100:103], a[16:19], v[32:35]
    ds_read_b64_tr_b16 a[104:105], v203 offset:32768
    v_mfma_f32_16x16x32_bf16 v[32:35], v[104:107], a[20:23], v[32:35]
    buffer_load_dwordx4 v192, s[88:91], s12 offen offset:1024 sc1 lds
    ds_read_b64_tr_b16 a[106:107], v203 offset:36864
    v_mfma_f32_16x16x32_bf16 v[48:51], v[100:103], a[24:27], v[48:51]
    ds_read_b64_tr_b16 a[108:109], v203 offset:40960
    v_mfma_f32_16x16x32_bf16 v[48:51], v[104:107], a[28:31], v[48:51]
    ds_read_b64_tr_b16 a[110:111], v203 offset:45056
    v_mfma_f32_16x16x32_bf16 v[52:55], v[108:111], a[24:27], v[52:55]
    v_mfma_f32_16x16x32_bf16 v[52:55], v[112:115], a[28:31], v[52:55]
    buffer_load_dwordx4 v192, s[88:91], s12 offen offset:2048 sc1 lds
    ds_read_b64_tr_b16 a[112:113], v204 offset:32768
    v_mfma_f32_16x16x32_bf16 v[36:39], v[108:111], a[16:19], v[36:39]
    ds_read_b64_tr_b16 a[114:115], v204 offset:36864
    v_mfma_f32_16x16x32_bf16 v[36:39], v[112:115], a[20:23], v[36:39]
    ds_read_b64_tr_b16 a[116:117], v204 offset:40960
    v_mfma_f32_16x16x32_bf16 v[20:23], v[108:111], a[8:11], v[20:23]
    ds_read_b64_tr_b16 a[118:119], v204 offset:45056
    v_mfma_f32_16x16x32_bf16 v[20:23], v[112:115], a[12:15], v[20:23]
    buffer_load_dwordx4 v192, s[88:91], s12 offen offset:3072 sc1 lds
    ds_read_b64_tr_b16 a[120:121], v205 offset:32768
    v_mfma_f32_16x16x32_bf16 v[4:7], v[108:111], a[0:3], v[4:7]
    ds_read_b64_tr_b16 a[122:123], v205 offset:36864
    v_mfma_f32_16x16x32_bf16 v[4:7], v[112:115], a[4:7], v[4:7]
    ds_read_b64_tr_b16 a[124:125], v205 offset:40960
    v_mfma_f32_16x16x32_bf16 v[8:11], v[116:119], a[0:3], v[8:11]
    s_add_u32 m0, s94, 65536
    ds_read_b64_tr_b16 a[126:127], v205 offset:45056
    v_mfma_f32_16x16x32_bf16 v[8:11], v[120:123], a[4:7], v[8:11]
    buffer_load_dwordx4 v194, s[80:83], s75 offen offset:0  lds
    v_mfma_f32_16x16x32_bf16 v[24:27], v[116:119], a[8:11], v[24:27]
    ds_read_b128 a[64:67], v193 offset:16384
    v_mfma_f32_16x16x32_bf16 v[24:27], v[120:123], a[12:15], v[24:27]
    ds_read_b128 a[68:71], v193 offset:24576
    v_mfma_f32_16x16x32_bf16 v[40:43], v[116:119], a[16:19], v[40:43]
    ds_read_b128 a[72:75], v193 offset:17408
    v_mfma_f32_16x16x32_bf16 v[40:43], v[120:123], a[20:23], v[40:43]
    buffer_load_dwordx4 v195, s[80:83], s75 offen offset:1024  lds
    ds_read_b128 a[76:79], v193 offset:25600
    v_mfma_f32_16x16x32_bf16 v[56:59], v[116:119], a[24:27], v[56:59]
    ds_read_b128 a[80:83], v193 offset:18432
    v_mfma_f32_16x16x32_bf16 v[56:59], v[120:123], a[28:31], v[56:59]
    ds_read_b128 a[84:87], v193 offset:26624
    v_mfma_f32_16x16x32_bf16 v[60:63], v[124:127], a[24:27], v[60:63]
    ds_read_b128 a[88:91], v193 offset:19456
    v_mfma_f32_16x16x32_bf16 v[60:63], v[128:131], a[28:31], v[60:63]
    buffer_load_dwordx4 v196, s[80:83], s75 offen offset:2048  lds
    ds_read_b128 a[92:95], v193 offset:27648
    v_mfma_f32_16x16x32_bf16 v[44:47], v[124:127], a[16:19], v[44:47]
    v_mfma_f32_16x16x32_bf16 v[44:47], v[128:131], a[20:23], v[44:47]
    v_mfma_f32_16x16x32_bf16 v[28:31], v[124:127], a[8:11], v[28:31]
    v_mfma_f32_16x16x32_bf16 v[28:31], v[128:131], a[12:15], v[28:31]
    buffer_load_dwordx4 v197, s[80:83], s75 offen offset:3072  lds
    v_mfma_f32_16x16x32_bf16 v[12:15], v[124:127], a[0:3], v[12:15]
    v_mfma_f32_16x16x32_bf16 v[12:15], v[128:131], a[4:7], v[12:15]
    s_waitcnt vmcnt(20) lgkmcnt(0)
    s_barrier
    v_mfma_f32_16x16x32_bf16 v[0:3], a[96:99], a[64:67], v[0:3]
    s_add_u32 m0, s25, 16384
    ds_read_b64_tr_b16 a[32:33], v198 offset:0
    v_mfma_f32_16x16x32_bf16 v[0:3], a[100:103], a[68:71], v[0:3]
    buffer_load_dwordx4 v192, s[88:91], s13 offen offset:0 sc1 lds
    ds_read_b64_tr_b16 a[34:35], v198 offset:4096
    v_mfma_f32_16x16x32_bf16 v[16:19], a[96:99], a[72:75], v[16:19]
    ds_read_b64_tr_b16 a[36:37], v198 offset:8192
    v_mfma_f32_16x16x32_bf16 v[16:19], a[100:103], a[76:79], v[16:19]
    ds_read_b64_tr_b16 a[38:39], v198 offset:12288
    v_mfma_f32_16x16x32_bf16 v[32:35], a[96:99], a[80:83], v[32:35]
    ds_read_b64_tr_b16 a[40:41], v199 offset:0
    v_mfma_f32_16x16x32_bf16 v[32:35], a[100:103], a[84:87], v[32:35]
    buffer_load_dwordx4 v192, s[88:91], s13 offen offset:1024 sc1 lds
    ds_read_b64_tr_b16 a[42:43], v199 offset:4096
    v_mfma_f32_16x16x32_bf16 v[48:51], a[96:99], a[88:91], v[48:51]
    ds_read_b64_tr_b16 a[44:45], v199 offset:8192
    v_mfma_f32_16x16x32_bf16 v[48:51], a[100:103], a[92:95], v[48:51]
    ds_read_b64_tr_b16 a[46:47], v199 offset:12288
    v_mfma_f32_16x16x32_bf16 v[52:55], a[104:107], a[88:91], v[52:55]
    v_mfma_f32_16x16x32_bf16 v[52:55], a[108:111], a[92:95], v[52:55]
    buffer_load_dwordx4 v192, s[88:91], s13 offen offset:2048 sc1 lds
    ds_read_b64_tr_b16 a[48:49], v200 offset:0
    v_mfma_f32_16x16x32_bf16 v[36:39], a[104:107], a[80:83], v[36:39]
    ds_read_b64_tr_b16 a[50:51], v200 offset:4096
    v_mfma_f32_16x16x32_bf16 v[36:39], a[108:111], a[84:87], v[36:39]
    ds_read_b64_tr_b16 a[52:53], v200 offset:8192
    v_mfma_f32_16x16x32_bf16 v[20:23], a[104:107], a[72:75], v[20:23]
    ds_read_b64_tr_b16 a[54:55], v200 offset:12288
    v_mfma_f32_16x16x32_bf16 v[20:23], a[108:111], a[76:79], v[20:23]
    buffer_load_dwordx4 v192, s[88:91], s13 offen offset:3072 sc1 lds
    ds_read_b64_tr_b16 a[56:57], v201 offset:0
    v_mfma_f32_16x16x32_bf16 v[4:7], a[104:107], a[64:67], v[4:7]
    ds_read_b64_tr_b16 a[58:59], v201 offset:4096
    v_mfma_f32_16x16x32_bf16 v[4:7], a[108:111], a[68:71], v[4:7]
    ds_read_b64_tr_b16 a[60:61], v201 offset:8192
    v_mfma_f32_16x16x32_bf16 v[8:11], a[112:115], a[64:67], v[8:11]
    s_add_u32 m0, s94, 81920
    ds_read_b64_tr_b16 a[62:63], v201 offset:12288
    v_mfma_f32_16x16x32_bf16 v[8:11], a[116:119], a[68:71], v[8:11]
    buffer_load_dwordx4 v194, s[80:83], s76 offen offset:0  lds
    v_mfma_f32_16x16x32_bf16 v[24:27], a[112:115], a[72:75], v[24:27]
    ds_read_b128 a[0:3], v193 offset:32768
    v_mfma_f32_16x16x32_bf16 v[24:27], a[116:119], a[76:79], v[24:27]
    ds_read_b128 a[4:7], v193 offset:40960
    v_mfma_f32_16x16x32_bf16 v[40:43], a[112:115], a[80:83], v[40:43]
    ds_read_b128 a[8:11], v193 offset:33792
    v_mfma_f32_16x16x32_bf16 v[40:43], a[116:119], a[84:87], v[40:43]
    buffer_load_dwordx4 v195, s[80:83], s76 offen offset:1024  lds
    ds_read_b128 a[12:15], v193 offset:41984
    v_mfma_f32_16x16x32_bf16 v[56:59], a[112:115], a[88:91], v[56:59]
    ds_read_b128 a[16:19], v193 offset:34816
    v_mfma_f32_16x16x32_bf16 v[56:59], a[116:119], a[92:95], v[56:59]
    ds_read_b128 a[20:23], v193 offset:43008
    v_mfma_f32_16x16x32_bf16 v[60:63], a[120:123], a[88:91], v[60:63]
    ds_read_b128 a[24:27], v193 offset:35840
    v_mfma_f32_16x16x32_bf16 v[60:63], a[124:127], a[92:95], v[60:63]
    buffer_load_dwordx4 v196, s[80:83], s76 offen offset:2048  lds
    ds_read_b128 a[28:31], v193 offset:44032
    v_mfma_f32_16x16x32_bf16 v[44:47], a[120:123], a[80:83], v[44:47]
    v_mfma_f32_16x16x32_bf16 v[44:47], a[124:127], a[84:87], v[44:47]
    v_mfma_f32_16x16x32_bf16 v[28:31], a[120:123], a[72:75], v[28:31]
    v_mfma_f32_16x16x32_bf16 v[28:31], a[124:127], a[76:79], v[28:31]
    buffer_load_dwordx4 v197, s[80:83], s76 offen offset:3072  lds
    v_mfma_f32_16x16x32_bf16 v[12:15], a[120:123], a[64:67], v[12:15]
    v_mfma_f32_16x16x32_bf16 v[12:15], a[124:127], a[68:71], v[12:15]
    s_waitcnt vmcnt(20) lgkmcnt(0)
    s_barrier
    v_mfma_f32_16x16x32_bf16 v[0:3], a[32:35], a[0:3], v[0:3]
    s_add_u32 m0, s25, 32768
    ds_read_b64_tr_b16 a[96:97], v198 offset:16384
    v_mfma_f32_16x16x32_bf16 v[0:3], a[36:39], a[4:7], v[0:3]
    buffer_load_dwordx4 v192, s[88:91], s14 offen offset:0 sc1 lds
    ds_read_b64_tr_b16 a[98:99], v198 offset:20480
    v_mfma_f32_16x16x32_bf16 v[16:19], a[32:35], a[8:11], v[16:19]
    ds_read_b64_tr_b16 a[100:101], v198 offset:24576
    v_mfma_f32_16x16x32_bf16 v[16:19], a[36:39], a[12:15], v[16:19]
    ds_read_b64_tr_b16 a[102:103], v198 offset:28672
    v_mfma_f32_16x16x32_bf16 v[32:35], a[32:35], a[16:19], v[32:35]
    ds_read_b64_tr_b16 a[104:105], v199 offset:16384
    v_mfma_f32_16x16x32_bf16 v[32:35], a[36:39], a[20:23], v[32:35]
    buffer_load_dwordx4 v192, s[88:91], s14 offen offset:1024 sc1 lds
    ds_read_b64_tr_b16 a[106:107], v199 offset:20480
    v_mfma_f32_16x16x32_bf16 v[48:51], a[32:35], a[24:27], v[48:51]
    ds_read_b64_tr_b16 a[108:109], v199 offset:24576
    v_mfma_f32_16x16x32_bf16 v[48:51], a[36:39], a[28:31], v[48:51]
    ds_read_b64_tr_b16 a[110:111], v199 offset:28672
    v_mfma_f32_16x16x32_bf16 v[52:55], a[40:43], a[24:27], v[52:55]
    v_mfma_f32_16x16x32_bf16 v[52:55], a[44:47], a[28:31], v[52:55]
    buffer_load_dwordx4 v192, s[88:91], s14 offen offset:2048 sc1 lds
    ds_read_b64_tr_b16 a[112:113], v200 offset:16384
    v_mfma_f32_16x16x32_bf16 v[36:39], a[40:43], a[16:19], v[36:39]
    ds_read_b64_tr_b16 a[114:115], v200 offset:20480
    v_mfma_f32_16x16x32_bf16 v[36:39], a[44:47], a[20:23], v[36:39]
    ds_read_b64_tr_b16 a[116:117], v200 offset:24576
    v_mfma_f32_16x16x32_bf16 v[20:23], a[40:43], a[8:11], v[20:23]
    ds_read_b64_tr_b16 a[118:119], v200 offset:28672
    v_mfma_f32_16x16x32_bf16 v[20:23], a[44:47], a[12:15], v[20:23]
    buffer_load_dwordx4 v192, s[88:91], s14 offen offset:3072 sc1 lds
    ds_read_b64_tr_b16 a[120:121], v201 offset:16384
    v_mfma_f32_16x16x32_bf16 v[4:7], a[40:43], a[0:3], v[4:7]
    ds_read_b64_tr_b16 a[122:123], v201 offset:20480
    v_mfma_f32_16x16x32_bf16 v[4:7], a[44:47], a[4:7], v[4:7]
    ds_read_b64_tr_b16 a[124:125], v201 offset:24576
    v_mfma_f32_16x16x32_bf16 v[8:11], a[48:51], a[0:3], v[8:11]
    s_add_u32 m0, s94, 0
    ds_read_b64_tr_b16 a[126:127], v201 offset:28672
    v_mfma_f32_16x16x32_bf16 v[8:11], a[52:55], a[4:7], v[8:11]
    buffer_load_dwordx4 v194, s[80:83], s77 offen offset:0  lds
    v_mfma_f32_16x16x32_bf16 v[24:27], a[48:51], a[8:11], v[24:27]
    ds_read_b128 a[64:67], v193 offset:49152
    v_mfma_f32_16x16x32_bf16 v[24:27], a[52:55], a[12:15], v[24:27]
    ds_read_b128 a[68:71], v193 offset:57344
    v_mfma_f32_16x16x32_bf16 v[40:43], a[48:51], a[16:19], v[40:43]
    ds_read_b128 a[72:75], v193 offset:50176
    v_mfma_f32_16x16x32_bf16 v[40:43], a[52:55], a[20:23], v[40:43]
    buffer_load_dwordx4 v195, s[80:83], s77 offen offset:1024  lds
    ds_read_b128 a[76:79], v193 offset:58368
    v_mfma_f32_16x16x32_bf16 v[56:59], a[48:51], a[24:27], v[56:59]
    ds_read_b128 a[80:83], v193 offset:51200
    v_mfma_f32_16x16x32_bf16 v[56:59], a[52:55], a[28:31], v[56:59]
    ds_read_b128 a[84:87], v193 offset:59392
    v_mfma_f32_16x16x32_bf16 v[60:63], a[56:59], a[24:27], v[60:63]
    ds_read_b128 a[88:91], v193 offset:52224
    v_mfma_f32_16x16x32_bf16 v[60:63], a[60:63], a[28:31], v[60:63]
    buffer_load_dwordx4 v196, s[80:83], s77 offen offset:2048  lds
    ds_read_b128 a[92:95], v193 offset:60416
    v_mfma_f32_16x16x32_bf16 v[44:47], a[56:59], a[16:19], v[44:47]
    v_mfma_f32_16x16x32_bf16 v[44:47], a[60:63], a[20:23], v[44:47]
    v_mfma_f32_16x16x32_bf16 v[28:31], a[56:59], a[8:11], v[28:31]
    v_mfma_f32_16x16x32_bf16 v[28:31], a[60:63], a[12:15], v[28:31]
    buffer_load_dwordx4 v197, s[80:83], s77 offen offset:3072  lds
    v_mfma_f32_16x16x32_bf16 v[12:15], a[56:59], a[0:3], v[12:15]
    v_mfma_f32_16x16x32_bf16 v[12:15], a[60:63], a[4:7], v[12:15]
    s_waitcnt vmcnt(20) lgkmcnt(0)
    s_barrier
    v_mfma_f32_16x16x32_bf16 v[0:3], a[96:99], a[64:67], v[0:3]
L_pg8:
    s_cbranch_execz L_back2
    s_add_u32 m0, s25, 49152
    ds_read_b64_tr_b16 a[32:33], v198 offset:32768
    v_mfma_f32_16x16x32_bf16 v[0:3], a[100:103], a[68:71], v[0:3]
    buffer_load_dwordx4 v192, s[88:91], s15 offen offset:0 sc1 lds
    ds_read_b64_tr_b16 a[34:35], v198 offset:36864
    v_mfma_f32_16x16x32_bf16 v[16:19], a[96:99], a[72:75], v[16:19]
    ds_read_b64_tr_b16 a[36:37], v198 offset:40960
    v_mfma_f32_16x16x32_bf16 v[16:19], a[100:103], a[76:79], v[16:19]
    ds_read_b64_tr_b16 a[38:39], v198 offset:45056
    v_mfma_f32_16x16x32_bf16 v[32:35], a[96:99], a[80:83], v[32:35]
    ds_read_b64_tr_b16 a[40:41], v199 offset:32768
    v_mfma_f32_16x16x32_bf16 v[32:35], a[100:103], a[84:87], v[32:35]
    buffer_load_dwordx4 v192, s[88:91], s15 offen offset:1024 sc1 lds
    ds_read_b64_tr_b16 a[42:43], v199 offset:36864
    v_mfma_f32_16x16x32_bf16 v[48:51], a[96:99], a[88:91], v[48:51]
    ds_read_b64_tr_b16 a[44:45], v199 offset:40960
    v_mfma_f32_16x16x32_bf16 v[48:51], a[100:103], a[92:95], v[48:51]
    ds_read_b64_tr_b16 a[46:47], v199 offset:45056
    v_mfma_f32_16x16x32_bf16 v[52:55], a[104:107], a[88:91], v[52:55]
    v_mfma_f32_16x16x32_bf16 v[52:55], a[108:111], a[92:95], v[52:55]
    buffer_load_dwordx4 v192, s[88:91], s15 offen offset:2048 sc1 lds
    ds_read_b64_tr_b16 a[48:49], v200 offset:32768
    v_mfma_f32_16x16x32_bf16 v[36:39], a[104:107], a[80:83], v[36:39]
    ds_read_b64_tr_b16 a[50:51], v200 offset:36864
    v_mfma_f32_16x16x32_bf16 v[36:39], a[108:111], a[84:87], v[36:39]
    ds_read_b64_tr_b16 a[52:53], v200 offset:40960
    v_mfma_f32_16x16x32_bf16 v[20:23], a[104:107], a[72:75], v[20:23]
    ds_read_b64_tr_b16 a[54:55], v200 offset:45056
    v_mfma_f32_16x16x32_bf16 v[20:23], a[108:111], a[76:79], v[20:23]
    buffer_load_dwordx4 v192, s[88:91], s15 offen offset:3072 sc1 lds
    ds_read_b64_tr_b16 a[56:57], v201 offset:32768
    v_mfma_f32_16x16x32_bf16 v[4:7], a[104:107], a[64:67], v[4:7]
    ds_read_b64_tr_b16 a[58:59], v201 offset:36864
    v_mfma_f32_16x16x32_bf16 v[4:7], a[108:111], a[68:71], v[4:7]
    ds_read_b64_tr_b16 a[60:61], v201 offset:40960
    v_mfma_f32_16x16x32_bf16 v[8:11], a[112:115], a[64:67], v[8:11]
    s_add_u32 m0, s94, 16384
    ds_read_b64_tr_b16 a[62:63], v201 offset:45056
    v_mfma_f32_16x16x32_bf16 v[8:11], a[116:119], a[68:71], v[8:11]
    buffer_load_dwordx4 v194, s[80:83], s78 offen offset:0  lds
    v_mfma_f32_16x16x32_bf16 v[24:27], a[112:115], a[72:75], v[24:27]
    ds_read_b128 a[0:3], v193 offset:0
    v_mfma_f32_16x16x32_bf16 v[24:27], a[116:119], a[76:79], v[24:27]
    ds_read_b128 a[4:7], v193 offset:8192
    v_mfma_f32_16x16x32_bf16 v[40:43], a[112:115], a[80:83], v[40:43]
    ds_read_b128 a[8:11], v193 offset:1024
    v_mfma_f32_16x16x32_bf16 v[40:43], a[116:119], a[84:87], v[40:43]
    buffer_load_dwordx4 v195, s[80:83], s78 offen offset:1024  lds
    ds_read_b128 a[12:15], v193 offset:9216
    v_mfma_f32_16x16x32_bf16 v[56:59], a[112:115], a[88:91], v[56:59]
    ds_read_b128 a[16:19], v193 offset:2048
    v_mfma_f32_16x16x32_bf16 v[56:59], a[116:119], a[92:95], v[56:59]
    ds_read_b128 a[20:23], v193 offset:10240
    v_mfma_f32_16x16x32_bf16 v[60:63], a[120:123], a[88:91], v[60:63]
    ds_read_b128 a[24:27], v193 offset:3072
    v_mfma_f32_16x16x32_bf16 v[60:63], a[124:127], a[92:95], v[60:63]
    buffer_load_dwordx4 v196, s[80:83], s78 offen offset:2048  lds
    ds_read_b128 a[28:31], v193 offset:11264
    v_mfma_f32_16x16x32_bf16 v[44:47], a[120:123], a[80:83], v[44:47]
    v_mfma_f32_16x16x32_bf16 v[44:47], a[124:127], a[84:87], v[44:47]
    v_mfma_f32_16x16x32_bf16 v[28:31], a[120:123], a[72:75], v[28:31]
    v_mfma_f32_16x16x32_bf16 v[28:31], a[124:127], a[76:79], v[28:31]
    buffer_load_dwordx4 v197, s[80:83], s78 offen offset:3072  lds
    v_mfma_f32_16x16x32_bf16 v[12:15], a[120:123], a[64:67], v[12:15]
    v_mfma_f32_16x16x32_bf16 v[12:15], a[124:127], a[68:71], v[12:15]
    s_waitcnt vmcnt(20) lgkmcnt(0)
    s_barrier
    v_mfma_f32_16x16x32_bf16 v[0:3], a[32:35], a[0:3], v[0:3]
    s_add_u32 m0, s25, 0
    ds_read_b64_tr_b16 a[96:97], v202 offset:0
    v_mfma_f32_16x16x32_bf16 v[0:3], a[36:39], a[4:7], v[0:3]
    buffer_load_dwordx4 v192, s[88:91], s64 offen offset:0 sc1 lds
    ds_read_b64_tr_b16 a[98:99], v202 offset:4096
    v_mfma_f32_16x16x32_bf16 v[16:19], a[32:35], a[8:11], v[16:19]
    ds_read_b64_tr_b16 a[100:101], v202 offset:8192
    v_mfma_f32_16x16x32_bf16 v[16:19], a[36:39], a[12:15], v[16:19]
    ds_read_b64_tr_b16 a[102:103], v202 offset:12288
    v_mfma_f32_16x16x32_bf16 v[32:35], a[32:35], a[16:19], v[32:35]
    ds_read_b64_tr_b16 a[104:105], v203 offset:0
    v_mfma_f32_16x16x32_bf16 v[32:35], a[36:39], a[20:23], v[32:35]
    buffer_load_dwordx4 v192, s[88:91], s64 offen offset:1024 sc1 lds
    ds_read_b64_tr_b16 a[106:107], v203 offset:4096
    v_mfma_f32_16x16x32_bf16 v[48:51], a[32:35], a[24:27], v[48:51]
    ds_read_b64_tr_b16 a[108:109], v203 offset:8192
    v_mfma_f32_16x16x32_bf16 v[48:51], a[36:39], a[28:31], v[48:51]
    ds_read_b64_tr_b16 a[110:111], v203 offset:12288
    v_mfma_f32_16x16x32_bf16 v[52:55], a[40:43], a[24:27], v[52:55]
    v_mfma_f32_16x16x32_bf16 v[52:55], a[44:47], a[28:31], v[52:55]
    buffer_load_dwordx4 v192, s[88:91], s64 offen offset:2048 sc1 lds
    ds_read_b64_tr_b16 a[112:113], v204 offset:0
    v_mfma_f32_16x16x32_bf16 v[36:39], a[40:43], a[16:19], v[36:39]
    ds_read_b64_tr_b16 a[114:115], v204 offset:4096
    v_mfma_f32_16x16x32_bf16 v[36:39], a[44:47], a[20:23], v[36:39]
    ds_read_b64_tr_b16 a[116:117], v204 offset:8192
    v_mfma_f32_16x16x32_bf16 v[20:23], a[40:43], a[8:11], v[20:23]
    ds_read_b64_tr_b16 a[118:119], v204 offset:12288
    v_mfma_f32_16x16x32_bf16 v[20:23], a[44:47], a[12:15], v[20:23]
    buffer_load_dwordx4 v192, s[88:91], s64 offen offset:3072 sc1 lds
    ds_read_b64_tr_b16 a[120:121], v205 offset:0
    v_mfma_f32_16x16x32_bf16 v[4:7], a[40:43], a[0:3], v[4:7]
    ds_read_b64_tr_b16 a[122:123], v205 offset:4096
    v_mfma_f32_16x16x32_bf16 v[4:7], a[44:47], a[4:7], v[4:7]
    ds_read_b64_tr_b16 a[124:125], v205 offset:8192
    v_mfma_f32_16x16x32_bf16 v[8:11], a[48:51], a[0:3], v[8:11]
    s_add_u32 m0, s94, 32768
    ds_read_b64_tr_b16 a[126:127], v205 offset:12288
    v_mfma_f32_16x16x32_bf16 v[8:11], a[52:55], a[4:7], v[8:11]
    buffer_load_dwordx4 v194, s[80:83], s79 offen offset:0  lds
    v_mfma_f32_16x16x32_bf16 v[24:27], a[48:51], a[8:11], v[24:27]
    ds_read_b128 a[64:67], v193 offset:16384
    v_mfma_f32_16x16x32_bf16 v[24:27], a[52:55], a[12:15], v[24:27]
    ds_read_b128 a[68:71], v193 offset:24576
    v_mfma_f32_16x16x32_bf16 v[40:43], a[48:51], a[16:19], v[40:43]
    ds_read_b128 a[72:75], v193 offset:17408
    v_mfma_f32_16x16x32_bf16 v[40:43], a[52:55], a[20:23], v[40:43]
    buffer_load_dwordx4 v195, s[80:83], s79 offen offset:1024  lds
    ds_read_b128 a[76:79], v193 offset:25600
    v_mfma_f32_16x16x32_bf16 v[56:59], a[48:51], a[24:27], v[56:59]
    ds_read_b128 a[80:83], v193 offset:18432
    v_mfma_f32_16x16x32_bf16 v[56:59], a[52:55], a[28:31], v[56:59]
    ds_read_b128 a[84:87], v193 offset:26624
    v_mfma_f32_16x16x32_bf16 v[60:63], a[56:59], a[24:27], v[60:63]
    ds_read_b128 a[88:91], v193 offset:19456
    v_mfma_f32_16x16x32_bf16 v[60:63], a[60:63], a[28:31], v[60:63]
    buffer_load_dwordx4 v196, s[80:83], s79 offen offset:2048  lds
    ds_read_b128 a[92:95], v193 offset:27648
    v_mfma_f32_16x16x32_bf16 v[44:47], a[56:59], a[16:19], v[44:47]
    v_mfma_f32_16x16x32_bf16 v[44:47], a[60:63], a[20:23], v[44:47]
    v_mfma_f32_16x16x32_bf16 v[28:31], a[56:59], a[8:11], v[28:31]
    v_mfma_f32_16x16x32_bf16 v[28:31], a[60:63], a[12:15], v[28:31]
    buffer_load_dwordx4 v197, s[80:83], s79 offen offset:3072  lds
    v_mfma_f32_16x16x32_bf16 v[12:15], a[56:59], a[0:3], v[12:15]
    v_mfma_f32_16x16x32_bf16 v[12:15], a[60:63], a[4:7], v[12:15]
    s_waitcnt vmcnt(20) lgkmcnt(0)
    s_barrier
    v_mfma_f32_16x16x32_bf16 v[0:3], a[96:99], a[64:67], v[0:3]
    s_add_u32 m0, s25, 16384
    ds_read_b64_tr_b16 a[32:33], v202 offset:16384
    v_mfma_f32_16x16x32_bf16 v[0:3], a[100:103], a[68:71], v[0:3]
    buffer_load_dwordx4 v192, s[88:91], s65 offen offset:0 sc1 lds
    ds_read_b64_tr_b16 a[34:35], v202 offset:20480
    v_mfma_f32_16x16x32_bf16 v[16:19], a[96:99], a[72:75], v[16:19]
    ds_read_b64_tr_b16 a[36:37], v202 offset:24576
    v_mfma_f32_16x16x32_bf16 v[16:19], a[100:103], a[76:79], v[16:19]
    ds_read_b64_tr_b16 a[38:39], v202 offset:28672
    v_mfma_f32_16x16x32_bf16 v[32:35], a[96:99], a[80:83], v[32:35]
    ds_read_b64_tr_b16 a[40:41], v203 offset:16384
    v_mfma_f32_16x16x32_bf16 v[32:35], a[100:103], a[84:87], v[32:35]
    buffer_load_dwordx4 v192, s[88:91], s65 offen offset:1024 sc1 lds
    ds_read_b64_tr_b16 a[42:43], v203 offset:20480
    v_mfma_f32_16x16x32_bf16 v[48:51], a[96:99], a[88:91], v[48:51]
    ds_read_b64_tr_b16 a[44:45], v203 offset:24576
    v_mfma_f32_16x16x32_bf16 v[48:51], a[100:103], a[92:95], v[48:51]
    ds_read_b64_tr_b16 a[46:47], v203 offset:28672
    v_mfma_f32_16x16x32_bf16 v[52:55], a[104:107], a[88:91], v[52:55]
    v_mfma_f32_16x16x32_bf16 v[52:55], a[108:111], a[92:95], v[52:55]
    buffer_load_dwordx4 v192, s[88:91], s65 offen offset:2048 sc1 lds
    ds_read_b64_tr_b16 a[48:49], v204 offset:16384
    v_mfma_f32_16x16x32_bf16 v[36:39], a[104:107], a[80:83], v[36:39]
    ds_read_b64_tr_b16 a[50:51], v204 offset:20480
    v_mfma_f32_16x16x32_bf16 v[36:39], a[108:111], a[84:87], v[36:39]
    ds_read_b64_tr_b16 a[52:53], v204 offset:24576
    v_mfma_f32_16x16x32_bf16 v[20:23], a[104:107], a[72:75], v[20:23]
    ds_read_b64_tr_b16 a[54:55], v204 offset:28672
    v_mfma_f32_16x16x32_bf16 v[20:23], a[108:111], a[76:79], v[20:23]
    buffer_load_dwordx4 v192, s[88:91], s65 offen offset:3072 sc1 lds
    ds_read_b64_tr_b16 a[56:57], v205 offset:16384
    v_mfma_f32_16x16x32_bf16 v[4:7], a[104:107], a[64:67], v[4:7]
    ds_read_b64_tr_b16 a[58:59], v205 offset:20480
    v_mfma_f32_16x16x32_bf16 v[4:7], a[108:111], a[68:71], v[4:7]
    ds_read_b64_tr_b16 a[60:61], v205 offset:24576
    v_mfma_f32_16x16x32_bf16 v[8:11], a[112:115], a[64:67], v[8:11]
    s_add_u32 m0, s94, 49152
    ds_read_b64_tr_b16 a[62:63], v205 offset:28672
    v_mfma_f32_16x16x32_bf16 v[8:11], a[116:119], a[68:71], v[8:11]
    buffer_load_dwordx4 v194, s[80:83], s41 offen offset:0  lds
    v_mfma_f32_16x16x32_bf16 v[24:27], a[112:115], a[72:75], v[24:27]
    ds_read_b128 a[0:3], v193 offset:32768
    v_mfma_f32_16x16x32_bf16 v[24:27], a[116:119], a[76:79], v[24:27]
    ds_read_b128 a[4:7], v193 offset:40960
    v_mfma_f32_16x16x32_bf16 v[40:43], a[112:115], a[80:83], v[40:43]
    ds_read_b128 a[8:11], v193 offset:33792
    v_mfma_f32_16x16x32_bf16 v[40:43], a[116:119], a[84:87], v[40:43]
    buffer_load_dwordx4 v195, s[80:83], s41 offen offset:1024  lds
    ds_read_b128 a[12:15], v193 offset:41984
    v_mfma_f32_16x16x32_bf16 v[56:59], a[112:115], a[88:91], v[56:59]
    ds_read_b128 a[16:19], v193 offset:34816
    v_mfma_f32_16x16x32_bf16 v[56:59], a[116:119], a[92:95], v[56:59]
    ds_read_b128 a[20:23], v193 offset:43008
    v_mfma_f32_16x16x32_bf16 v[60:63], a[120:123], a[88:91], v[60:63]
    ds_read_b128 a[24:27], v193 offset:35840
    v_mfma_f32_16x16x32_bf16 v[60:63], a[124:127], a[92:95], v[60:63]
    buffer_load_dwordx4 v196, s[80:83], s41 offen offset:2048  lds
    ds_read_b128 a[28:31], v193 offset:44032
    v_mfma_f32_16x16x32_bf16 v[44:47], a[120:123], a[80:83], v[44:47]
    v_mfma_f32_16x16x32_bf16 v[44:47], a[124:127], a[84:87], v[44:47]
    v_mfma_f32_16x16x32_bf16 v[28:31], a[120:123], a[72:75], v[28:31]
    v_mfma_f32_16x16x32_bf16 v[28:31], a[124:127], a[76:79], v[28:31]
    buffer_load_dwordx4 v197, s[80:83], s41 offen offset:3072  lds
    v_mfma_f32_16x16x32_bf16 v[12:15], a[120:123], a[64:67], v[12:15]
    v_mfma_f32_16x16x32_bf16 v[12:15], a[124:127], a[68:71], v[12:15]
    s_waitcnt vmcnt(20) lgkmcnt(0)
    s_barrier
    v_mfma_f32_16x16x32_bf16 v[0:3], a[32:35], a[0:3], v[0:3]
    s_add_u32 m0, s25, 32768
    ds_read_b64_tr_b16 a[96:97], v202 offset:32768
    v_mfma_f32_16x16x32_bf16 v[0:3], a[36:39], a[4:7], v[0:3]
    buffer_load_dwordx4 v192, s[88:91], s66 offen offset:0 sc1 lds
    ds_read_b64_tr_b16 a[98:99], v202 offset:36864
    v_mfma_f32_16x16x32_bf16 v[16:19], a[32:35], a[8:11], v[16:19]
    ds_read_b64_tr_b16 a[100:101], v202 offset:40960
    v_mfma_f32_16x16x32_bf16 v[16:19], a[36:39], a[12:15], v[16:19]
    ds_read_b64_tr_b16 a[102:103], v202 offset:45056
    v_mfma_f32_16x16x32_bf16 v[32:35], a[32:35], a[16:19], v[32:35]
    ds_read_b64_tr_b16 a[104:105], v203 offset:32768
    v_mfma_f32_16x16x32_bf16 v[32:35], a[36:39], a[20:23], v[32:35]
    buffer_load_dwordx4 v192, s[88:91], s66 offen offset:1024 sc1 lds
    ds_read_b64_tr_b16 a[106:107], v203 offset:36864
    v_mfma_f32_16x16x32_bf16 v[48:51], a[32:35], a[24:27], v[48:51]
    ds_read_b64_tr_b16 a[108:109], v203 offset:40960
    v_mfma_f32_16x16x32_bf16 v[48:51], a[36:39], a[28:31], v[48:51]
    ds_read_b64_tr_b16 a[110:111], v203 offset:45056
    v_mfma_f32_16x16x32_bf16 v[52:55], a[40:43], a[24:27], v[52:55]
    v_mfma_f32_16x16x32_bf16 v[52:55], a[44:47], a[28:31], v[52:55]
    buffer_load_dwordx4 v192, s[88:91], s66 offen offset:2048 sc1 lds
    ds_read_b64_tr_b16 a[112:113], v204 offset:32768
    v_mfma_f32_16x16x32_bf16 v[36:39], a[40:43], a[16:19], v[36:39]
    ds_read_b64_tr_b16 a[114:115], v204 offset:36864
    v_mfma_f32_16x16x32_bf16 v[36:39], a[44:47], a[20:23], v[36:39]
    ds_read_b64_tr_b16 a[116:117], v204 offset:40960
    v_mfma_f32_16x16x32_bf16 v[20:23], a[40:43], a[8:11], v[20:23]
    ds_read_b64_tr_b16 a[118:119], v204 offset:45056
    v_mfma_f32_16x16x32_bf16 v[20:23], a[44:47], a[12:15], v[20:23]
    buffer_load_dwordx4 v192, s[88:91], s66 offen offset:3072 sc1 lds
    ds_read_b64_tr_b16 a[120:121], v205 offset:32768
    v_mfma_f32_16x16x32_bf16 v[4:7], a[40:43], a[0:3], v[4:7]
    ds_read_b64_tr_b16 a[122:123], v205 offset:36864
    v_mfma_f32_16x16x32_bf16 v[4:7], a[44:47], a[4:7], v[4:7]
    ds_read_b64_tr_b16 a[124:125], v205 offset:40960
    v_mfma_f32_16x16x32_bf16 v[8:11], a[48:51], a[0:3], v[8:11]
    ds_read_b64_tr_b16 a[126:127], v205 offset:45056
    v_mfma_f32_16x16x32_bf16 v[8:11], a[52:55], a[4:7], v[8:11]
    v_mfma_f32_16x16x32_bf16 v[24:27], a[48:51], a[8:11], v[24:27]
    ds_read_b128 a[64:67], v193 offset:49152
    v_mfma_f32_16x16x32_bf16 v[24:27], a[52:55], a[12:15], v[24:27]
    ds_read_b128 a[68:71], v193 offset:57344
    v_mfma_f32_16x16x32_bf16 v[40:43], a[48:51], a[16:19], v[40:43]
    ds_read_b128 a[72:75], v193 offset:50176
    v_mfma_f32_16x16x32_bf16 v[40:43], a[52:55], a[20:23], v[40:43]
    ds_read_b128 a[76:79], v193 offset:58368
    v_mfma_f32_16x16x32_bf16 v[56:59], a[48:51], a[24:27], v[56:59]
    ds_read_b128 a[80:83], v193 offset:51200
    v_mfma_f32_16x16x32_bf16 v[56:59], a[52:55], a[28:31], v[56:59]
    ds_read_b128 a[84:87], v193 offset:59392
    v_mfma_f32_16x16x32_bf16 v[60:63], a[56:59], a[24:27], v[60:63]
    ds_read_b128 a[88:91], v193 offset:52224
    v_mfma_f32_16x16x32_bf16 v[60:63], a[60:63], a[28:31], v[60:63]
    ds_read_b128 a[92:95], v193 offset:60416
    v_mfma_f32_16x16x32_bf16 v[44:47], a[56:59], a[16:19], v[44:47]
    v_mfma_f32_16x16x32_bf16 v[44:47], a[60:63], a[20:23], v[44:47]
    v_mfma_f32_16x16x32_bf16 v[28:31], a[56:59], a[8:11], v[28:31]
    v_mfma_f32_16x16x32_bf16 v[28:31], a[60:63], a[12:15], v[28:31]
    v_mfma_f32_16x16x32_bf16 v[12:15], a[56:59], a[0:3], v[12:15]
    v_mfma_f32_16x16x32_bf16 v[12:15], a[60:63], a[4:7], v[12:15]
    s_waitcnt vmcnt(12) lgkmcnt(0)
    s_barrier
    v_mfma_f32_16x16x32_bf16 v[0:3], a[96:99], a[64:67], v[0:3]
    s_add_u32 m0, s25, 49152
    ds_read_b64_tr_b16 a[32:33], v198 offset:0
    ds_read_b64_tr_b16 a[34:35], v198 offset:4096
    v_mfma_f32_16x16x32_bf16 v[0:3], a[100:103], a[68:71], v[0:3]
    buffer_load_dwordx4 v192, s[88:91], s67 offen offset:0 sc1 lds
    ds_read_b64_tr_b16 a[36:37], v198 offset:8192
    v_mfma_f32_16x16x32_bf16 v[16:19], a[96:99], a[72:75], v[16:19]
    ds_read_b64_tr_b16 a[38:39], v198 offset:12288
    ds_read_b64_tr_b16 a[40:41], v199 offset:0
    v_mfma_f32_16x16x32_bf16 v[16:19], a[100:103], a[76:79], v[16:19]
    ds_read_b64_tr_b16 a[42:43], v199 offset:4096
    v_mfma_f32_16x16x32_bf16 v[32:35], a[96:99], a[80:83], v[32:35]
    ds_read_b64_tr_b16 a[44:45], v199 offset:8192
    ds_read_b64_tr_b16 a[46:47], v199 offset:12288
    v_mfma_f32_16x16x32_bf16 v[32:35], a[100:103], a[84:87], v[32:35]
    buffer_load_dwordx4 v192, s[88:91], s67 offen offset:1024 sc1 lds
    ds_read_b64_tr_b16 a[48:49], v200 offset:0
    v_mfma_f32_16x16x32_bf16 v[48:51], a[96:99], a[88:91], v[48:51]
    ds_read_b64_tr_b16 a[50:51], v200 offset:4096
    ds_read_b64_tr_b16 a[52:53], v200 offset:8192
    v_mfma_f32_16x16x32_bf16 v[48:51], a[100:103], a[92:95], v[48:51]
    ds_read_b64_tr_b16 a[54:55], v200 offset:12288
    v_mfma_f32_16x16x32_bf16 v[52:55], a[104:107], a[88:91], v[52:55]
    ds_read_b64_tr_b16 a[56:57], v201 offset:0
    ds_read_b64_tr_b16 a[58:59], v201 offset:4096
    v_mfma_f32_16x16x32_bf16 v[52:55], a[108:111], a[92:95], v[52:55]
    buffer_load_dwordx4 v192, s[88:91], s67 offen offset:2048 sc1 lds
    ds_read_b64_tr_b16 a[60:61], v201 offset:8192
    v_mfma_f32_16x16x32_bf16 v[36:39], a[104:107], a[80:83], v[36:39]
    ds_read_b64_tr_b16 a[62:63], v201 offset:12288
    ds_read_b128 a[0:3], v193 offset:0
    v_mfma_f32_16x16x32_bf16 v[36:39], a[108:111], a[84:87], v[36:39]
    ds_read_b128 a[4:7], v193 offset:8192
    v_mfma_f32_16x16x32_bf16 v[20:23], a[104:107], a[72:75], v[20:23]
    ds_read_b128 a[8:11], v193 offset:1024
    ds_read_b128 a[12:15], v193 offset:9216
    v_mfma_f32_16x16x32_bf16 v[20:23], a[108:111], a[76:79], v[20:23]
    buffer_load_dwordx4 v192, s[88:91], s67 offen offset:3072 sc1 lds
    ds_read_b128 a[16:19], v193 offset:2048
    v_mfma_f32_16x16x32_bf16 v[4:7], a[104:107], a[64:67], v[4:7]
    ds_read_b128 a[20:23], v193 offset:10240
    ds_read_b128 a[24:27], v193 offset:3072
    v_mfma_f32_16x16x32_bf16 v[4:7], a[108:111], a[68:71], v[4:7]
    ds_read_b128 a[28:31], v193 offset:11264
    v_mfma_f32_16x16x32_bf16 v[8:11], a[112:115], a[64:67], v[8:11]
    ds_read_b64_tr_b16 a[128:129], v198 offset:32768
    ds_read_b64_tr_b16 a[130:131], v198 offset:36864
    v_mfma_f32_16x16x32_bf16 v[8:11], a[116:119], a[68:71], v[8:11]
    ds_read_b64_tr_b16 a[132:133], v198 offset:40960
    v_mfma_f32_16x16x32_bf16 v[24:27], a[112:115], a[72:75], v[24:27]
    ds_read_b64_tr_b16 a[134:135], v198 offset:45056
    ds_read_b64_tr_b16 a[136:137], v199 offset:32768
    v_mfma_f32_16x16x32_bf16 v[24:27], a[116:119], a[76:79], v[24:27]
    ds_read_b64_tr_b16 a[138:139], v199 offset:36864
    v_mfma_f32_16x16x32_bf16 v[40:43], a[112:115], a[80:83], v[40:43]
    ds_read_b64_tr_b16 a[140:141], v199 offset:40960
    ds_read_b64_tr_b16 a[142:143], v199 offset:45056
    v_mfma_f32_16x16x32_bf16 v[40:43], a[116:119], a[84:87], v[40:43]
    ds_read_b64_tr_b16 a[144:145], v200 offset:32768
    v_mfma_f32_16x16x32_bf16 v[56:59], a[112:115], a[88:91], v[56:59]
    ds_read_b64_tr_b16 a[146:147], v200 offset:36864
    ds_read_b64_tr_b16 a[148:149], v200 offset:40960
    v_mfma_f32_16x16x32_bf16 v[56:59], a[116:119], a[92:95], v[56:59]
    ds_read_b64_tr_b16 a[150:151], v200 offset:45056
    v_mfma_f32_16x16x32_bf16 v[60:63], a[120:123], a[88:91], v[60:63]
    ds_read_b64_tr_b16 a[152:153], v201 offset:32768
    ds_read_b64_tr_b16 a[154:155], v201 offset:36864
    v_mfma_f32_16x16x32_bf16 v[60:63], a[124:127], a[92:95], v[60:63]
    ds_read_b64_tr_b16 a[156:157], v201 offset:40960
    v_mfma_f32_16x16x32_bf16 v[44:47], a[120:123], a[80:83], v[44:47]
    ds_read_b64_tr_b16 a[158:159], v201 offset:45056
    v_mfma_f32_16x16x32_bf16 v[44:47], a[124:127], a[84:87], v[44:47]
    v_mfma_f32_16x16x32_bf16 v[28:31], a[120:123], a[72:75], v[28:31]
    v_mfma_f32_16x16x32_bf16 v[28:31], a[124:127], a[76:79], v[28:31]
    v_mfma_f32_16x16x32_bf16 v[12:15], a[120:123], a[64:67], v[12:15]
    v_mfma_f32_16x16x32_bf16 v[12:15], a[124:127], a[68:71], v[12:15]
    s_waitcnt vmcnt(4) lgkmcnt(0)
    s_barrier
    v_mfma_f32_16x16x32_bf16 v[0:3], a[32:35], a[0:3], v[0:3]
    ds_read_b64_tr_b16 a[96:97], v198 offset:16384
    ds_read_b64_tr_b16 a[98:99], v198 offset:20480
    v_mfma_f32_16x16x32_bf16 v[0:3], a[36:39], a[4:7], v[0:3]
    ds_read_b64_tr_b16 a[100:101], v198 offset:24576
    v_mfma_f32_16x16x32_bf16 v[16:19], a[32:35], a[8:11], v[16:19]
    ds_read_b64_tr_b16 a[102:103], v198 offset:28672
    v_mfma_f32_16x16x32_bf16 v[16:19], a[36:39], a[12:15], v[16:19]
    ds_read_b64_tr_b16 a[104:105], v199 offset:16384
    ds_read_b64_tr_b16 a[106:107], v199 offset:20480
    v_mfma_f32_16x16x32_bf16 v[32:35], a[32:35], a[16:19], v[32:35]
    ds_read_b64_tr_b16 a[108:109], v199 offset:24576
    v_mfma_f32_16x16x32_bf16 v[32:35], a[36:39], a[20:23], v[32:35]
    ds_read_b64_tr_b16 a[110:111], v199 offset:28672
    v_mfma_f32_16x16x32_bf16 v[48:51], a[32:35], a[24:27], v[48:51]
    ds_read_b64_tr_b16 a[112:113], v200 offset:16384
    ds_read_b64_tr_b16 a[114:115], v200 offset:20480
    v_mfma_f32_16x16x32_bf16 v[48:51], a[36:39], a[28:31], v[48:51]
    ds_read_b64_tr_b16 a[116:117], v200 offset:24576
    v_mfma_f32_16x16x32_bf16 v[52:55], a[40:43], a[24:27], v[52:55]
    ds_read_b64_tr_b16 a[118:119], v200 offset:28672
    v_mfma_f32_16x16x32_bf16 v[52:55], a[44:47], a[28:31], v[52:55]
    ds_read_b64_tr_b16 a[120:121], v201 offset:16384
    ds_read_b64_tr_b16 a[122:123], v201 offset:20480
    v_mfma_f32_16x16x32_bf16 v[36:39], a[40:43], a[16:19], v[36:39]
    ds_read_b64_tr_b16 a[124:125], v201 offset:24576
    v_mfma_f32_16x16x32_bf16 v[36:39], a[44:47], a[20:23], v[36:39]
    ds_read_b64_tr_b16 a[126:127], v201 offset:28672
    v_mfma_f32_16x16x32_bf16 v[20:23], a[40:43], a[8:11], v[20:23]
    ds_read_b64_tr_b16 a[160:161], v202 offset:0
    ds_read_b64_tr_b16 a[162:163], v202 offset:4096
    v_mfma_f32_16x16x32_bf16 v[20:23], a[44:47], a[12:15], v[20:23]
    ds_read_b64_tr_b16 a[164:165], v202 offset:8192
    v_mfma_f32_16x16x32_bf16 v[4:7], a[40:43], a[0:3], v[4:7]
    ds_read_b64_tr_b16 a[166:167], v202 offset:12288
    v_mfma_f32_16x16x32_bf16 v[4:7], a[44:47], a[4:7], v[4:7]
    ds_read_b64_tr_b16 a[168:169], v203 offset:0
    ds_read_b64_tr_b16 a[170:171], v203 offset:4096
    v_mfma_f32_16x16x32_bf16 v[8:11], a[48:51], a[0:3], v[8:11]
    ds_read_b64_tr_b16 a[172:173], v203 offset:8192
    v_mfma_f32_16x16x32_bf16 v[8:11], a[52:55], a[4:7], v[8:11]
    ds_read_b64_tr_b16 a[174:175], v203 offset:12288
    v_mfma_f32_16x16x32_bf16 v[24:27], a[48:51], a[8:11], v[24:27]
    ds_read_b64_tr_b16 a[176:177], v204 offset:0
    ds_read_b64_tr_b16 a[178:179], v204 offset:4096
    v_mfma_f32_16x16x32_bf16 v[24:27], a[52:55], a[12:15], v[24:27]
    ds_read_b64_tr_b16 a[180:181], v204 offset:8192
    v_mfma_f32_16x16x32_bf16 v[40:43], a[48:51], a[16:19], v[40:43]
    ds_read_b64_tr_b16 a[182:183], v204 offset:12288
    v_mfma_f32_16x16x32_bf16 v[40:43], a[52:55], a[20:23], v[40:43]
    ds_read_b64_tr_b16 a[184:185], v205 offset:0
    ds_read_b64_tr_b16 a[186:187], v205 offset:4096
    v_mfma_f32_16x16x32_bf16 v[56:59], a[48:51], a[24:27], v[56:59]
    ds_read_b64_tr_b16 a[188:189], v205 offset:8192
    v_mfma_f32_16x16x32_bf16 v[56:59], a[52:55], a[28:31], v[56:59]
    ds_read_b64_tr_b16 a[190:191], v205 offset:12288
    v_mfma_f32_16x16x32_bf16 v[60:63], a[56:59], a[24:27], v[60:63]
    ds_read_b128 a[192:195], v193 offset:16384
    ds_read_b128 a[196:199], v193 offset:24576
    v_mfma_f32_16x16x32_bf16 v[60:63], a[60:63], a[28:31], v[60:63]
    ds_read_b128 a[200:203], v193 offset:32768
    v_mfma_f32_16x16x32_bf16 v[44:47], a[56:59], a[16:19], v[44:47]
    ds_read_b128 a[204:207], v193 offset:40960
    v_mfma_f32_16x16x32_bf16 v[44:47], a[60:63], a[20:23], v[44:47]
    v_mfma_f32_16x16x32_bf16 v[28:31], a[56:59], a[8:11], v[28:31]
    v_mfma_f32_16x16x32_bf16 v[28:31], a[60:63], a[12:15], v[28:31]
    v_mfma_f32_16x16x32_bf16 v[12:15], a[56:59], a[0:3], v[12:15]
    v_mfma_f32_16x16x32_bf16 v[12:15], a[60:63], a[4:7], v[12:15]
    s_waitcnt vmcnt(0) lgkmcnt(0)
    s_barrier
    v_mfma_f32_16x16x32_bf16 v[0:3], a[96:99], a[192:195], v[0:3]
    ds_read_b128 a[208:211], v193 offset:49152
    ds_read_b128 a[212:215], v193 offset:57344
    v_mfma_f32_16x16x32_bf16 v[0:3], a[100:103], a[196:199], v[0:3]
    v_mfma_f32_16x16x32_bf16 v[0:3], a[128:131], a[200:203], v[0:3]
    ds_read_b128 a[216:219], v193 offset:17408
    v_mfma_f32_16x16x32_bf16 v[0:3], a[132:135], a[204:207], v[0:3]
    ds_read_b128 a[220:223], v193 offset:25600
    v_mfma_f32_16x16x32_bf16 v[4:7], a[104:107], a[192:195], v[4:7]
    ds_read_b128 a[224:227], v193 offset:33792
    v_mfma_f32_16x16x32_bf16 v[4:7], a[108:111], a[196:199], v[4:7]
    ds_read_b128 a[228:231], v193 offset:41984
    v_mfma_f32_16x16x32_bf16 v[4:7], a[136:139], a[200:203], v[4:7]
    ds_read_b128 a[232:235], v193 offset:50176
    v_mfma_f32_16x16x32_bf16 v[4:7], a[140:143], a[204:207], v[4:7]
    ds_read_b128 a[236:239], v193 offset:58368
    v_mfma_f32_16x16x32_bf16 v[8:11], a[112:115], a[192:195], v[8:11]
    v_mfma_f32_16x16x32_bf16 v[8:11], a[116:119], a[196:199], v[8:11]
    v_mfma_f32_16x16x32_bf16 v[8:11], a[144:147], a[200:203], v[8:11]
    v_mfma_f32_16x16x32_bf16 v[8:11], a[148:151], a[204:207], v[8:11]
    v_mfma_f32_16x16x32_bf16 v[12:15], a[120:123], a[192:195], v[12:15]
    v_mfma_f32_16x16x32_bf16 v[12:15], a[124:127], a[196:199], v[12:15]
    v_mfma_f32_16x16x32_bf16 v[12:15], a[152:155], a[200:203], v[12:15]
    v_mfma_f32_16x16x32_bf16 v[12:15], a[156:159], a[204:207], v[12:15]
    s_waitcnt lgkmcnt(0)
    v_mfma_f32_16x16x32_bf16 v[0:3], a[160:163], a[208:211], v[0:3]
    v_mfma_f32_16x16x32_bf16 v[0:3], a[164:167], a[212:215], v[0:3]
    v_mfma_f32_16x16x32_bf16 v[4:7], a[168:171], a[208:211], v[4:7]
    v_mfma_f32_16x16x32_bf16 v[4:7], a[172:175], a[212:215], v[4:7]
    v_mfma_f32_16x16x32_bf16 v[8:11], a[176:179], a[208:211], v[8:11]
    v_mfma_f32_16x16x32_bf16 v[8:11], a[180:183], a[212:215], v[8:11]
    v_mfma_f32_16x16x32_bf16 v[12:15], a[184:187], a[208:211], v[12:15]
    v_mfma_f32_16x16x32_bf16 v[12:15], a[188:191], a[212:215], v[12:15]
    v_mfma_f32_16x16x32_bf16 v[16:19], a[96:99], a[216:219], v[16:19]
    ds_read_b128 a[192:195], v193 offset:18432
    ds_read_b128 a[196:199], v193 offset:26624
    v_mfma_f32_16x16x32_bf16 v[16:19], a[100:103], a[220:223], v[16:19]
    ds_read_b128 a[200:203], v193 offset:34816
    ds_read_b128 a[204:207], v193 offset:43008
    v_mfma_f32_16x16x32_bf16 v[16:19], a[128:131], a[224:227], v[16:19]
    ds_read_b128 a[208:211], v193 offset:51200
    ds_read_b128 a[212:215], v193 offset:59392
    v_mfma_f32_16x16x32_bf16 v[16:19], a[132:135], a[228:231], v[16:19]
    v_cvt_pk_bf16_f32 v0, v0, v1
    v_cvt_pk_bf16_f32 v1, v2, v3
    v_mfma_f32_16x16x32_bf16 v[16:19], a[160:163], a[232:235], v[16:19]
    v_cvt_pk_bf16_f32 v2, v4, v5
    v_cvt_pk_bf16_f32 v3, v6, v7
    v_mfma_f32_16x16x32_bf16 v[16:19], a[164:167], a[236:239], v[16:19]
    v_cvt_pk_bf16_f32 v8, v8, v9
    v_cvt_pk_bf16_f32 v9, v10, v11
    v_mfma_f32_16x16x32_bf16 v[20:23], a[104:107], a[216:219], v[20:23]
    v_cvt_pk_bf16_f32 v10, v12, v13
    v_cvt_pk_bf16_f32 v11, v14, v15
    v_mfma_f32_16x16x32_bf16 v[20:23], a[108:111], a[220:223], v[20:23]
    v_permlane16_swap_b32 v0, v2
    v_permlane16_swap_b32 v1, v3
    v_mfma_f32_16x16x32_bf16 v[20:23], a[136:139], a[224:227], v[20:23]
    v_permlane16_swap_b32 v8, v10
    v_permlane16_swap_b32 v9, v11
    v_mfma_f32_16x16x32_bf16 v[20:23], a[140:143], a[228:231], v[20:23]
    ds_write_b128 v212, v[0:3] offset:0
    v_mfma_f32_16x16x32_bf16 v[20:23], a[168:171], a[232:235], v[20:23]
    v_mfma_f32_16x16x32_bf16 v[20:23], a[172:175], a[236:239], v[20:23]
    v_mfma_f32_16x16x32_bf16 v[24:27], a[112:115], a[216:219], v[24:27]
    v_mfma_f32_16x16x32_bf16 v[24:27], a[116:119], a[220:223], v[24:27]
    ds_write_b128 v213, v[8:11] offset:0
    v_mfma_f32_16x16x32_bf16 v[24:27], a[144:147], a[224:227], v[24:27]
    ds_read_b128 v[64:67], v214 offset:0
    v_mfma_f32_16x16x32_bf16 v[24:27], a[148:151], a[228:231], v[24:27]
    ds_read_b128 v[68:71], v214 offset:1024
    v_mfma_f32_16x16x32_bf16 v[24:27], a[176:179], a[232:235], v[24:27]
    v_mfma_f32_16x16x32_bf16 v[24:27], a[180:183], a[236:239], v[24:27]
    v_mfma_f32_16x16x32_bf16 v[28:31], a[120:123], a[216:219], v[28:31]
    v_mfma_f32_16x16x32_bf16 v[28:31], a[124:127], a[220:223], v[28:31]
    v_mfma_f32_16x16x32_bf16 v[28:31], a[152:155], a[224:227], v[28:31]
    v_mfma_f32_16x16x32_bf16 v[28:31], a[156:159], a[228:231], v[28:31]
    v_mfma_f32_16x16x32_bf16 v[28:31], a[184:187], a[232:235], v[28:31]
    s_waitcnt lgkmcnt(0)
    buffer_store_dwordx4 v[64:67], v206, s[84:87], s95 offen sc1
    s_add_u32 s95, s95, 32768
    v_mfma_f32_16x16x32_bf16 v[28:31], a[188:191], a[236:239], v[28:31]
    v_mfma_f32_16x16x32_bf16 v[32:35], a[96:99], a[192:195], v[32:35]
    ds_read_b128 a[216:219], v193 offset:19456
    ds_read_b128 a[220:223], v193 offset:27648
    v_mfma_f32_16x16x32_bf16 v[32:35], a[100:103], a[196:199], v[32:35]
    ds_read_b128 a[224:227], v193 offset:35840
    ds_read_b128 a[228:231], v193 offset:44032
    v_mfma_f32_16x16x32_bf16 v[32:35], a[128:131], a[200:203], v[32:35]
    buffer_store_dwordx4 v[68:71], v206, s[84:87], s95 offen sc1
    s_add_u32 s95, s95, 32768
    ds_read_b128 a[232:235], v193 offset:52224
    ds_read_b128 a[236:239], v193 offset:60416
    v_mfma_f32_16x16x32_bf16 v[32:35], a[132:135], a[204:207], v[32:35]
    v_cvt_pk_bf16_f32 v16, v16, v17
    v_cvt_pk_bf16_f32 v17, v18, v19
    v_mfma_f32_16x16x32_bf16 v[32:35], a[160:163], a[208:211], v[32:35]
    v_cvt_pk_bf16_f32 v18, v20, v21
    v_cvt_pk_bf16_f32 v19, v22, v23
    v_mfma_f32_16x16x32_bf16 v[32:35], a[164:167], a[212:215], v[32:35]
    v_cvt_pk_bf16_f32 v24, v24, v25
    v_cvt_pk_bf16_f32 v25, v26, v27
    v_mfma_f32_16x16x32_bf16 v[36:39], a[104:107], a[192:195], v[36:39]
    v_cvt_pk_bf16_f32 v26, v28, v29
    v_cvt_pk_bf16_f32 v27, v30, v31
    v_mfma_f32_16x16x32_bf16 v[36:39], a[108:111], a[196:199], v[36:39]
L_pg9:
    s_cbranch_execz L_back2
    v_permlane16_swap_b32 v16, v18
    v_permlane16_swap_b32 v17, v19
    v_mfma_f32_16x16x32_bf16 v[36:39], a[136:139], a[200:203], v[36:39]
    v_permlane16_swap_b32 v24, v26
    v_permlane16_swap_b32 v25, v27
    v_mfma_f32_16x16x32_bf16 v[36:39], a[140:143], a[204:207], v[36:39]
    ds_write_b128 v212, v[16:19] offset:2048
    v_mfma_f32_16x16x32_bf16 v[36:39], a[168:171], a[208:211], v[36:39]
    v_mfma_f32_16x16x32_bf16 v[36:39], a[172:175], a[212:215], v[36:39]
    v_mfma_f32_16x16x32_bf16 v[40:43], a[112:115], a[192:195], v[40:43]
    v_mfma_f32_16x16x32_bf16 v[40:43], a[116:119], a[196:199], v[40:43]
    ds_write_b128 v213, v[24:27] offset:2048
    v_mfma_f32_16x16x32_bf16 v[40:43], a[144:147], a[200:203], v[40:43]
    ds_read_b128 v[72:75], v214 offset:2048
    v_mfma_f32_16x16x32_bf16 v[40:43], a[148:151], a[204:207], v[40:43]
    ds_read_b128 v[76:79], v214 offset:3072
    v_mfma_f32_16x16x32_bf16 v[40:43], a[176:179], a[208:211], v[40:43]
    v_mfma_f32_16x16x32_bf16 v[40:43], a[180:183], a[212:215], v[40:43]
    v_mfma_f32_16x16x32_bf16 v[44:47], a[120:123], a[192:195], v[44:47]
    v_mfma_f32_16x16x32_bf16 v[44:47], a[124:127], a[196:199], v[44:47]
    v_mfma_f32_16x16x32_bf16 v[44:47], a[152:155], a[200:203], v[44:47]
    v_mfma_f32_16x16x32_bf16 v[44:47], a[156:159], a[204:207], v[44:47]
    v_mfma_f32_16x16x32_bf16 v[44:47], a[184:187], a[208:211], v[44:47]
    s_waitcnt lgkmcnt(0)
    buffer_store_dwordx4 v[72:75], v206, s[84:87], s95 offen sc1
    s_add_u32 s95, s95, 32768
    v_mfma_f32_16x16x32_bf16 v[44:47], a[188:191], a[212:215], v[44:47]
    v_mfma_f32_16x16x32_bf16 v[48:51], a[96:99], a[216:219], v[48:51]
    v_mfma_f32_16x16x32_bf16 v[48:51], a[100:103], a[220:223], v[48:51]
    v_mfma_f32_16x16x32_bf16 v[48:51], a[128:131], a[224:227], v[48:51]
    buffer_store_dwordx4 v[76:79], v206, s[84:87], s95 offen sc1
    s_add_u32 s95, s95, 32768
    v_mfma_f32_16x16x32_bf16 v[48:51], a[132:135], a[228:231], v[48:51]
    v_cvt_pk_bf16_f32 v32, v32, v33
    v_cvt_pk_bf16_f32 v33, v34, v35
    v_mfma_f32_16x16x32_bf16 v[48:51], a[160:163], a[232:235], v[48:51]
    v_cvt_pk_bf16_f32 v34, v36, v37
    v_cvt_pk_bf16_f32 v35, v38, v39
    v_mfma_f32_16x16x32_bf16 v[48:51], a[164:167], a[236:239], v[48:51]
    v_cvt_pk_bf16_f32 v40, v40, v41
    v_cvt_pk_bf16_f32 v41, v42, v43
    v_mfma_f32_16x16x32_bf16 v[52:55], a[104:107], a[216:219], v[52:55]
    v_cvt_pk_bf16_f32 v42, v44, v45
    v_cvt_pk_bf16_f32 v43, v46, v47
    v_mfma_f32_16x16x32_bf16 v[52:55], a[108:111], a[220:223], v[52:55]
    v_permlane16_swap_b32 v32, v34
    v_permlane16_swap_b32 v33, v35
    v_mfma_f32_16x16x32_bf16 v[52:55], a[136:139], a[224:227], v[52:55]
    v_permlane16_swap_b32 v40, v42
    v_permlane16_swap_b32 v41, v43
    v_mfma_f32_16x16x32_bf16 v[52:55], a[140:143], a[228:231], v[52:55]
    ds_write_b128 v212, v[32:35] offset:4096
    v_mfma_f32_16x16x32_bf16 v[52:55], a[168:171], a[232:235], v[52:55]
    v_mfma_f32_16x16x32_bf16 v[52:55], a[172:175], a[236:239], v[52:55]
    v_mfma_f32_16x16x32_bf16 v[56:59], a[112:115], a[216:219], v[56:59]
    v_mfma_f32_16x16x32_bf16 v[56:59], a[116:119], a[220:223], v[56:59]
    ds_write_b128 v213, v[40:43] offset:4096
    v_mfma_f32_16x16x32_bf16 v[56:59], a[144:147], a[224:227], v[56:59]
    ds_read_b128 v[64:67], v214 offset:4096
    v_mfma_f32_16x16x32_bf16 v[56:59], a[148:151], a[228:231], v[56:59]
    ds_read_b128 v[68:71], v214 offset:5120
    v_mfma_f32_16x16x32_bf16 v[56:59], a[176:179], a[232:235], v[56:59]
    v_cvt_pk_bf16_f32 v48, v48, v49
    v_cvt_pk_bf16_f32 v49, v50, v51
    v_mfma_f32_16x16x32_bf16 v[56:59], a[180:183], a[236:239], v[56:59]
    v_cvt_pk_bf16_f32 v50, v52, v53
    v_cvt_pk_bf16_f32 v51, v54, v55
    v_mfma_f32_16x16x32_bf16 v[60:63], a[120:123], a[216:219], v[60:63]
    v_mfma_f32_16x16x32_bf16 v[60:63], a[124:127], a[220:223], v[60:63]
    v_permlane16_swap_b32 v48, v50
    v_permlane16_swap_b32 v49, v51
    v_mfma_f32_16x16x32_bf16 v[60:63], a[152:155], a[224:227], v[60:63]
    v_mfma_f32_16x16x32_bf16 v[60:63], a[156:159], a[228:231], v[60:63]
    ds_write_b128 v212, v[48:51] offset:6144
    v_mfma_f32_16x16x32_bf16 v[60:63], a[184:187], a[232:235], v[60:63]
    s_waitcnt lgkmcnt(1)
    buffer_store_dwordx4 v[64:67], v206, s[84:87], s95 offen sc1
    s_add_u32 s95, s95, 32768
    v_mfma_f32_16x16x32_bf16 v[60:63], a[188:191], a[236:239], v[60:63]
    buffer_store_dwordx4 v[68:71], v206, s[84:87], s95 offen sc1
    s_add_u32 s95, s95, 32768
    v_cvt_pk_bf16_f32 v56, v56, v57
    v_cvt_pk_bf16_f32 v57, v58, v59
    s_nop 3
    v_cvt_pk_bf16_f32 v58, v60, v61
    v_cvt_pk_bf16_f32 v59, v62, v63
    s_nop 0
    v_permlane16_swap_b32 v56, v58
    v_permlane16_swap_b32 v57, v59
    ds_write_b128 v213, v[56:59] offset:6144
    ds_read_b128 v[72:75], v214 offset:6144
    ds_read_b128 v[76:79], v214 offset:7168
    s_waitcnt lgkmcnt(1)
    buffer_store_dwordx4 v[72:75], v206, s[84:87], s95 offen sc1
    s_add_u32 s95, s95, 32768
    s_waitcnt lgkmcnt(0)
    buffer_store_dwordx4 v[76:79], v206, s[84:87], s95 offen sc1
L_end:
    s_endpgm
L_code_end:
L_retry:
    s_mov_b32 s76, 0
    v_min_u32 v1, 6, v209
    s_add_u32 s4, s31, 1
    v_add_u32 v1, s4, v1
    v_and_b32 v1, 7, v1
    v_lshlrev_b32 v1, 7, v1
    v_cmp_ne_u32 vcc, 256, v210
    s_nop 0
    s_cbranch_vccz L_wait
    buffer_store_dword v208, off, s[16:19], s71 sc1
L_cert:
    buffer_load_dword v210, off, s[36:39], 0 sc1
    s_waitcnt vmcnt(0)
    v_cmp_ne_u32 vcc, 256, v210
    s_nop 0
    s_cbranch_vccnz L_cert
    v_mov_b32 v8, -1
    v_accvgpr_write_b32 a250, v8
    v_accvgpr_write_b32 a251, v8
L_wait:
    v_accvgpr_read_b32 v8, a250
    v_accvgpr_read_b32 v9, a251
    v_cmp_eq_u32 s[6:7], -1, v8
    v_cmp_eq_u32 vcc, -1, v9
    s_mov_b32 s3, 0
    s_bfe_u32 s4, s6, 0x100000
    s_cmp_lg_u32 s4, 0
    s_cselect_b32 s4, 1, 0
    s_or_b32 s3, s3, s4
    s_bfe_u32 s4, vcc_lo, 0x100000
    s_cmp_lg_u32 s4, 0
    s_cselect_b32 s4, 16, 0
    s_or_b32 s3, s3, s4
    s_bfe_u32 s4, s6, 0x100010
    s_cmp_lg_u32 s4, 0
    s_cselect_b32 s4, 2, 0
    s_or_b32 s3, s3, s4
    s_bfe_u32 s4, vcc_lo, 0x100010
    s_cmp_lg_u32 s4, 0
    s_cselect_b32 s4, 32, 0
    s_or_b32 s3, s3, s4
    s_bfe_u32 s4, s7, 0x100000
    s_cmp_lg_u32 s4, 0
    s_cselect_b32 s4, 4, 0
    s_or_b32 s3, s3, s4
    s_bfe_u32 s4, vcc_hi, 0x100000
    s_cmp_lg_u32 s4, 0
    s_cselect_b32 s4, 64, 0
    s_or_b32 s3, s3, s4
    s_bfe_u32 s4, s7, 0x100010
    s_cmp_lg_u32 s4, 0
    s_cselect_b32 s4, 8, 0
    s_or_b32 s3, s3, s4
    s_bfe_u32 s4, vcc_hi, 0x100010
    s_cmp_lg_u32 s4, 0
    s_cselect_b32 s4, 128, 0
    s_or_b32 s3, s3, s4
    s_cmp_eq_u32 s3, 0
    s_cselect_b32 s3, 0xff, s3
    s_lshl_b32 s4, s3, 8
    s_or_b32 s3, s3, s4
    s_lshr_b32 s3, s3, s31
    s_mov_b32 s6, 0
    s_mov_b64 s[4:5], -1
    s_cmp_eq_u32 s76, 0
    s_mov_b32 s76, 1
    s_cbranch_scc1 L_regather
L_wait2:
    buffer_load_dword v8, v239, s[16:19], s43 offen sc1
    buffer_load_dword v9, v239, s[16:19], s43 offen offset:256 sc1
    s_add_u32 s6, s6, 1
    s_waitcnt vmcnt(0)
    v_max_u32_e64 v8, v8, v9
    v_cmp_eq_u32 vcc, -1, v8
    s_nop 0
    s_cbranch_vccz L_zok
    s_sleep 1
    s_and_b32 s7, s6, 7
    s_cbranch_scc1 L_wait2
L_flags:
    buffer_store_dword v208, off, s[16:19], s71 sc1
    buffer_load_dword v3, v1, s[16:19], s40 offen sc1
    s_waitcnt vmcnt(0)
    v_cmp_ne_u32 vcc, 1, v3
    s_nop 0
    s_mov_b64 s[4:5], vcc
    s_cbranch_vccz L_all
    s_branch L_wait2
L_zok:
    s_cmp_eq_u32 s68, 77
    s_mov_b32 s68, 77
    s_cbranch_scc0 L_regather
    s_mov_b32 s68, 0
    s_branch L_flags
L_all:
    s_mov_b32 s3, 0xff
L_regather:
    buffer_load_dword a250, v239, s[16:19], s43 offen sc1
    buffer_load_dword a251, v239, s[16:19], s43 offen offset:256 sc1
    s_bitcmp1_b32 s3, 1
    s_cbranch_scc0 L_skip1
    s_add_u32 s97, s31, 1
    s_and_b32 s97, s97, 7
    s_lshl_b32 s97, s97, 13
    s_add_u32 s97, s97, s41
    buffer_load_dwordx4 a[192:195], v233, s[16:19], s97 offen offset:0 sc1
    buffer_load_dwordx4 a[196:199], v233, s[16:19], s97 offen offset:1024 sc1
L_skip1:
    s_bitcmp1_b32 s3, 2
    s_cbranch_scc0 L_skip2
    s_add_u32 s96, s31, 2
    s_and_b32 s96, s96, 7
    s_lshl_b32 s96, s96, 13
    s_add_u32 s96, s96, s41
    buffer_load_dwordx4 a[200:203], v233, s[16:19], s96 offen offset:0 sc1
    buffer_load_dwordx4 a[204:207], v233, s[16:19], s96 offen offset:1024 sc1
L_skip2:
    s_bitcmp1_b32 s3, 3
    s_cbranch_scc0 L_skip3
    s_add_u32 s97, s31, 3
    s_and_b32 s97, s97, 7
    s_lshl_b32 s97, s97, 13
    s_add_u32 s97, s97, s41
    buffer_load_dwordx4 a[208:211], v233, s[16:19], s97 offen offset:0 sc1
    buffer_load_dwordx4 a[212:215], v233, s[16:19], s97 offen offset:1024 sc1
L_skip3:
    s_bitcmp1_b32 s3, 4
    s_cbranch_scc0 L_skip4
    s_add_u32 s96, s31, 4
    s_and_b32 s96, s96, 7
    s_lshl_b32 s96, s96, 13
    s_add_u32 s96, s96, s41
    buffer_load_dwordx4 a[216:219], v233, s[16:19], s96 offen offset:0 sc1
    buffer_load_dwordx4 a[220:223], v233, s[16:19], s96 offen offset:1024 sc1
L_skip4:
    s_bitcmp1_b32 s3, 5
    s_cbranch_scc0 L_skip5
    s_add_u32 s97, s31, 5
    s_and_b32 s97, s97, 7
    s_lshl_b32 s97, s97, 13
    s_add_u32 s97, s97, s41
    buffer_load_dwordx4 a[80:83], v233, s[16:19], s97 offen offset:0 sc1
    buffer_load_dwordx4 a[84:87], v233, s[16:19], s97 offen offset:1024 sc1
L_skip5:
    s_bitcmp1_b32 s3, 6
    s_cbranch_scc0 L_skip6
    s_add_u32 s96, s31, 6
    s_and_b32 s96, s96, 7
    s_lshl_b32 s96, s96, 13
    s_add_u32 s96, s96, s41
    buffer_load_dwordx4 a[88:91], v233, s[16:19], s96 offen offset:0 sc1
    buffer_load_dwordx4 a[92:95], v233, s[16:19], s96 offen offset:1024 sc1
L_skip6:
    s_bitcmp1_b32 s3, 7
    s_cbranch_scc0 L_skip7
    s_add_u32 s97, s31, 7
    s_and_b32 s97, s97, 7
    s_lshl_b32 s97, s97, 13
    s_add_u32 s97, s97, s41
    buffer_load_dwordx4 a[96:99], v233, s[16:19], s97 offen offset:0 sc1
    buffer_load_dwordx4 a[100:103], v233, s[16:19], s97 offen offset:1024 sc1
L_skip7:
    s_waitcnt vmcnt(0)
    v_mov_b32 v248, 889599933
    v_mov_b32 v249, 889599933
    v_mov_b32 v250, 889599933
    v_mov_b32 v251, 889599933
    v_mov_b32 v252, 889599933
    v_mov_b32 v253, 889599933
    v_mov_b32 v254, 889599933
    v_mov_b32 v255, 889599933
    v_mfma_f32_16x16x32_bf16 v[248:251], a[250:253], a[242:245], v[248:251]
    s_nop 0
    v_mfma_f32_16x16x32_bf16 v[252:255], a[250:253], a[246:249], v[252:255]
    v_mfma_f32_16x16x32_bf16 v[212:215], a[238:241], a[192:195], v[192:195]
    v_mfma_f32_16x16x32_bf16 v[220:223], a[236:239], a[192:195], v[200:203]
    v_mfma_f32_16x16x32_bf16 v[216:219], a[238:241], a[196:199], v[196:199]
    v_mfma_f32_16x16x32_bf16 v[226:229], a[236:239], a[196:199], v[204:207]
    v_mfma_f32_16x16x32_bf16 v[212:215], a[238:241], a[200:203], v[212:215]
    v_mfma_f32_16x16x32_bf16 v[220:223], a[236:239], a[200:203], v[220:223]
    v_mfma_f32_16x16x32_bf16 v[216:219], a[238:241], a[204:207], v[216:219]
    v_mfma_f32_16x16x32_bf16 v[226:229], a[236:239], a[204:207], v[226:229]
    v_mfma_f32_16x16x32_bf16 v[212:215], a[238:241], a[208:211], v[212:215]
    v_mfma_f32_16x16x32_bf16 v[220:223], a[236:239], a[208:211], v[220:223]
    v_mfma_f32_16x16x32_bf16 v[216:219], a[238:241], a[212:215], v[216:219]
    v_mfma_f32_16x16x32_bf16 v[226:229], a[236:239], a[212:215], v[226:229]
    v_mfma_f32_16x16x32_bf16 v[212:215], a[238:241], a[216:219], v[212:215]
    v_mfma_f32_16x16x32_bf16 v[220:223], a[236:239], a[216:219], v[220:223]
    v_mfma_f32_16x16x32_bf16 v[216:219], a[238:241], a[220:223], v[216:219]
    v_mfma_f32_16x16x32_bf16 v[226:229], a[236:239], a[220:223], v[226:229]
    v_mfma_f32_16x16x32_bf16 v[212:215], a[238:241], a[80:83], v[212:215]
    v_mfma_f32_16x16x32_bf16 v[220:223], a[236:239], a[80:83], v[220:223]
    v_mfma_f32_16x16x32_bf16 v[216:219], a[238:241], a[84:87], v[216:219]
    v_mfma_f32_16x16x32_bf16 v[226:229], a[236:239], a[84:87], v[226:229]
    v_mfma_f32_16x16x32_bf16 v[212:215], a[238:241], a[88:91], v[212:215]
    v_mfma_f32_16x16x32_bf16 v[220:223], a[236:239], a[88:91], v[220:223]
    v_mfma_f32_16x16x32_bf16 v[216:219], a[238:241], a[92:95], v[216:219]
    v_mfma_f32_16x16x32_bf16 v[226:229], a[236:239], a[92:95], v[226:229]
    v_mfma_f32_16x16x32_bf16 v[212:215], a[238:241], a[96:99], v[212:215]
    v_mfma_f32_16x16x32_bf16 v[220:223], a[236:239], a[96:99], v[220:223]
    v_mfma_f32_16x16x32_bf16 v[216:219], a[238:241], a[100:103], v[216:219]
    v_mfma_f32_16x16x32_bf16 v[226:229], a[236:239], a[100:103], v[226:229]
    s_nop 6
    v_add_f32 v232, v212, v216
    v_add_f32 v234, v248, v249
    v_add_f32 v236, v250, v251
    v_add_f32 v232, v232, v234
    v_add_f32_e64 v232, v232, v236
    v_cmp_u_f32 vcc, v232, v232
    s_nop 0
    s_cbranch_vccz L_valid
    s_cmp_lg_u64 s[4:5], 0
    s_cbranch_scc0 L_valid
    s_branch L_wait
L_warm_end:
L_slowK:
    s_nop 15
    s_waitcnt vmcnt(0) lgkmcnt(0)
    v_mfma_f32_16x16x32_bf16 v[68:71], a[224:227], v[64:67], 0
    v_mfma_f32_16x16x32_bf16 v[76:79], a[228:231], v[64:67], 0
    s_nop 6
    v_pk_mul_f32 v[68:69], v[68:69], v[224:225] op_sel_hi:[1,0]
    v_pk_mul_f32 v[70:71], v[70:71], v[224:225] op_sel_hi:[1,0]
    v_pk_mul_f32 v[76:77], v[76:77], v[224:225] op_sel_hi:[1,0]
    v_pk_mul_f32 v[78:79], v[78:79], v[224:225] op_sel_hi:[1,0]
    v_max3_f32 v232, v68, v69, v70
    v_max3_f32 v232, v232, v71, v76
    v_max3_f32 v232, v232, v77, v78
    v_max_f32 v232, v232, v79
    v_mov_b32 v236, v232
    s_nop 1
    v_permlane16_swap_b32 v232, v236
    v_max_f32 v232, v232, v236
    v_mov_b32 v236, v232
    s_nop 1
    v_permlane32_swap_b32 v232, v236
    v_max_f32 v232, v232, v236
    v_min3_f32 v234, v68, v69, v70
    v_min3_f32 v234, v234, v71, v76
    v_min3_f32 v234, v234, v77, v78
    v_min_f32 v234, v234, v79
    v_mov_b32 v236, v234
    s_nop 1
    v_permlane16_swap_b32 v234, v236
    v_min_f32 v234, v234, v236
    v_mov_b32 v236, v234
    s_nop 1
    v_permlane32_swap_b32 v234, v236
    v_min_f32 v234, v234, v236
    v_sub_f32 v116, v68, v232
    v_exp_f32 v116, v116
    v_sub_f32 v68, v234, v68
    v_exp_f32 v68, v68
    v_sub_f32 v117, v69, v232
    v_exp_f32 v117, v117
    v_sub_f32 v69, v234, v69
    v_exp_f32 v69, v69
    v_sub_f32 v118, v70, v232
    v_exp_f32 v118, v118
    v_sub_f32 v70, v234, v70
    v_exp_f32 v70, v70
    v_sub_f32 v119, v71, v232
    v_exp_f32 v119, v119
    v_sub_f32 v71, v234, v71
    v_exp_f32 v71, v71
    v_sub_f32 v124, v76, v232
    v_exp_f32 v124, v124
    v_sub_f32 v76, v234, v76
    v_exp_f32 v76, v76
    v_sub_f32 v125, v77, v232
    v_exp_f32 v125, v125
    v_sub_f32 v77, v234, v77
    v_exp_f32 v77, v77
    v_sub_f32 v126, v78, v232
    v_exp_f32 v126, v126
    v_sub_f32 v78, v234, v78
    v_exp_f32 v78, v78
    v_sub_f32 v127, v79, v232
    v_exp_f32 v127, v127
    v_sub_f32 v79, v234, v79
    v_exp_f32_e64 v79, v79
    v_cvt_pk_bf16_f32 v148, v116, v117
    v_cvt_pk_bf16_f32 v149, v118, v119
    v_cvt_pk_bf16_f32 v150, v124, v125
    v_cvt_pk_bf16_f32 v151, v126, v127
    s_nop 1
    v_mfma_f32_16x16x32_bf16 v[180:183], a[232:235], v[148:151], 0
    v_cvt_pk_bf16_f32 v156, v68, v69
    v_cvt_pk_bf16_f32 v157, v70, v71
    v_cvt_pk_bf16_f32 v158, v76, v77
    v_cvt_pk_bf16_f32 v159, v78, v79
    s_nop 1
    v_mfma_f32_16x16x32_bf16 v[188:191], a[232:235], v[156:159], 0
    s_nop 0
    v_rcp_f32 v232, v180
    s_nop 5
    v_rcp_f32 v234, v188
    v_max3_f32 v237, v180, v188, v237
    v_pk_mul_f32 v[116:117], v[116:117], v[232:233] op_sel_hi:[1,0]
    v_pk_mul_f32 v[118:119], v[118:119], v[232:233] op_sel_hi:[1,0]
    v_pk_mul_f32 v[124:125], v[124:125], v[232:233] op_sel_hi:[1,0]
    v_pk_mul_f32 v[126:127], v[126:127], v[232:233] op_sel_hi:[1,0]
    v_pk_mul_f32 v[68:69], v[68:69], v[234:235] op_sel_hi:[1,0]
    v_pk_mul_f32 v[70:71], v[70:71], v[234:235] op_sel_hi:[1,0]
    v_pk_mul_f32 v[76:77], v[76:77], v[234:235] op_sel_hi:[1,0]
    v_pk_mul_f32 v[78:79], v[78:79], v[234:235] op_sel_hi:[1,0]
    v_cvt_pk_bf16_f32 v148, v116, v117
    v_cvt_pk_bf16_f32 v149, v118, v119
    v_cvt_pk_bf16_f32 v150, v124, v125
    v_cvt_pk_bf16_f32 v151, v126, v127
    v_cvt_pk_bf16_f32 v156, v68, v69
    v_cvt_pk_bf16_f32 v157, v70, v71
    v_cvt_pk_bf16_f32 v158, v76, v77
    v_cvt_pk_bf16_f32 v159, v78, v79
    v_mfma_f32_16x16x32_bf16 v[212:215], v[148:151], a[238:241], 0
    v_mfma_f32_16x16x32_bf16 v[216:219], v[148:151], a[236:239], 0
    v_mfma_f32_16x16x32_bf16 v[220:223], v[156:159], a[238:241], 0
    v_mfma_f32_16x16x32_bf16 v[226:229], v[156:159], a[236:239], 0
    s_nop 4
    v_cvt_pk_bf16_f32 v240, v212, v213
    v_cvt_pk_bf16_f32 v241, v214, v215
    v_cvt_pk_bf16_f32 v244, v216, v217
    v_cvt_pk_bf16_f32 v245, v218, v219
    v_cvt_pk_bf16_f32 v248, v220, v221
    v_cvt_pk_bf16_f32 v249, v222, v223
    v_cvt_pk_bf16_f32 v252, v226, v227
    v_cvt_pk_bf16_f32 v253, v228, v229
    v_mfma_f32_16x16x32_bf16 v[84:87], a[224:227], v[72:75], 0
    v_mfma_f32_16x16x32_bf16 v[92:95], a[228:231], v[72:75], 0
    s_nop 6
    v_pk_mul_f32 v[84:85], v[84:85], v[224:225] op_sel_hi:[1,0]
    v_pk_mul_f32 v[86:87], v[86:87], v[224:225] op_sel_hi:[1,0]
    v_pk_mul_f32 v[92:93], v[92:93], v[224:225] op_sel_hi:[1,0]
    v_pk_mul_f32 v[94:95], v[94:95], v[224:225] op_sel_hi:[1,0]
    v_max3_f32 v232, v84, v85, v86
    v_max3_f32 v232, v232, v87, v92
    v_max3_f32 v232, v232, v93, v94
    v_max_f32 v232, v232, v95
    v_mov_b32 v236, v232
    s_nop 1
    v_permlane16_swap_b32 v232, v236
    v_max_f32 v232, v232, v236
    v_mov_b32 v236, v232
    s_nop 1
    v_permlane32_swap_b32 v232, v236
    v_max_f32_e64 v232, v232, v236
    v_min3_f32 v234, v84, v85, v86
    v_min3_f32 v234, v234, v87, v92
    v_min3_f32 v234, v234, v93, v94
    v_min_f32 v234, v234, v95
    v_mov_b32 v236, v234
    s_nop 1
    v_permlane16_swap_b32 v234, v236
    v_min_f32 v234, v234, v236
    v_mov_b32 v236, v234
    s_nop 1
    v_permlane32_swap_b32 v234, v236
    v_min_f32 v234, v234, v236
    v_sub_f32 v132, v84, v232
    v_exp_f32 v132, v132
    v_sub_f32 v84, v234, v84
    v_exp_f32 v84, v84
    v_sub_f32 v133, v85, v232
    v_exp_f32 v133, v133
    v_sub_f32 v85, v234, v85
    v_exp_f32 v85, v85
    v_sub_f32 v134, v86, v232
    v_exp_f32 v134, v134
    v_sub_f32 v86, v234, v86
    v_exp_f32 v86, v86
    v_sub_f32 v135, v87, v232
    v_exp_f32 v135, v135
    v_sub_f32 v87, v234, v87
    v_exp_f32 v87, v87
    v_sub_f32 v140, v92, v232
    v_exp_f32 v140, v140
    v_sub_f32 v92, v234, v92
    v_exp_f32 v92, v92
    v_sub_f32 v141, v93, v232
    v_exp_f32 v141, v141
    v_sub_f32 v93, v234, v93
    v_exp_f32 v93, v93
    v_sub_f32 v142, v94, v232
    v_exp_f32 v142, v142
    v_sub_f32 v94, v234, v94
    v_exp_f32 v94, v94
    v_sub_f32 v143, v95, v232
    v_exp_f32 v143, v143
    v_sub_f32 v95, v234, v95
    v_exp_f32_e64 v95, v95
    v_cvt_pk_bf16_f32 v164, v132, v133
    v_cvt_pk_bf16_f32 v165, v134, v135
    v_cvt_pk_bf16_f32 v166, v140, v141
    v_cvt_pk_bf16_f32 v167, v142, v143
    s_nop 1
    v_mfma_f32_16x16x32_bf16 v[180:183], a[232:235], v[164:167], 0
    v_cvt_pk_bf16_f32 v172, v84, v85
    v_cvt_pk_bf16_f32 v173, v86, v87
    v_cvt_pk_bf16_f32 v174, v92, v93
    v_cvt_pk_bf16_f32 v175, v94, v95
    s_nop 1
    v_mfma_f32_16x16x32_bf16 v[188:191], a[232:235], v[172:175], 0
    s_nop 0
    v_rcp_f32 v236, v180
    s_nop 5
    v_rcp_f32 v238, v188
    v_max3_f32 v237, v180, v188, v237
    v_pk_mul_f32 v[132:133], v[132:133], v[236:237] op_sel_hi:[1,0]
    v_pk_mul_f32 v[134:135], v[134:135], v[236:237] op_sel_hi:[1,0]
    v_pk_mul_f32 v[140:141], v[140:141], v[236:237] op_sel_hi:[1,0]
    v_pk_mul_f32 v[142:143], v[142:143], v[236:237] op_sel_hi:[1,0]
    v_pk_mul_f32 v[84:85], v[84:85], v[238:239] op_sel_hi:[1,0]
    v_pk_mul_f32 v[86:87], v[86:87], v[238:239] op_sel_hi:[1,0]
    v_pk_mul_f32 v[92:93], v[92:93], v[238:239] op_sel_hi:[1,0]
    v_pk_mul_f32 v[94:95], v[94:95], v[238:239] op_sel_hi:[1,0]
    v_cvt_pk_bf16_f32 v164, v132, v133
    v_cvt_pk_bf16_f32 v165, v134, v135
    v_cvt_pk_bf16_f32 v166, v140, v141
    v_cvt_pk_bf16_f32 v167, v142, v143
    v_cvt_pk_bf16_f32 v172, v84, v85
    v_cvt_pk_bf16_f32 v173, v86, v87
    v_cvt_pk_bf16_f32 v174, v92, v93
    v_cvt_pk_bf16_f32 v175, v94, v95
    v_mfma_f32_16x16x32_bf16 v[212:215], v[164:167], a[238:241], 0
    v_mfma_f32_16x16x32_bf16 v[216:219], v[164:167], a[236:239], 0
    v_mfma_f32_16x16x32_bf16 v[220:223], v[172:175], a[238:241], 0
    v_mfma_f32_16x16x32_bf16 v[226:229], v[172:175], a[236:239], 0
    s_nop 4
    v_cvt_pk_bf16_f32 v242, v212, v213
    v_cvt_pk_bf16_f32 v243, v214, v215
    v_cvt_pk_bf16_f32 v246, v216, v217
    v_cvt_pk_bf16_f32 v247, v218, v219
    v_cvt_pk_bf16_f32 v250, v220, v221
    v_cvt_pk_bf16_f32 v251, v222, v223
    v_cvt_pk_bf16_f32 v254, v226, v227
    v_cvt_pk_bf16_f32 v255, v228, v229
    v_mfma_f32_16x16x32_bf16 a[80:83], v[248:251], v[128:131], 0
    v_mfma_f32_16x16x32_bf16 a[84:87], v[248:251], v[136:139], 0
    v_mfma_f32_16x16x32_bf16 a[96:99], a[232:235], v[248:251], 0
    v_mfma_f32_16x16x32_bf16 a[88:91], v[252:255], v[128:131], 0
    v_mfma_f32_16x16x32_bf16 a[92:95], v[252:255], v[136:139], 0
    v_mfma_f32_16x16x32_bf16 a[100:103], a[232:235], v[252:255], 0
    v_mfma_f32_16x16x32_bf16 v[192:195], v[240:243], v[128:131], 0
    v_mfma_f32_16x16x32_bf16 v[196:199], v[240:243], v[136:139], 0
    v_mfma_f32_16x16x32_bf16 a[104:107], a[232:235], v[240:243], 0
    v_mfma_f32_16x16x32_bf16 v[200:203], v[244:247], v[128:131], 0
    v_mfma_f32_16x16x32_bf16 v[204:207], v[244:247], v[136:139], 0
    v_mfma_f32_16x16x32_bf16 a[108:111], a[232:235], v[244:247], 0
    v_mfma_f32_16x16x32_bf16 v[100:103], a[224:227], v[80:83], 0
    v_mfma_f32_16x16x32_bf16 v[108:111], a[228:231], v[80:83], 0
    s_nop 6
    v_pk_mul_f32 v[100:101], v[100:101], v[224:225] op_sel_hi:[1,0]
    v_pk_mul_f32 v[102:103], v[102:103], v[224:225] op_sel_hi:[1,0]
    v_pk_mul_f32 v[108:109], v[108:109], v[224:225] op_sel_hi:[1,0]
    v_pk_mul_f32 v[110:111], v[110:111], v[224:225] op_sel_hi:[1,0]
    v_max3_f32 v232, v100, v101, v102
    v_max3_f32 v232, v232, v103, v108
    v_max3_f32 v232, v232, v109, v110
    v_max_f32 v232, v232, v111
    v_mov_b32 v236, v232
    s_nop 1
    v_permlane16_swap_b32 v232, v236
    v_max_f32 v232, v232, v236
    v_mov_b32 v236, v232
    s_nop 1
    v_permlane32_swap_b32 v232, v236
    v_max_f32_e64 v232, v232, v236
    v_min3_f32 v234, v100, v101, v102
    v_min3_f32 v234, v234, v103, v108
    v_min3_f32 v234, v234, v109, v110
    v_min_f32 v234, v234, v111
    v_mov_b32 v236, v234
    s_nop 1
    v_permlane16_swap_b32 v234, v236
    v_min_f32 v234, v234, v236
    v_mov_b32 v236, v234
    s_nop 1
    v_permlane32_swap_b32 v234, v236
    v_min_f32 v234, v234, v236
    v_sub_f32 v116, v100, v232
    v_exp_f32 v116, v116
    v_sub_f32 v100, v234, v100
    v_exp_f32 v100, v100
    v_sub_f32 v117, v101, v232
    v_exp_f32 v117, v117
    v_sub_f32 v101, v234, v101
    v_exp_f32 v101, v101
    v_sub_f32 v118, v102, v232
    v_exp_f32 v118, v118
    v_sub_f32 v102, v234, v102
    v_exp_f32 v102, v102
    v_sub_f32 v119, v103, v232
    v_exp_f32 v119, v119
    v_sub_f32 v103, v234, v103
    v_exp_f32 v103, v103
    v_sub_f32 v124, v108, v232
    v_exp_f32 v124, v124
    v_sub_f32 v108, v234, v108
    v_exp_f32 v108, v108
    v_sub_f32 v125, v109, v232
    v_exp_f32 v125, v125
    v_sub_f32 v109, v234, v109
    v_exp_f32 v109, v109
    v_sub_f32 v126, v110, v232
    v_exp_f32 v126, v126
    v_sub_f32 v110, v234, v110
    v_exp_f32 v110, v110
    v_sub_f32 v127, v111, v232
    v_exp_f32 v127, v127
    v_sub_f32 v111, v234, v111
    v_exp_f32_e64 v111, v111
    v_cvt_pk_bf16_f32 v148, v116, v117
    v_cvt_pk_bf16_f32 v149, v118, v119
    v_cvt_pk_bf16_f32 v150, v124, v125
    v_cvt_pk_bf16_f32 v151, v126, v127
    s_nop 1
    v_mfma_f32_16x16x32_bf16 v[180:183], a[232:235], v[148:151], 0
    v_cvt_pk_bf16_f32 v156, v100, v101
    v_cvt_pk_bf16_f32 v157, v102, v103
    v_cvt_pk_bf16_f32 v158, v108, v109
    v_cvt_pk_bf16_f32 v159, v110, v111
    s_nop 1
    v_mfma_f32_16x16x32_bf16 v[188:191], a[232:235], v[156:159], 0
    s_nop 0
    v_rcp_f32 v232, v180
    s_nop 5
    v_rcp_f32 v234, v188
    v_max3_f32 v237, v180, v188, v237
    v_pk_mul_f32 v[116:117], v[116:117], v[232:233] op_sel_hi:[1,0]
    v_pk_mul_f32 v[118:119], v[118:119], v[232:233] op_sel_hi:[1,0]
    v_pk_mul_f32 v[124:125], v[124:125], v[232:233] op_sel_hi:[1,0]
    v_pk_mul_f32 v[126:127], v[126:127], v[232:233] op_sel_hi:[1,0]
    v_pk_mul_f32 v[100:101], v[100:101], v[234:235] op_sel_hi:[1,0]
    v_pk_mul_f32 v[102:103], v[102:103], v[234:235] op_sel_hi:[1,0]
    v_pk_mul_f32 v[108:109], v[108:109], v[234:235] op_sel_hi:[1,0]
    v_pk_mul_f32 v[110:111], v[110:111], v[234:235] op_sel_hi:[1,0]
    v_cvt_pk_bf16_f32 v148, v116, v117
    v_cvt_pk_bf16_f32 v149, v118, v119
    v_cvt_pk_bf16_f32 v150, v124, v125
    v_cvt_pk_bf16_f32 v151, v126, v127
    v_cvt_pk_bf16_f32 v156, v100, v101
    v_cvt_pk_bf16_f32 v157, v102, v103
    v_cvt_pk_bf16_f32 v158, v108, v109
    v_cvt_pk_bf16_f32 v159, v110, v111
    v_mfma_f32_16x16x32_bf16 v[212:215], v[148:151], a[238:241], 0
    v_mfma_f32_16x16x32_bf16 v[216:219], v[148:151], a[236:239], 0
    v_mfma_f32_16x16x32_bf16 v[220:223], v[156:159], a[238:241], 0
    v_mfma_f32_16x16x32_bf16 v[226:229], v[156:159], a[236:239], 0
    s_nop 4
    v_cvt_pk_bf16_f32 v240, v212, v213
    v_cvt_pk_bf16_f32 v241, v214, v215
    v_cvt_pk_bf16_f32 v244, v216, v217
    v_cvt_pk_bf16_f32 v245, v218, v219
    v_cvt_pk_bf16_f32 v248, v220, v221
    v_cvt_pk_bf16_f32 v249, v222, v223
    v_cvt_pk_bf16_f32 v252, v226, v227
    v_cvt_pk_bf16_f32 v253, v228, v229
    v_mfma_f32_16x16x32_bf16 v[68:71], a[224:227], v[88:91], 0
    v_mfma_f32_16x16x32_bf16 v[76:79], a[228:231], v[88:91], 0
    s_nop 6
    v_pk_mul_f32 v[68:69], v[68:69], v[224:225] op_sel_hi:[1,0]
    v_pk_mul_f32 v[70:71], v[70:71], v[224:225] op_sel_hi:[1,0]
    v_pk_mul_f32 v[76:77], v[76:77], v[224:225] op_sel_hi:[1,0]
    v_pk_mul_f32 v[78:79], v[78:79], v[224:225] op_sel_hi:[1,0]
    v_max3_f32 v232, v68, v69, v70
    v_max3_f32 v232, v232, v71, v76
    v_max3_f32 v232, v232, v77, v78
    v_max_f32 v232, v232, v79
    v_mov_b32 v236, v232
    s_nop 1
    v_permlane16_swap_b32 v232, v236
    v_max_f32 v232, v232, v236
    v_mov_b32 v236, v232
    s_nop 1
    v_permlane32_swap_b32 v232, v236
    v_max_f32_e64 v232, v232, v236
    v_min3_f32 v234, v68, v69, v70
    v_min3_f32 v234, v234, v71, v76
    v_min3_f32 v234, v234, v77, v78
    v_min_f32 v234, v234, v79
    v_mov_b32 v236, v234
    s_nop 1
    v_permlane16_swap_b32 v234, v236
    v_min_f32 v234, v234, v236
    v_mov_b32 v236, v234
    s_nop 1
    v_permlane32_swap_b32 v234, v236
    v_min_f32 v234, v234, v236
    v_sub_f32 v132, v68, v232
    v_exp_f32 v132, v132
    v_sub_f32 v68, v234, v68
    v_exp_f32 v68, v68
    v_sub_f32 v133, v69, v232
    v_exp_f32 v133, v133
    v_sub_f32 v69, v234, v69
    v_exp_f32 v69, v69
    v_sub_f32 v134, v70, v232
    v_exp_f32 v134, v134
    v_sub_f32 v70, v234, v70
    v_exp_f32 v70, v70
    v_sub_f32 v135, v71, v232
    v_exp_f32 v135, v135
    v_sub_f32 v71, v234, v71
    v_exp_f32 v71, v71
    v_sub_f32 v140, v76, v232
    v_exp_f32 v140, v140
    v_sub_f32 v76, v234, v76
    v_exp_f32 v76, v76
    v_sub_f32 v141, v77, v232
    v_exp_f32 v141, v141
    v_sub_f32 v77, v234, v77
    v_exp_f32 v77, v77
    v_sub_f32 v142, v78, v232
    v_exp_f32 v142, v142
    v_sub_f32 v78, v234, v78
    v_exp_f32 v78, v78
    v_sub_f32 v143, v79, v232
    v_exp_f32 v143, v143
    v_sub_f32 v79, v234, v79
    v_exp_f32_e64 v79, v79
    v_cvt_pk_bf16_f32 v164, v132, v133
    v_cvt_pk_bf16_f32 v165, v134, v135
    v_cvt_pk_bf16_f32 v166, v140, v141
    v_cvt_pk_bf16_f32 v167, v142, v143
    s_nop 1
    v_mfma_f32_16x16x32_bf16 v[180:183], a[232:235], v[164:167], 0
    v_cvt_pk_bf16_f32 v172, v68, v69
    v_cvt_pk_bf16_f32 v173, v70, v71
    v_cvt_pk_bf16_f32 v174, v76, v77
    v_cvt_pk_bf16_f32 v175, v78, v79
    s_nop 1
    v_mfma_f32_16x16x32_bf16 v[188:191], a[232:235], v[172:175], 0
    s_nop 0
    v_rcp_f32 v236, v180
    s_nop 5
    v_rcp_f32 v238, v188
    v_max3_f32 v237, v180, v188, v237
    v_pk_mul_f32 v[132:133], v[132:133], v[236:237] op_sel_hi:[1,0]
    v_pk_mul_f32 v[134:135], v[134:135], v[236:237] op_sel_hi:[1,0]
    v_pk_mul_f32 v[140:141], v[140:141], v[236:237] op_sel_hi:[1,0]
    v_pk_mul_f32 v[142:143], v[142:143], v[236:237] op_sel_hi:[1,0]
    v_pk_mul_f32 v[68:69], v[68:69], v[238:239] op_sel_hi:[1,0]
    v_pk_mul_f32 v[70:71], v[70:71], v[238:239] op_sel_hi:[1,0]
    v_pk_mul_f32 v[76:77], v[76:77], v[238:239] op_sel_hi:[1,0]
    v_pk_mul_f32 v[78:79], v[78:79], v[238:239] op_sel_hi:[1,0]
    v_cvt_pk_bf16_f32 v164, v132, v133
    v_cvt_pk_bf16_f32 v165, v134, v135
    v_cvt_pk_bf16_f32 v166, v140, v141
    v_cvt_pk_bf16_f32 v167, v142, v143
    v_cvt_pk_bf16_f32 v172, v68, v69
    v_cvt_pk_bf16_f32 v173, v70, v71
    v_cvt_pk_bf16_f32 v174, v76, v77
    v_cvt_pk_bf16_f32 v175, v78, v79
    v_mfma_f32_16x16x32_bf16 v[212:215], v[164:167], a[238:241], 0
    v_mfma_f32_16x16x32_bf16 v[216:219], v[164:167], a[236:239], 0
    v_mfma_f32_16x16x32_bf16 v[220:223], v[172:175], a[238:241], 0
    v_mfma_f32_16x16x32_bf16 v[226:229], v[172:175], a[236:239], 0
    s_nop 4
    v_cvt_pk_bf16_f32 v242, v212, v213
    v_cvt_pk_bf16_f32 v243, v214, v215
    v_cvt_pk_bf16_f32 v246, v216, v217
    v_cvt_pk_bf16_f32 v247, v218, v219
    v_cvt_pk_bf16_f32 v250, v220, v221
    v_cvt_pk_bf16_f32 v251, v222, v223
    v_cvt_pk_bf16_f32 v254, v226, v227
    v_cvt_pk_bf16_f32 v255, v228, v229
    v_mfma_f32_16x16x32_bf16 a[80:83], v[248:251], v[144:147], a[80:83]
    v_mfma_f32_16x16x32_bf16 a[84:87], v[248:251], v[152:155], a[84:87]
    v_mfma_f32_16x16x32_bf16 a[96:99], a[232:235], v[248:251], a[96:99]
    v_mfma_f32_16x16x32_bf16 a[88:91], v[252:255], v[144:147], a[88:91]
    v_mfma_f32_16x16x32_bf16 a[92:95], v[252:255], v[152:155], a[92:95]
    v_mfma_f32_16x16x32_bf16 a[100:103], a[232:235], v[252:255], a[100:103]
    v_mfma_f32_16x16x32_bf16 v[192:195], v[240:243], v[144:147], v[192:195]
    v_mfma_f32_16x16x32_bf16 v[196:199], v[240:243], v[152:155], v[196:199]
    v_mfma_f32_16x16x32_bf16 a[104:107], a[232:235], v[240:243], a[104:107]
    v_mfma_f32_16x16x32_bf16 v[200:203], v[244:247], v[144:147], v[200:203]
    v_mfma_f32_16x16x32_bf16 v[204:207], v[244:247], v[152:155], v[204:207]
    v_mfma_f32_16x16x32_bf16 a[108:111], a[232:235], v[244:247], a[108:111]
    v_mfma_f32_16x16x32_bf16 v[84:87], a[224:227], v[96:99], 0
    v_mfma_f32_16x16x32_bf16 v[92:95], a[228:231], v[96:99], 0
    s_nop 6
    v_pk_mul_f32 v[84:85], v[84:85], v[224:225] op_sel_hi:[1,0]
    v_pk_mul_f32 v[86:87], v[86:87], v[224:225] op_sel_hi:[1,0]
    v_pk_mul_f32 v[92:93], v[92:93], v[224:225] op_sel_hi:[1,0]
    v_pk_mul_f32 v[94:95], v[94:95], v[224:225] op_sel_hi:[1,0]
    v_max3_f32 v232, v84, v85, v86
    v_max3_f32 v232, v232, v87, v92
    v_max3_f32 v232, v232, v93, v94
    v_max_f32 v232, v232, v95
    v_mov_b32 v236, v232
    s_nop 1
    v_permlane16_swap_b32 v232, v236
    v_max_f32 v232, v232, v236
    v_mov_b32 v236, v232
    s_nop 1
    v_permlane32_swap_b32 v232, v236
    v_max_f32_e64 v232, v232, v236
    v_min3_f32 v234, v84, v85, v86
    v_min3_f32 v234, v234, v87, v92
    v_min3_f32 v234, v234, v93, v94
    v_min_f32 v234, v234, v95
    v_mov_b32 v236, v234
    s_nop 1
    v_permlane16_swap_b32 v234, v236
    v_min_f32 v234, v234, v236
    v_mov_b32 v236, v234
    s_nop 1
    v_permlane32_swap_b32 v234, v236
    v_min_f32 v234, v234, v236
    v_sub_f32 v116, v84, v232
    v_exp_f32 v116, v116
    v_sub_f32 v84, v234, v84
    v_exp_f32 v84, v84
    v_sub_f32 v117, v85, v232
    v_exp_f32 v117, v117
    v_sub_f32 v85, v234, v85
    v_exp_f32 v85, v85
    v_sub_f32 v118, v86, v232
    v_exp_f32 v118, v118
    v_sub_f32 v86, v234, v86
    v_exp_f32 v86, v86
    v_sub_f32 v119, v87, v232
    v_exp_f32 v119, v119
    v_sub_f32 v87, v234, v87
    v_exp_f32 v87, v87
    v_sub_f32 v124, v92, v232
    v_exp_f32 v124, v124
    v_sub_f32 v92, v234, v92
    v_exp_f32 v92, v92
    v_sub_f32 v125, v93, v232
    v_exp_f32 v125, v125
    v_sub_f32 v93, v234, v93
    v_exp_f32 v93, v93
    v_sub_f32 v126, v94, v232
    v_exp_f32 v126, v126
    v_sub_f32 v94, v234, v94
    v_exp_f32 v94, v94
    v_sub_f32 v127, v95, v232
    v_exp_f32 v127, v127
    v_sub_f32 v95, v234, v95
    v_exp_f32_e64 v95, v95
    v_cvt_pk_bf16_f32 v148, v116, v117
    v_cvt_pk_bf16_f32 v149, v118, v119
    v_cvt_pk_bf16_f32 v150, v124, v125
    v_cvt_pk_bf16_f32 v151, v126, v127
    s_nop 1
    v_mfma_f32_16x16x32_bf16 v[180:183], a[232:235], v[148:151], 0
    v_cvt_pk_bf16_f32 v156, v84, v85
    v_cvt_pk_bf16_f32 v157, v86, v87
    v_cvt_pk_bf16_f32 v158, v92, v93
    v_cvt_pk_bf16_f32 v159, v94, v95
    s_nop 1
    v_mfma_f32_16x16x32_bf16 v[188:191], a[232:235], v[156:159], 0
    s_nop 0
    v_rcp_f32 v232, v180
    s_nop 5
    v_rcp_f32 v234, v188
    v_max3_f32 v237, v180, v188, v237
    v_pk_mul_f32 v[116:117], v[116:117], v[232:233] op_sel_hi:[1,0]
    v_pk_mul_f32 v[118:119], v[118:119], v[232:233] op_sel_hi:[1,0]
    v_pk_mul_f32 v[124:125], v[124:125], v[232:233] op_sel_hi:[1,0]
    v_pk_mul_f32 v[126:127], v[126:127], v[232:233] op_sel_hi:[1,0]
    v_pk_mul_f32 v[84:85], v[84:85], v[234:235] op_sel_hi:[1,0]
    v_pk_mul_f32 v[86:87], v[86:87], v[234:235] op_sel_hi:[1,0]
    v_pk_mul_f32 v[92:93], v[92:93], v[234:235] op_sel_hi:[1,0]
    v_pk_mul_f32 v[94:95], v[94:95], v[234:235] op_sel_hi:[1,0]
    v_cvt_pk_bf16_f32 v148, v116, v117
    v_cvt_pk_bf16_f32 v149, v118, v119
    v_cvt_pk_bf16_f32 v150, v124, v125
    v_cvt_pk_bf16_f32 v151, v126, v127
    v_cvt_pk_bf16_f32 v156, v84, v85
    v_cvt_pk_bf16_f32 v157, v86, v87
    v_cvt_pk_bf16_f32 v158, v92, v93
    v_cvt_pk_bf16_f32 v159, v94, v95
    v_mfma_f32_16x16x32_bf16 v[212:215], v[148:151], a[238:241], 0
    v_mfma_f32_16x16x32_bf16 v[216:219], v[148:151], a[236:239], 0
    v_mfma_f32_16x16x32_bf16 v[220:223], v[156:159], a[238:241], 0
    v_mfma_f32_16x16x32_bf16 v[226:229], v[156:159], a[236:239], 0
    s_nop 4
    v_cvt_pk_bf16_f32 v240, v212, v213
    v_cvt_pk_bf16_f32 v241, v214, v215
    v_cvt_pk_bf16_f32 v244, v216, v217
    v_cvt_pk_bf16_f32 v245, v218, v219
    v_cvt_pk_bf16_f32 v248, v220, v221
    v_cvt_pk_bf16_f32 v249, v222, v223
    v_cvt_pk_bf16_f32 v252, v226, v227
    v_cvt_pk_bf16_f32 v253, v228, v229
    v_mfma_f32_16x16x32_bf16 v[100:103], a[224:227], v[104:107], 0
    v_mfma_f32_16x16x32_bf16 v[108:111], a[228:231], v[104:107], 0
    s_nop 6
    v_pk_mul_f32 v[100:101], v[100:101], v[224:225] op_sel_hi:[1,0]
    v_pk_mul_f32 v[102:103], v[102:103], v[224:225] op_sel_hi:[1,0]
    v_pk_mul_f32 v[108:109], v[108:109], v[224:225] op_sel_hi:[1,0]
    v_pk_mul_f32 v[110:111], v[110:111], v[224:225] op_sel_hi:[1,0]
    v_max3_f32 v232, v100, v101, v102
    v_max3_f32 v232, v232, v103, v108
    v_max3_f32 v232, v232, v109, v110
    v_max_f32 v232, v232, v111
    v_mov_b32 v236, v232
    s_nop 1
    v_permlane16_swap_b32 v232, v236
    v_max_f32 v232, v232, v236
    v_mov_b32 v236, v232
    s_nop 1
    v_permlane32_swap_b32 v232, v236
    v_max_f32_e64 v232, v232, v236
    v_min3_f32 v234, v100, v101, v102
    v_min3_f32 v234, v234, v103, v108
    v_min3_f32 v234, v234, v109, v110
    v_min_f32 v234, v234, v111
    v_mov_b32 v236, v234
    s_nop 1
    v_permlane16_swap_b32 v234, v236
    v_min_f32 v234, v234, v236
    v_mov_b32 v236, v234
    s_nop 1
    v_permlane32_swap_b32 v234, v236
    v_min_f32 v234, v234, v236
    v_sub_f32 v132, v100, v232
    v_exp_f32 v132, v132
    v_sub_f32 v100, v234, v100
    v_exp_f32 v100, v100
    v_sub_f32 v133, v101, v232
    v_exp_f32 v133, v133
    v_sub_f32 v101, v234, v101
    v_exp_f32 v101, v101
    v_sub_f32 v134, v102, v232
    v_exp_f32 v134, v134
    v_sub_f32 v102, v234, v102
    v_exp_f32 v102, v102
    v_sub_f32 v135, v103, v232
    v_exp_f32 v135, v135
    v_sub_f32 v103, v234, v103
    v_exp_f32 v103, v103
    v_sub_f32 v140, v108, v232
    v_exp_f32 v140, v140
    v_sub_f32 v108, v234, v108
    v_exp_f32 v108, v108
    v_sub_f32 v141, v109, v232
    v_exp_f32 v141, v141
    v_sub_f32 v109, v234, v109
    v_exp_f32 v109, v109
    v_sub_f32 v142, v110, v232
    v_exp_f32 v142, v142
    v_sub_f32 v110, v234, v110
    v_exp_f32 v110, v110
    v_sub_f32 v143, v111, v232
    v_exp_f32 v143, v143
    v_sub_f32 v111, v234, v111
    v_exp_f32_e64 v111, v111
    v_cvt_pk_bf16_f32 v164, v132, v133
    v_cvt_pk_bf16_f32 v165, v134, v135
    v_cvt_pk_bf16_f32 v166, v140, v141
    v_cvt_pk_bf16_f32 v167, v142, v143
    s_nop 1
    v_mfma_f32_16x16x32_bf16 v[180:183], a[232:235], v[164:167], 0
    v_cvt_pk_bf16_f32 v172, v100, v101
    v_cvt_pk_bf16_f32 v173, v102, v103
    v_cvt_pk_bf16_f32 v174, v108, v109
    v_cvt_pk_bf16_f32 v175, v110, v111
    s_nop 1
    v_mfma_f32_16x16x32_bf16 v[188:191], a[232:235], v[172:175], 0
    s_nop 0
    v_rcp_f32 v236, v180
    s_nop 5
    v_rcp_f32 v238, v188
    v_max3_f32 v237, v180, v188, v237
    v_pk_mul_f32 v[132:133], v[132:133], v[236:237] op_sel_hi:[1,0]
    v_pk_mul_f32 v[134:135], v[134:135], v[236:237] op_sel_hi:[1,0]
    v_pk_mul_f32 v[140:141], v[140:141], v[236:237] op_sel_hi:[1,0]
    v_pk_mul_f32 v[142:143], v[142:143], v[236:237] op_sel_hi:[1,0]
    v_pk_mul_f32 v[100:101], v[100:101], v[238:239] op_sel_hi:[1,0]
    v_pk_mul_f32 v[102:103], v[102:103], v[238:239] op_sel_hi:[1,0]
    v_pk_mul_f32 v[108:109], v[108:109], v[238:239] op_sel_hi:[1,0]
    v_pk_mul_f32 v[110:111], v[110:111], v[238:239] op_sel_hi:[1,0]
    v_cvt_pk_bf16_f32 v164, v132, v133
    v_cvt_pk_bf16_f32 v165, v134, v135
    v_cvt_pk_bf16_f32 v166, v140, v141
    v_cvt_pk_bf16_f32 v167, v142, v143
    v_cvt_pk_bf16_f32 v172, v100, v101
    v_cvt_pk_bf16_f32 v173, v102, v103
    v_cvt_pk_bf16_f32 v174, v108, v109
    v_cvt_pk_bf16_f32 v175, v110, v111
    v_mfma_f32_16x16x32_bf16 v[212:215], v[164:167], a[238:241], 0
    v_mfma_f32_16x16x32_bf16 v[216:219], v[164:167], a[236:239], 0
    v_mfma_f32_16x16x32_bf16 v[220:223], v[172:175], a[238:241], 0
    v_mfma_f32_16x16x32_bf16 v[226:229], v[172:175], a[236:239], 0
    s_nop 4
    v_cvt_pk_bf16_f32 v242, v212, v213
    v_cvt_pk_bf16_f32 v243, v214, v215
    v_cvt_pk_bf16_f32 v246, v216, v217
    v_cvt_pk_bf16_f32 v247, v218, v219
    v_cvt_pk_bf16_f32 v250, v220, v221
    v_cvt_pk_bf16_f32 v251, v222, v223
    v_cvt_pk_bf16_f32 v254, v226, v227
    v_cvt_pk_bf16_f32 v255, v228, v229
    v_mfma_f32_16x16x32_bf16 a[80:83], v[248:251], v[160:163], a[80:83]
    v_mfma_f32_16x16x32_bf16 a[84:87], v[248:251], v[168:171], a[84:87]
    v_mfma_f32_16x16x32_bf16 a[96:99], a[232:235], v[248:251], a[96:99]
    v_mfma_f32_16x16x32_bf16 a[88:91], v[252:255], v[160:163], a[88:91]
    v_mfma_f32_16x16x32_bf16 a[92:95], v[252:255], v[168:171], a[92:95]
    v_mfma_f32_16x16x32_bf16 a[100:103], a[232:235], v[252:255], a[100:103]
    v_mfma_f32_16x16x32_bf16 v[192:195], v[240:243], v[160:163], v[192:195]
    v_mfma_f32_16x16x32_bf16 v[196:199], v[240:243], v[168:171], v[196:199]
    v_mfma_f32_16x16x32_bf16 a[104:107], a[232:235], v[240:243], a[104:107]
    v_mfma_f32_16x16x32_bf16 v[200:203], v[244:247], v[160:163], v[200:203]
    v_mfma_f32_16x16x32_bf16 v[204:207], v[244:247], v[168:171], v[204:207]
    v_mfma_f32_16x16x32_bf16 a[108:111], a[232:235], v[244:247], a[108:111]
    v_mfma_f32_16x16x32_bf16 v[68:71], a[224:227], v[112:115], 0
    v_mfma_f32_16x16x32_bf16 v[76:79], a[228:231], v[112:115], 0
    s_nop 6
    v_pk_mul_f32 v[68:69], v[68:69], v[224:225] op_sel_hi:[1,0]
    v_pk_mul_f32 v[70:71], v[70:71], v[224:225] op_sel_hi:[1,0]
    v_pk_mul_f32 v[76:77], v[76:77], v[224:225] op_sel_hi:[1,0]
    v_pk_mul_f32 v[78:79], v[78:79], v[224:225] op_sel_hi:[1,0]
    v_max3_f32 v232, v68, v69, v70
    v_max3_f32 v232, v232, v71, v76
    v_max3_f32 v232, v232, v77, v78
    v_max_f32 v232, v232, v79
    v_mov_b32 v236, v232
    s_nop 1
    v_permlane16_swap_b32 v232, v236
    v_max_f32 v232, v232, v236
    v_mov_b32 v236, v232
    s_nop 1
    v_permlane32_swap_b32 v232, v236
    v_max_f32_e64 v232, v232, v236
    v_min3_f32 v234, v68, v69, v70
    v_min3_f32 v234, v234, v71, v76
    v_min3_f32 v234, v234, v77, v78
    v_min_f32 v234, v234, v79
    v_mov_b32 v236, v234
    s_nop 1
    v_permlane16_swap_b32 v234, v236
    v_min_f32 v234, v234, v236
    v_mov_b32 v236, v234
    s_nop 1
    v_permlane32_swap_b32 v234, v236
    v_min_f32 v234, v234, v236
    v_sub_f32 v116, v68, v232
    v_exp_f32 v116, v116
    v_sub_f32 v68, v234, v68
    v_exp_f32 v68, v68
    v_sub_f32 v117, v69, v232
    v_exp_f32 v117, v117
    v_sub_f32 v69, v234, v69
    v_exp_f32 v69, v69
    v_sub_f32 v118, v70, v232
    v_exp_f32 v118, v118
    v_sub_f32 v70, v234, v70
    v_exp_f32 v70, v70
    v_sub_f32 v119, v71, v232
    v_exp_f32 v119, v119
    v_sub_f32 v71, v234, v71
    v_exp_f32 v71, v71
    v_sub_f32 v124, v76, v232
    v_exp_f32 v124, v124
    v_sub_f32 v76, v234, v76
    v_exp_f32 v76, v76
    v_sub_f32 v125, v77, v232
    v_exp_f32 v125, v125
    v_sub_f32 v77, v234, v77
    v_exp_f32 v77, v77
    v_sub_f32 v126, v78, v232
    v_exp_f32 v126, v126
    v_sub_f32 v78, v234, v78
    v_exp_f32 v78, v78
    v_sub_f32 v127, v79, v232
    v_exp_f32 v127, v127
    v_sub_f32 v79, v234, v79
    v_exp_f32_e64 v79, v79
    v_cvt_pk_bf16_f32 v148, v116, v117
    v_cvt_pk_bf16_f32 v149, v118, v119
    v_cvt_pk_bf16_f32 v150, v124, v125
    v_cvt_pk_bf16_f32 v151, v126, v127
    s_nop 1
    v_mfma_f32_16x16x32_bf16 v[180:183], a[232:235], v[148:151], 0
    v_cvt_pk_bf16_f32 v156, v68, v69
    v_cvt_pk_bf16_f32 v157, v70, v71
    v_cvt_pk_bf16_f32 v158, v76, v77
    v_cvt_pk_bf16_f32 v159, v78, v79
    s_nop 1
    v_mfma_f32_16x16x32_bf16 v[188:191], a[232:235], v[156:159], 0
    s_nop 0
    v_rcp_f32 v232, v180
    s_nop 5
    v_rcp_f32 v234, v188
    v_max3_f32 v237, v180, v188, v237
    v_pk_mul_f32 v[116:117], v[116:117], v[232:233] op_sel_hi:[1,0]
    v_pk_mul_f32 v[118:119], v[118:119], v[232:233] op_sel_hi:[1,0]
    v_pk_mul_f32 v[124:125], v[124:125], v[232:233] op_sel_hi:[1,0]
    v_pk_mul_f32 v[126:127], v[126:127], v[232:233] op_sel_hi:[1,0]
    v_pk_mul_f32 v[68:69], v[68:69], v[234:235] op_sel_hi:[1,0]
    v_pk_mul_f32 v[70:71], v[70:71], v[234:235] op_sel_hi:[1,0]
    v_pk_mul_f32 v[76:77], v[76:77], v[234:235] op_sel_hi:[1,0]
    v_pk_mul_f32 v[78:79], v[78:79], v[234:235] op_sel_hi:[1,0]
    v_cvt_pk_bf16_f32 v148, v116, v117
    v_cvt_pk_bf16_f32 v149, v118, v119
    v_cvt_pk_bf16_f32 v150, v124, v125
    v_cvt_pk_bf16_f32 v151, v126, v127
    v_cvt_pk_bf16_f32 v156, v68, v69
    v_cvt_pk_bf16_f32 v157, v70, v71
    v_cvt_pk_bf16_f32 v158, v76, v77
    v_cvt_pk_bf16_f32 v159, v78, v79
    v_mfma_f32_16x16x32_bf16 v[212:215], v[148:151], a[238:241], 0
    v_mfma_f32_16x16x32_bf16 v[216:219], v[148:151], a[236:239], 0
    v_mfma_f32_16x16x32_bf16 v[220:223], v[156:159], a[238:241], 0
    v_mfma_f32_16x16x32_bf16 v[226:229], v[156:159], a[236:239], 0
    s_nop 4
    v_cvt_pk_bf16_f32 v240, v212, v213
    v_cvt_pk_bf16_f32 v241, v214, v215
    v_cvt_pk_bf16_f32 v244, v216, v217
    v_cvt_pk_bf16_f32 v245, v218, v219
    v_cvt_pk_bf16_f32 v248, v220, v221
    v_cvt_pk_bf16_f32 v249, v222, v223
    v_cvt_pk_bf16_f32 v252, v226, v227
    v_cvt_pk_bf16_f32 v253, v228, v229
    v_mfma_f32_16x16x32_bf16 v[84:87], a[224:227], v[120:123], 0
    v_mfma_f32_16x16x32_bf16 v[92:95], a[228:231], v[120:123], 0
    s_nop 6
    v_pk_mul_f32 v[84:85], v[84:85], v[224:225] op_sel_hi:[1,0]
    v_pk_mul_f32 v[86:87], v[86:87], v[224:225] op_sel_hi:[1,0]
    v_pk_mul_f32 v[92:93], v[92:93], v[224:225] op_sel_hi:[1,0]
    v_pk_mul_f32 v[94:95], v[94:95], v[224:225] op_sel_hi:[1,0]
    v_max3_f32 v232, v84, v85, v86
    v_max3_f32 v232, v232, v87, v92
    v_max3_f32 v232, v232, v93, v94
    v_max_f32 v232, v232, v95
    v_mov_b32 v236, v232
    s_nop 1
    v_permlane16_swap_b32 v232, v236
    v_max_f32 v232, v232, v236
    v_mov_b32 v236, v232
    s_nop 1
    v_permlane32_swap_b32 v232, v236
    v_max_f32_e64 v232, v232, v236
    v_min3_f32 v234, v84, v85, v86
    v_min3_f32 v234, v234, v87, v92
    v_min3_f32 v234, v234, v93, v94
    v_min_f32 v234, v234, v95
    v_mov_b32 v236, v234
    s_nop 1
    v_permlane16_swap_b32 v234, v236
    v_min_f32 v234, v234, v236
    v_mov_b32 v236, v234
    s_nop 1
    v_permlane32_swap_b32 v234, v236
    v_min_f32 v234, v234, v236
    v_sub_f32 v132, v84, v232
    v_exp_f32 v132, v132
    v_sub_f32 v84, v234, v84
    v_exp_f32 v84, v84
    v_sub_f32 v133, v85, v232
    v_exp_f32 v133, v133
    v_sub_f32 v85, v234, v85
    v_exp_f32 v85, v85
    v_sub_f32 v134, v86, v232
    v_exp_f32 v134, v134
    v_sub_f32 v86, v234, v86
    v_exp_f32 v86, v86
    v_sub_f32 v135, v87, v232
    v_exp_f32 v135, v135
    v_sub_f32 v87, v234, v87
    v_exp_f32 v87, v87
    v_sub_f32 v140, v92, v232
    v_exp_f32 v140, v140
    v_sub_f32 v92, v234, v92
    v_exp_f32 v92, v92
    v_sub_f32 v141, v93, v232
    v_exp_f32 v141, v141
    v_sub_f32 v93, v234, v93
    v_exp_f32 v93, v93
    v_sub_f32 v142, v94, v232
    v_exp_f32 v142, v142
    v_sub_f32 v94, v234, v94
    v_exp_f32 v94, v94
    v_sub_f32 v143, v95, v232
    v_exp_f32 v143, v143
    v_sub_f32 v95, v234, v95
    v_exp_f32_e64 v95, v95
    v_cvt_pk_bf16_f32 v164, v132, v133
    v_cvt_pk_bf16_f32 v165, v134, v135
    v_cvt_pk_bf16_f32 v166, v140, v141
    v_cvt_pk_bf16_f32 v167, v142, v143
    s_nop 1
    v_mfma_f32_16x16x32_bf16 v[180:183], a[232:235], v[164:167], 0
    v_cvt_pk_bf16_f32 v172, v84, v85
    v_cvt_pk_bf16_f32 v173, v86, v87
    v_cvt_pk_bf16_f32 v174, v92, v93
    v_cvt_pk_bf16_f32 v175, v94, v95
    s_nop 1
    v_mfma_f32_16x16x32_bf16 v[188:191], a[232:235], v[172:175], 0
    s_nop 0
    v_rcp_f32 v236, v180
    s_nop 5
    v_rcp_f32 v238, v188
    v_max3_f32 v237, v180, v188, v237
    v_pk_mul_f32 v[132:133], v[132:133], v[236:237] op_sel_hi:[1,0]
    v_pk_mul_f32 v[134:135], v[134:135], v[236:237] op_sel_hi:[1,0]
    v_pk_mul_f32 v[140:141], v[140:141], v[236:237] op_sel_hi:[1,0]
    v_pk_mul_f32 v[142:143], v[142:143], v[236:237] op_sel_hi:[1,0]
    v_pk_mul_f32 v[84:85], v[84:85], v[238:239] op_sel_hi:[1,0]
    v_pk_mul_f32 v[86:87], v[86:87], v[238:239] op_sel_hi:[1,0]
    v_pk_mul_f32 v[92:93], v[92:93], v[238:239] op_sel_hi:[1,0]
    v_pk_mul_f32 v[94:95], v[94:95], v[238:239] op_sel_hi:[1,0]
    v_cvt_pk_bf16_f32 v164, v132, v133
    v_cvt_pk_bf16_f32 v165, v134, v135
    v_cvt_pk_bf16_f32 v166, v140, v141
    v_cvt_pk_bf16_f32 v167, v142, v143
    v_cvt_pk_bf16_f32 v172, v84, v85
    v_cvt_pk_bf16_f32 v173, v86, v87
    v_cvt_pk_bf16_f32 v174, v92, v93
    v_cvt_pk_bf16_f32 v175, v94, v95
    v_mfma_f32_16x16x32_bf16 v[212:215], v[164:167], a[238:241], 0
    v_mfma_f32_16x16x32_bf16 v[216:219], v[164:167], a[236:239], 0
    v_mfma_f32_16x16x32_bf16 v[220:223], v[172:175], a[238:241], 0
    v_mfma_f32_16x16x32_bf16 v[226:229], v[172:175], a[236:239], 0
    s_nop 4
    v_cvt_pk_bf16_f32 v242, v212, v213
    v_cvt_pk_bf16_f32 v243, v214, v215
    v_cvt_pk_bf16_f32 v246, v216, v217
    v_cvt_pk_bf16_f32 v247, v218, v219
    v_cvt_pk_bf16_f32 v250, v220, v221
    v_cvt_pk_bf16_f32 v251, v222, v223
    v_cvt_pk_bf16_f32 v254, v226, v227
    v_cvt_pk_bf16_f32 v255, v228, v229
    v_mfma_f32_16x16x32_bf16 a[80:83], v[248:251], v[176:179], a[80:83]
    v_mfma_f32_16x16x32_bf16 a[84:87], v[248:251], v[184:187], a[84:87]
    v_mfma_f32_16x16x32_bf16 a[96:99], a[232:235], v[248:251], a[96:99]
    v_mfma_f32_16x16x32_bf16 a[88:91], v[252:255], v[176:179], a[88:91]
    v_mfma_f32_16x16x32_bf16 a[92:95], v[252:255], v[184:187], a[92:95]
    v_mfma_f32_16x16x32_bf16 a[100:103], a[232:235], v[252:255], a[100:103]
    v_mfma_f32_16x16x32_bf16 v[192:195], v[240:243], v[176:179], v[192:195]
    v_mfma_f32_16x16x32_bf16 v[196:199], v[240:243], v[184:187], v[196:199]
    v_mfma_f32_16x16x32_bf16 a[104:107], a[232:235], v[240:243], a[104:107]
    v_mfma_f32_16x16x32_bf16 v[200:203], v[244:247], v[176:179], v[200:203]
    v_mfma_f32_16x16x32_bf16 v[204:207], v[244:247], v[184:187], v[204:207]
    v_mfma_f32_16x16x32_bf16 a[108:111], a[232:235], v[244:247], a[108:111]
    s_lshl_b32 s3, s24, 14
    s_xor_b32 s4, s3, 32768
    v_add_u32 v248, s3, v233
    v_add_u32 v249, s4, v233
    v_lshlrev_b32 v250, 3, v209
    v_add_u32 v251, s4, v250
    v_add_u32_e64 v250, s3, v250
    ds_write_b128 v248, a[80:83] offset:0
    ds_write_b128 v248, a[84:87] offset:1024
    ds_write_b128 v248, a[88:91] offset:2048
    ds_write_b128 v248, a[92:95] offset:3072
    ds_write2st64_b32 v250, a96, a100 offset0:16 offset1:18
    s_waitcnt lgkmcnt(0)
    s_barrier
    ds_read_b128 v[212:215], v249 offset:0
    ds_read_b128 v[216:219], v249 offset:1024
    ds_read_b128 v[220:223], v249 offset:2048
    ds_read_b128 v[226:229], v249 offset:3072
    ds_read2st64_b32 v[252:253], v251 offset0:16 offset1:18
    s_waitcnt lgkmcnt(4)
    v_pk_add_f32 v[192:193], v[192:193], v[212:213]
    v_pk_add_f32 v[194:195], v[194:195], v[214:215]
    s_waitcnt lgkmcnt(2)
    v_pk_add_f32 v[200:201], v[200:201], v[220:221]
    v_pk_add_f32 v[202:203], v[202:203], v[222:223]
    v_cvt_pk_bf16_f32 v240, v192, v193
    v_cvt_pk_bf16_f32 v241, v194, v195
    v_cvt_pk_bf16_f32 v242, v200, v201
    v_cvt_pk_bf16_f32 v243, v202, v203
    buffer_store_dwordx4 v[240:243], v233, s[16:19], s42 offen offset:0 sc1
    v_pk_add_f32 v[196:197], v[196:197], v[216:217]
    v_pk_add_f32 v[198:199], v[198:199], v[218:219]
    s_waitcnt lgkmcnt(1)
    v_pk_add_f32 v[204:205], v[204:205], v[226:227]
    v_pk_add_f32 v[206:207], v[206:207], v[228:229]
    v_cvt_pk_bf16_f32 v244, v196, v197
    v_cvt_pk_bf16_f32 v245, v198, v199
    v_cvt_pk_bf16_f32 v246, v204, v205
    v_cvt_pk_bf16_f32 v247, v206, v207
    buffer_store_dwordx4 v[244:247], v233, s[16:19], s42 offen offset:1024 sc1
    v_accvgpr_read_b32 v230, a104
    v_accvgpr_read_b32 v231, a108
    s_waitcnt lgkmcnt(0)
    v_add_f32 v252, v252, v230
    v_add_f32 v253, v253, v231
    v_cvt_pk_bf16_f32 v252, v252, v253
    buffer_store_dword v252, v239, s[16:19], s22 offen sc1
    v_accvgpr_write_b32 a255, v252
    v_lshrrev_b32 v254, 4, v209
    s_nop 1
    v_lshl_add_u32 v239, v254, 6, v239
    buffer_load_dword a250, v239, s[16:19], s43 offen sc1
    buffer_load_dword a251, v239, s[16:19], s43 offen offset:256 sc1
    s_add_u32 s97, s31, 1
    s_and_b32 s97, s97, 7
    s_lshl_b32 s97, s97, 13
    s_add_u32 s97, s97, s41
    buffer_load_dwordx4 a[192:195], v233, s[16:19], s97 offen offset:0 sc1
    buffer_load_dwordx4 a[196:199], v233, s[16:19], s97 offen offset:1024 sc1
    s_add_u32 s96, s31, 2
    s_and_b32 s96, s96, 7
    s_lshl_b32 s96, s96, 13
    s_add_u32 s96, s96, s41
    buffer_load_dwordx4 a[200:203], v233, s[16:19], s96 offen offset:0 sc1
    buffer_load_dwordx4 a[204:207], v233, s[16:19], s96 offen offset:1024 sc1
    s_add_u32 s97, s31, 3
    s_and_b32 s97, s97, 7
    s_lshl_b32 s97, s97, 13
    s_add_u32 s97, s97, s41
    buffer_load_dwordx4 a[208:211], v233, s[16:19], s97 offen offset:0 sc1
    buffer_load_dwordx4 a[212:215], v233, s[16:19], s97 offen offset:1024 sc1
    s_add_u32 s96, s31, 4
    s_and_b32 s96, s96, 7
    s_lshl_b32 s96, s96, 13
    s_add_u32 s96, s96, s41
    buffer_load_dwordx4 a[216:219], v233, s[16:19], s96 offen offset:0 sc1
    buffer_load_dwordx4 a[220:223], v233, s[16:19], s96 offen offset:1024 sc1
    s_add_u32 s97, s31, 5
    s_and_b32 s97, s97, 7
    s_lshl_b32 s97, s97, 13
    s_add_u32 s97, s97, s41
    buffer_load_dwordx4 a[80:83], v233, s[16:19], s97 offen offset:0 sc1
    buffer_load_dwordx4 a[84:87], v233, s[16:19], s97 offen offset:1024 sc1
    s_add_u32 s96, s31, 6
    s_and_b32 s96, s96, 7
    s_lshl_b32 s96, s96, 13
    s_add_u32 s96, s96, s41
    buffer_load_dwordx4 a[88:91], v233, s[16:19], s96 offen offset:0 sc1
    buffer_load_dwordx4 a[92:95], v233, s[16:19], s96 offen offset:1024 sc1
    s_add_u32 s97, s31, 7
    s_and_b32 s97, s97, 7
    s_lshl_b32 s97, s97, 13
    s_add_u32 s97, s97, s41
    buffer_load_dwordx4 a[96:99], v233, s[16:19], s97 offen offset:0 sc1
    buffer_load_dwordx4 a[100:103], v233, s[16:19], s97 offen offset:1024 sc1
    v_mov_b32 v248, 889599933
    v_mov_b32 v249, 889599933
    v_mov_b32 v250, 889599933
    v_mov_b32 v251, 889599933
    v_mov_b32 v252, 889599933
    v_mov_b32 v253, 889599933
    v_mov_b32 v254, 889599933
    v_mov_b32 v255, 889599933
    s_waitcnt vmcnt(14)
    v_mfma_f32_16x16x32_bf16 v[248:251], a[250:253], a[242:245], v[248:251]
    v_mfma_f32_16x16x32_bf16 v[252:255], a[250:253], a[246:249], v[252:255]
    s_waitcnt vmcnt(13)
    v_mfma_f32_16x16x32_bf16 v[212:215], a[238:241], a[192:195], v[192:195]
    v_mfma_f32_16x16x32_bf16 v[220:223], a[236:239], a[192:195], v[200:203]
    s_waitcnt vmcnt(12)
    v_mfma_f32_16x16x32_bf16 v[216:219], a[238:241], a[196:199], v[196:199]
    v_mfma_f32_16x16x32_bf16 v[226:229], a[236:239], a[196:199], v[204:207]
    s_waitcnt vmcnt(11)
    v_mfma_f32_16x16x32_bf16 v[212:215], a[238:241], a[200:203], v[212:215]
    v_mfma_f32_16x16x32_bf16 v[220:223], a[236:239], a[200:203], v[220:223]
    s_waitcnt vmcnt(10)
    v_mfma_f32_16x16x32_bf16 v[216:219], a[238:241], a[204:207], v[216:219]
    v_mfma_f32_16x16x32_bf16 v[226:229], a[236:239], a[204:207], v[226:229]
    s_waitcnt vmcnt(9)
    v_mfma_f32_16x16x32_bf16 v[212:215], a[238:241], a[208:211], v[212:215]
    v_mfma_f32_16x16x32_bf16 v[220:223], a[236:239], a[208:211], v[220:223]
    s_waitcnt vmcnt(8)
    v_mfma_f32_16x16x32_bf16 v[216:219], a[238:241], a[212:215], v[216:219]
    v_mfma_f32_16x16x32_bf16 v[226:229], a[236:239], a[212:215], v[226:229]
    s_waitcnt vmcnt(7)
    v_mfma_f32_16x16x32_bf16 v[212:215], a[238:241], a[216:219], v[212:215]
    v_mfma_f32_16x16x32_bf16 v[220:223], a[236:239], a[216:219], v[220:223]
    s_waitcnt vmcnt(6)
    v_mfma_f32_16x16x32_bf16 v[216:219], a[238:241], a[220:223], v[216:219]
    v_mfma_f32_16x16x32_bf16 v[226:229], a[236:239], a[220:223], v[226:229]
    s_waitcnt vmcnt(5)
    v_mfma_f32_16x16x32_bf16 v[212:215], a[238:241], a[80:83], v[212:215]
    v_mfma_f32_16x16x32_bf16 v[220:223], a[236:239], a[80:83], v[220:223]
    s_waitcnt vmcnt(4)
    v_mfma_f32_16x16x32_bf16 v[216:219], a[238:241], a[84:87], v[216:219]
    v_mfma_f32_16x16x32_bf16 v[226:229], a[236:239], a[84:87], v[226:229]
    s_waitcnt vmcnt(3)
    v_mfma_f32_16x16x32_bf16 v[212:215], a[238:241], a[88:91], v[212:215]
    v_mfma_f32_16x16x32_bf16 v[220:223], a[236:239], a[88:91], v[220:223]
    s_waitcnt vmcnt(2)
    v_mfma_f32_16x16x32_bf16 v[216:219], a[238:241], a[92:95], v[216:219]
    v_mfma_f32_16x16x32_bf16 v[226:229], a[236:239], a[92:95], v[226:229]
    s_waitcnt vmcnt(1)
    v_mfma_f32_16x16x32_bf16 v[212:215], a[238:241], a[96:99], v[212:215]
    v_mfma_f32_16x16x32_bf16 v[220:223], a[236:239], a[96:99], v[220:223]
    s_waitcnt vmcnt(0)
    v_mfma_f32_16x16x32_bf16 v[216:219], a[238:241], a[100:103], v[216:219]
    v_mfma_f32_16x16x32_bf16 v[226:229], a[236:239], a[100:103], v[226:229]
    v_mfma_f32_16x16x32_bf16 v[0:3], a[64:67], a[0:3], v[0:3]
    v_mfma_f32_16x16x32_bf16 v[0:3], a[68:71], a[4:7], v[0:3]
    v_mfma_f32_16x16x32_bf16 v[0:3], a[176:179], a[112:115], v[0:3]
    v_mfma_f32_16x16x32_bf16 v[0:3], a[180:183], a[116:119], v[0:3]
    v_mfma_f32_16x16x32_bf16 v[4:7], a[72:75], a[0:3], v[4:7]
    v_mfma_f32_16x16x32_bf16 v[4:7], a[76:79], a[4:7], v[4:7]
    v_mfma_f32_16x16x32_bf16 v[4:7], a[184:187], a[112:115], v[4:7]
    v_mfma_f32_16x16x32_bf16 v[4:7], a[188:191], a[116:119], v[4:7]
    s_nop 3
    v_cvt_pk_bf16_f32 v0, v0, v1
    v_cvt_pk_bf16_f32 v1, v2, v3
    s_nop 1
    v_cvt_pk_bf16_f32 v2, v4, v5
    v_cvt_pk_bf16_f32 v3, v6, v7
    v_mfma_f32_16x16x32_bf16 v[8:11], a[64:67], a[8:11], v[8:11]
    v_mfma_f32_16x16x32_bf16 v[8:11], a[68:71], a[12:15], v[8:11]
    v_mfma_f32_16x16x32_bf16 v[8:11], a[176:179], a[120:123], v[8:11]
    v_mfma_f32_16x16x32_bf16 v[8:11], a[180:183], a[124:127], v[8:11]
    v_mfma_f32_16x16x32_bf16 v[12:15], a[72:75], a[8:11], v[12:15]
    v_mfma_f32_16x16x32_bf16 v[12:15], a[76:79], a[12:15], v[12:15]
    v_mfma_f32_16x16x32_bf16 v[12:15], a[184:187], a[120:123], v[12:15]
    v_mfma_f32_16x16x32_bf16 v[12:15], a[188:191], a[124:127], v[12:15]
    s_nop 3
    v_cvt_pk_bf16_f32 v8, v8, v9
    v_cvt_pk_bf16_f32 v9, v10, v11
    s_nop 1
    v_cvt_pk_bf16_f32 v10, v12, v13
    v_cvt_pk_bf16_f32 v11, v14, v15
    v_mfma_f32_16x16x32_bf16 v[16:19], a[64:67], a[16:19], v[16:19]
    v_mfma_f32_16x16x32_bf16 v[16:19], a[68:71], a[20:23], v[16:19]
    v_mfma_f32_16x16x32_bf16 v[16:19], a[176:179], a[128:131], v[16:19]
    v_mfma_f32_16x16x32_bf16 v[16:19], a[180:183], a[132:135], v[16:19]
    v_mfma_f32_16x16x32_bf16 v[20:23], a[72:75], a[16:19], v[20:23]
    v_mfma_f32_16x16x32_bf16 v[20:23], a[76:79], a[20:23], v[20:23]
    v_mfma_f32_16x16x32_bf16 v[20:23], a[184:187], a[128:131], v[20:23]
    v_mfma_f32_16x16x32_bf16 v[20:23], a[188:191], a[132:135], v[20:23]
    s_nop 3
    v_cvt_pk_bf16_f32 v16, v16, v17
    v_cvt_pk_bf16_f32 v17, v18, v19
    s_nop 1
    v_cvt_pk_bf16_f32 v18, v20, v21
    v_cvt_pk_bf16_f32 v19, v22, v23
    v_mfma_f32_16x16x32_bf16 v[24:27], a[64:67], a[24:27], v[24:27]
    v_mfma_f32_16x16x32_bf16 v[24:27], a[68:71], a[28:31], v[24:27]
    v_mfma_f32_16x16x32_bf16 v[24:27], a[176:179], a[136:139], v[24:27]
    v_mfma_f32_16x16x32_bf16 v[24:27], a[180:183], a[140:143], v[24:27]
    v_mfma_f32_16x16x32_bf16 v[28:31], a[72:75], a[24:27], v[28:31]
    v_mfma_f32_16x16x32_bf16 v[28:31], a[76:79], a[28:31], v[28:31]
    v_mfma_f32_16x16x32_bf16 v[28:31], a[184:187], a[136:139], v[28:31]
    v_mfma_f32_16x16x32_bf16 v[28:31], a[188:191], a[140:143], v[28:31]
    s_nop 3
    v_cvt_pk_bf16_f32 v24, v24, v25
    v_cvt_pk_bf16_f32 v25, v26, v27
    s_nop 1
    v_cvt_pk_bf16_f32 v26, v28, v29
    v_cvt_pk_bf16_f32 v27, v30, v31
    v_mfma_f32_16x16x32_bf16 v[32:35], a[64:67], a[32:35], v[32:35]
    v_mfma_f32_16x16x32_bf16 v[32:35], a[68:71], a[36:39], v[32:35]
    v_mfma_f32_16x16x32_bf16 v[32:35], a[176:179], a[144:147], v[32:35]
    v_mfma_f32_16x16x32_bf16 v[32:35], a[180:183], a[148:151], v[32:35]
    v_mfma_f32_16x16x32_bf16 v[36:39], a[72:75], a[32:35], v[36:39]
    v_mfma_f32_16x16x32_bf16 v[36:39], a[76:79], a[36:39], v[36:39]
    v_mfma_f32_16x16x32_bf16 v[36:39], a[184:187], a[144:147], v[36:39]
    v_mfma_f32_16x16x32_bf16 v[36:39], a[188:191], a[148:151], v[36:39]
    s_nop 3
    v_cvt_pk_bf16_f32 v32, v32, v33
    v_cvt_pk_bf16_f32 v33, v34, v35
    s_nop 1
    v_cvt_pk_bf16_f32 v34, v36, v37
    v_cvt_pk_bf16_f32 v35, v38, v39
    v_mfma_f32_16x16x32_bf16 v[40:43], a[64:67], a[40:43], v[40:43]
    v_mfma_f32_16x16x32_bf16 v[40:43], a[68:71], a[44:47], v[40:43]
    v_mfma_f32_16x16x32_bf16 v[40:43], a[176:179], a[152:155], v[40:43]
    v_mfma_f32_16x16x32_bf16 v[40:43], a[180:183], a[156:159], v[40:43]
    v_mfma_f32_16x16x32_bf16 v[44:47], a[72:75], a[40:43], v[44:47]
    v_mfma_f32_16x16x32_bf16 v[44:47], a[76:79], a[44:47], v[44:47]
    v_mfma_f32_16x16x32_bf16 v[44:47], a[184:187], a[152:155], v[44:47]
    v_mfma_f32_16x16x32_bf16 v[44:47], a[188:191], a[156:159], v[44:47]
    s_nop 3
    v_cvt_pk_bf16_f32 v40, v40, v41
    v_cvt_pk_bf16_f32 v41, v42, v43
    s_nop 1
    v_cvt_pk_bf16_f32 v42, v44, v45
    v_cvt_pk_bf16_f32 v43, v46, v47
    v_mfma_f32_16x16x32_bf16 v[48:51], a[64:67], a[48:51], v[48:51]
    v_mfma_f32_16x16x32_bf16 v[48:51], a[68:71], a[52:55], v[48:51]
    v_mfma_f32_16x16x32_bf16 v[48:51], a[176:179], a[160:163], v[48:51]
    v_mfma_f32_16x16x32_bf16 v[48:51], a[180:183], a[164:167], v[48:51]
    v_mfma_f32_16x16x32_bf16 v[52:55], a[72:75], a[48:51], v[52:55]
    v_mfma_f32_16x16x32_bf16 v[52:55], a[76:79], a[52:55], v[52:55]
    v_mfma_f32_16x16x32_bf16 v[52:55], a[184:187], a[160:163], v[52:55]
    v_mfma_f32_16x16x32_bf16 v[52:55], a[188:191], a[164:167], v[52:55]
    s_nop 3
    v_cvt_pk_bf16_f32 v48, v48, v49
    v_cvt_pk_bf16_f32 v49, v50, v51
    s_nop 1
    v_cvt_pk_bf16_f32 v50, v52, v53
    v_cvt_pk_bf16_f32 v51, v54, v55
    v_mfma_f32_16x16x32_bf16 v[56:59], a[64:67], a[56:59], v[56:59]
    v_mfma_f32_16x16x32_bf16 v[56:59], a[68:71], a[60:63], v[56:59]
    v_mfma_f32_16x16x32_bf16 v[56:59], a[176:179], a[168:171], v[56:59]
    v_mfma_f32_16x16x32_bf16 v[56:59], a[180:183], a[172:175], v[56:59]
    v_mfma_f32_16x16x32_bf16 v[60:63], a[72:75], a[56:59], v[60:63]
    v_mfma_f32_16x16x32_bf16 v[60:63], a[76:79], a[60:63], v[60:63]
    v_mfma_f32_16x16x32_bf16 v[60:63], a[184:187], a[168:171], v[60:63]
    v_mfma_f32_16x16x32_bf16 v[60:63], a[188:191], a[172:175], v[60:63]
    s_nop 3
    v_cvt_pk_bf16_f32 v56, v56, v57
    v_cvt_pk_bf16_f32 v57, v58, v59
    s_nop 1
    v_cvt_pk_bf16_f32 v58, v60, v61
    v_cvt_pk_bf16_f32 v59, v62, v63
L_slowQ:
    s_nop 15
    v_mfma_f32_16x16x32_bf16 v[100:103], a[224:227], v[0:3], 0
    v_mfma_f32_16x16x32_bf16 v[108:111], a[228:231], v[0:3], 0
    s_nop 6
    v_pk_mul_f32 v[100:101], v[100:101], v[224:225] op_sel_hi:[1,0]
    v_pk_mul_f32 v[102:103], v[102:103], v[224:225] op_sel_hi:[1,0]
    v_pk_mul_f32 v[108:109], v[108:109], v[224:225] op_sel_hi:[1,0]
    v_pk_mul_f32 v[110:111], v[110:111], v[224:225] op_sel_hi:[1,0]
    v_max3_f32 v232, v100, v101, v102
    v_max3_f32 v232, v232, v103, v108
    v_max3_f32 v232, v232, v109, v110
    v_max_f32 v232, v232, v111
    v_mov_b32 v236, v232
    s_nop 1
    v_permlane16_swap_b32 v232, v236
    v_max_f32 v232, v232, v236
    v_mov_b32 v236, v232
    s_nop 1
    v_permlane32_swap_b32 v232, v236
    v_max_f32 v232, v232, v236
    v_min3_f32 v234, v100, v101, v102
    v_min3_f32 v234, v234, v103, v108
    v_min3_f32 v234, v234, v109, v110
    v_min_f32 v234, v234, v111
    v_mov_b32 v236, v234
    s_nop 1
    v_permlane16_swap_b32 v234, v236
    v_min_f32 v234, v234, v236
    v_mov_b32 v236, v234
    s_nop 1
    v_permlane32_swap_b32 v234, v236
    v_min_f32 v234, v234, v236
    v_sub_f32 v116, v100, v232
    v_exp_f32 v116, v116
    v_sub_f32 v100, v234, v100
    v_exp_f32 v100, v100
    v_sub_f32 v117, v101, v232
    v_exp_f32 v117, v117
    v_sub_f32 v101, v234, v101
    v_exp_f32 v101, v101
    v_sub_f32 v118, v102, v232
    v_exp_f32 v118, v118
    v_sub_f32 v102, v234, v102
    v_exp_f32 v102, v102
    v_sub_f32 v119, v103, v232
    v_exp_f32 v119, v119
    v_sub_f32 v103, v234, v103
    v_exp_f32 v103, v103
    v_sub_f32 v124, v108, v232
    v_exp_f32 v124, v124
    v_sub_f32 v108, v234, v108
    v_exp_f32 v108, v108
    v_sub_f32 v125, v109, v232
    v_exp_f32 v125, v125
    v_sub_f32 v109, v234, v109
    v_exp_f32 v109, v109
    v_sub_f32 v126, v110, v232
    v_exp_f32 v126, v126
    v_sub_f32 v110, v234, v110
    v_exp_f32 v110, v110
    v_sub_f32 v127, v111, v232
    v_exp_f32 v127, v127
    v_sub_f32 v111, v234, v111
    v_exp_f32_e64 v111, v111
    v_cvt_pk_bf16_f32 v64, v116, v117
    v_cvt_pk_bf16_f32 v65, v118, v119
    v_cvt_pk_bf16_f32 v66, v124, v125
    v_cvt_pk_bf16_f32 v67, v126, v127
    s_nop 1
    v_mfma_f32_16x16x32_bf16 v[180:183], a[232:235], v[64:67], 0
    v_cvt_pk_bf16_f32 v148, v100, v101
    v_cvt_pk_bf16_f32 v149, v102, v103
    v_cvt_pk_bf16_f32 v150, v108, v109
    v_cvt_pk_bf16_f32 v151, v110, v111
    s_nop 1
    v_mfma_f32_16x16x32_bf16 v[188:191], a[232:235], v[148:151], 0
    s_nop 7
    v_rcp_f32 v232, v188
    v_max3_f32 v237, v180, v188, v237
    v_mul_f32_e64 v232, v232, v180
    v_pk_mul_f32 v[100:101], v[100:101], v[232:233] op_sel_hi:[1,0]
    v_pk_mul_f32 v[102:103], v[102:103], v[232:233] op_sel_hi:[1,0]
    v_pk_mul_f32 v[108:109], v[108:109], v[232:233] op_sel_hi:[1,0]
    v_pk_mul_f32 v[110:111], v[110:111], v[232:233] op_sel_hi:[1,0]
    v_cvt_pk_bf16_f32 v128, v100, v101
    v_cvt_pk_bf16_f32 v129, v102, v103
    v_cvt_pk_bf16_f32 v130, v108, v109
    v_cvt_pk_bf16_f32 v131, v110, v111
    v_mfma_f32_16x16x32_bf16 v[68:71], a[224:227], v[8:11], 0
    v_mfma_f32_16x16x32_bf16 v[76:79], a[228:231], v[8:11], 0
    s_nop 6
    v_pk_mul_f32 v[68:69], v[68:69], v[224:225] op_sel_hi:[1,0]
    v_pk_mul_f32 v[70:71], v[70:71], v[224:225] op_sel_hi:[1,0]
    v_pk_mul_f32 v[76:77], v[76:77], v[224:225] op_sel_hi:[1,0]
    v_pk_mul_f32 v[78:79], v[78:79], v[224:225] op_sel_hi:[1,0]
    v_max3_f32 v232, v68, v69, v70
    v_max3_f32 v232, v232, v71, v76
    v_max3_f32 v232, v232, v77, v78
    v_max_f32 v232, v232, v79
    v_mov_b32 v236, v232
    s_nop 1
    v_permlane16_swap_b32 v232, v236
    v_max_f32 v232, v232, v236
    v_mov_b32 v236, v232
    s_nop 1
    v_permlane32_swap_b32 v232, v236
    v_max_f32 v232, v232, v236
    v_min3_f32 v234, v68, v69, v70
    v_min3_f32 v234, v234, v71, v76
    v_min3_f32 v234, v234, v77, v78
    v_min_f32 v234, v234, v79
    v_mov_b32 v236, v234
    s_nop 1
    v_permlane16_swap_b32 v234, v236
    v_min_f32 v234, v234, v236
    v_mov_b32 v236, v234
    s_nop 1
    v_permlane32_swap_b32 v234, v236
    v_min_f32 v234, v234, v236
    v_sub_f32 v132, v68, v232
    v_exp_f32 v132, v132
    v_sub_f32 v68, v234, v68
    v_exp_f32 v68, v68
    v_sub_f32 v133, v69, v232
    v_exp_f32 v133, v133
    v_sub_f32 v69, v234, v69
    v_exp_f32 v69, v69
    v_sub_f32 v134, v70, v232
    v_exp_f32 v134, v134
    v_sub_f32 v70, v234, v70
    v_exp_f32 v70, v70
    v_sub_f32 v135, v71, v232
    v_exp_f32 v135, v135
    v_sub_f32 v71, v234, v71
    v_exp_f32 v71, v71
    v_sub_f32 v140, v76, v232
    v_exp_f32 v140, v140
    v_sub_f32 v76, v234, v76
    v_exp_f32 v76, v76
    v_sub_f32 v141, v77, v232
    v_exp_f32 v141, v141
    v_sub_f32 v77, v234, v77
    v_exp_f32 v77, v77
    v_sub_f32 v142, v78, v232
    v_exp_f32 v142, v142
    v_sub_f32 v78, v234, v78
    v_exp_f32 v78, v78
    v_sub_f32 v143, v79, v232
    v_exp_f32 v143, v143
    v_sub_f32 v79, v234, v79
    v_exp_f32_e64 v79, v79
    v_cvt_pk_bf16_f32 v72, v132, v133
    v_cvt_pk_bf16_f32 v73, v134, v135
    v_cvt_pk_bf16_f32 v74, v140, v141
    v_cvt_pk_bf16_f32 v75, v142, v143
    s_nop 1
    v_mfma_f32_16x16x32_bf16 v[180:183], a[232:235], v[72:75], 0
    v_cvt_pk_bf16_f32 v164, v68, v69
    v_cvt_pk_bf16_f32 v165, v70, v71
    v_cvt_pk_bf16_f32 v166, v76, v77
    v_cvt_pk_bf16_f32 v167, v78, v79
    s_nop 1
    v_mfma_f32_16x16x32_bf16 v[188:191], a[232:235], v[164:167], 0
    s_nop 7
    v_rcp_f32 v234, v188
    v_max3_f32 v237, v180, v188, v237
    v_mul_f32_e64 v234, v234, v180
    v_pk_mul_f32 v[68:69], v[68:69], v[234:235] op_sel_hi:[1,0]
    v_pk_mul_f32 v[70:71], v[70:71], v[234:235] op_sel_hi:[1,0]
    v_pk_mul_f32 v[76:77], v[76:77], v[234:235] op_sel_hi:[1,0]
    v_pk_mul_f32 v[78:79], v[78:79], v[234:235] op_sel_hi:[1,0]
    v_cvt_pk_bf16_f32 v136, v68, v69
    v_cvt_pk_bf16_f32 v137, v70, v71
    v_cvt_pk_bf16_f32 v138, v76, v77
    v_cvt_pk_bf16_f32 v139, v78, v79
    v_mfma_f32_16x16x32_bf16 v[84:87], a[224:227], v[16:19], 0
    v_mfma_f32_16x16x32_bf16 v[92:95], a[228:231], v[16:19], 0
    s_nop 6
    v_pk_mul_f32 v[84:85], v[84:85], v[224:225] op_sel_hi:[1,0]
    v_pk_mul_f32 v[86:87], v[86:87], v[224:225] op_sel_hi:[1,0]
    v_pk_mul_f32 v[92:93], v[92:93], v[224:225] op_sel_hi:[1,0]
    v_pk_mul_f32 v[94:95], v[94:95], v[224:225] op_sel_hi:[1,0]
    v_max3_f32 v232, v84, v85, v86
    v_max3_f32 v232, v232, v87, v92
    v_max3_f32 v232, v232, v93, v94
    v_max_f32 v232, v232, v95
    v_mov_b32 v236, v232
    s_nop 1
    v_permlane16_swap_b32 v232, v236
    v_max_f32 v232, v232, v236
    v_mov_b32 v236, v232
    s_nop 1
    v_permlane32_swap_b32 v232, v236
    v_max_f32 v232, v232, v236
    v_min3_f32 v234, v84, v85, v86
    v_min3_f32 v234, v234, v87, v92
    v_min3_f32 v234, v234, v93, v94
    v_min_f32 v234, v234, v95
    v_mov_b32 v236, v234
    s_nop 1
    v_permlane16_swap_b32 v234, v236
    v_min_f32 v234, v234, v236
    v_mov_b32 v236, v234
    s_nop 1
    v_permlane32_swap_b32 v234, v236
    v_min_f32 v234, v234, v236
    v_sub_f32 v116, v84, v232
    v_exp_f32 v116, v116
    v_sub_f32 v84, v234, v84
    v_exp_f32 v84, v84
    v_sub_f32 v117, v85, v232
    v_exp_f32 v117, v117
    v_sub_f32 v85, v234, v85
    v_exp_f32 v85, v85
    v_sub_f32 v118, v86, v232
    v_exp_f32 v118, v118
    v_sub_f32 v86, v234, v86
    v_exp_f32 v86, v86
    v_sub_f32 v119, v87, v232
    v_exp_f32 v119, v119
    v_sub_f32 v87, v234, v87
    v_exp_f32 v87, v87
    v_sub_f32 v124, v92, v232
    v_exp_f32 v124, v124
    v_sub_f32 v92, v234, v92
    v_exp_f32 v92, v92
    v_sub_f32 v125, v93, v232
    v_exp_f32 v125, v125
    v_sub_f32 v93, v234, v93
    v_exp_f32 v93, v93
    v_sub_f32 v126, v94, v232
    v_exp_f32 v126, v126
    v_sub_f32 v94, v234, v94
    v_exp_f32 v94, v94
    v_sub_f32 v127, v95, v232
    v_exp_f32 v127, v127
    v_sub_f32 v95, v234, v95
    v_exp_f32_e64 v95, v95
    v_cvt_pk_bf16_f32 v80, v116, v117
    v_cvt_pk_bf16_f32 v81, v118, v119
    v_cvt_pk_bf16_f32 v82, v124, v125
    v_cvt_pk_bf16_f32 v83, v126, v127
    s_nop 1
    v_mfma_f32_16x16x32_bf16 v[180:183], a[232:235], v[80:83], 0
    v_cvt_pk_bf16_f32 v148, v84, v85
    v_cvt_pk_bf16_f32 v149, v86, v87
    v_cvt_pk_bf16_f32 v150, v92, v93
    v_cvt_pk_bf16_f32 v151, v94, v95
    s_nop 1
    v_mfma_f32_16x16x32_bf16 v[188:191], a[232:235], v[148:151], 0
    s_nop 7
    v_rcp_f32 v236, v188
    v_max3_f32 v237, v180, v188, v237
    v_mul_f32_e64 v236, v236, v180
    v_pk_mul_f32 v[84:85], v[84:85], v[236:237] op_sel_hi:[1,0]
    v_pk_mul_f32 v[86:87], v[86:87], v[236:237] op_sel_hi:[1,0]
    v_pk_mul_f32 v[92:93], v[92:93], v[236:237] op_sel_hi:[1,0]
    v_pk_mul_f32 v[94:95], v[94:95], v[236:237] op_sel_hi:[1,0]
    v_cvt_pk_bf16_f32 v144, v84, v85
    v_cvt_pk_bf16_f32 v145, v86, v87
    v_cvt_pk_bf16_f32 v146, v92, v93
    v_cvt_pk_bf16_f32 v147, v94, v95
    v_mfma_f32_16x16x32_bf16 v[100:103], a[224:227], v[24:27], 0
    v_mfma_f32_16x16x32_bf16 v[108:111], a[228:231], v[24:27], 0
    s_nop 6
    v_pk_mul_f32 v[100:101], v[100:101], v[224:225] op_sel_hi:[1,0]
    v_pk_mul_f32 v[102:103], v[102:103], v[224:225] op_sel_hi:[1,0]
    v_pk_mul_f32 v[108:109], v[108:109], v[224:225] op_sel_hi:[1,0]
    v_pk_mul_f32 v[110:111], v[110:111], v[224:225] op_sel_hi:[1,0]
    v_max3_f32 v232, v100, v101, v102
    v_max3_f32 v232, v232, v103, v108
    v_max3_f32 v232, v232, v109, v110
    v_max_f32 v232, v232, v111
    v_mov_b32 v236, v232
    s_nop 1
    v_permlane16_swap_b32 v232, v236
    v_max_f32 v232, v232, v236
    v_mov_b32 v236, v232
    s_nop 1
    v_permlane32_swap_b32 v232, v236
    v_max_f32 v232, v232, v236
    v_min3_f32 v234, v100, v101, v102
    v_min3_f32 v234, v234, v103, v108
    v_min3_f32 v234, v234, v109, v110
    v_min_f32 v234, v234, v111
    v_mov_b32 v236, v234
    s_nop 1
    v_permlane16_swap_b32 v234, v236
    v_min_f32 v234, v234, v236
    v_mov_b32 v236, v234
    s_nop 1
    v_permlane32_swap_b32 v234, v236
    v_min_f32 v234, v234, v236
    v_sub_f32 v132, v100, v232
    v_exp_f32 v132, v132
    v_sub_f32 v100, v234, v100
    v_exp_f32 v100, v100
    v_sub_f32 v133, v101, v232
    v_exp_f32 v133, v133
    v_sub_f32 v101, v234, v101
    v_exp_f32 v101, v101
    v_sub_f32 v134, v102, v232
    v_exp_f32 v134, v134
    v_sub_f32 v102, v234, v102
    v_exp_f32 v102, v102
    v_sub_f32 v135, v103, v232
    v_exp_f32 v135, v135
    v_sub_f32 v103, v234, v103
    v_exp_f32 v103, v103
    v_sub_f32 v140, v108, v232
    v_exp_f32 v140, v140
    v_sub_f32 v108, v234, v108
    v_exp_f32 v108, v108
    v_sub_f32 v141, v109, v232
    v_exp_f32 v141, v141
    v_sub_f32 v109, v234, v109
    v_exp_f32 v109, v109
    v_sub_f32 v142, v110, v232
    v_exp_f32 v142, v142
    v_sub_f32 v110, v234, v110
    v_exp_f32 v110, v110
    v_sub_f32 v143, v111, v232
    v_exp_f32 v143, v143
    v_sub_f32 v111, v234, v111
    v_exp_f32_e64 v111, v111
    v_cvt_pk_bf16_f32 v88, v132, v133
    v_cvt_pk_bf16_f32 v89, v134, v135
    v_cvt_pk_bf16_f32 v90, v140, v141
    v_cvt_pk_bf16_f32 v91, v142, v143
    s_nop 1
    v_mfma_f32_16x16x32_bf16 v[4:7], a[232:235], v[88:91], 0
    v_cvt_pk_bf16_f32 v164, v100, v101
    v_cvt_pk_bf16_f32 v165, v102, v103
    v_cvt_pk_bf16_f32 v166, v108, v109
    v_cvt_pk_bf16_f32 v167, v110, v111
    s_nop 1
    v_mfma_f32_16x16x32_bf16 v[12:15], a[232:235], v[164:167], 0
    s_nop 7
    v_rcp_f32 v238, v12
    v_max3_f32 v237, v4, v12, v237
    v_mul_f32_e64 v238, v238, v4
    v_pk_mul_f32 v[100:101], v[100:101], v[238:239] op_sel_hi:[1,0]
    v_pk_mul_f32 v[102:103], v[102:103], v[238:239] op_sel_hi:[1,0]
    v_pk_mul_f32 v[108:109], v[108:109], v[238:239] op_sel_hi:[1,0]
    v_pk_mul_f32 v[110:111], v[110:111], v[238:239] op_sel_hi:[1,0]
    v_cvt_pk_bf16_f32 v152, v100, v101
    v_cvt_pk_bf16_f32 v153, v102, v103
    v_cvt_pk_bf16_f32 v154, v108, v109
    v_cvt_pk_bf16_f32 v155, v110, v111
    v_mfma_f32_16x16x32_bf16 v[68:71], a[224:227], v[32:35], 0
    v_mfma_f32_16x16x32_bf16 v[76:79], a[228:231], v[32:35], 0
    s_nop 6
    v_pk_mul_f32 v[68:69], v[68:69], v[224:225] op_sel_hi:[1,0]
    v_pk_mul_f32 v[70:71], v[70:71], v[224:225] op_sel_hi:[1,0]
    v_pk_mul_f32 v[76:77], v[76:77], v[224:225] op_sel_hi:[1,0]
    v_pk_mul_f32 v[78:79], v[78:79], v[224:225] op_sel_hi:[1,0]
    v_max3_f32 v232, v68, v69, v70
    v_max3_f32 v232, v232, v71, v76
    v_max3_f32 v232, v232, v77, v78
    v_max_f32 v232, v232, v79
    v_mov_b32 v236, v232
    s_nop 1
    v_permlane16_swap_b32 v232, v236
    v_max_f32 v232, v232, v236
    v_mov_b32 v236, v232
    s_nop 1
    v_permlane32_swap_b32 v232, v236
    v_max_f32 v232, v232, v236
    v_min3_f32 v234, v68, v69, v70
    v_min3_f32 v234, v234, v71, v76
    v_min3_f32 v234, v234, v77, v78
    v_min_f32 v234, v234, v79
    v_mov_b32 v236, v234
    s_nop 1
    v_permlane16_swap_b32 v234, v236
    v_min_f32 v234, v234, v236
    v_mov_b32 v236, v234
    s_nop 1
    v_permlane32_swap_b32 v234, v236
    v_min_f32 v234, v234, v236
    v_sub_f32 v116, v68, v232
    v_exp_f32 v116, v116
    v_sub_f32 v68, v234, v68
    v_exp_f32 v68, v68
    v_sub_f32 v117, v69, v232
    v_exp_f32 v117, v117
    v_sub_f32 v69, v234, v69
    v_exp_f32 v69, v69
    v_sub_f32 v118, v70, v232
    v_exp_f32 v118, v118
    v_sub_f32 v70, v234, v70
    v_exp_f32 v70, v70
    v_sub_f32 v119, v71, v232
    v_exp_f32 v119, v119
    v_sub_f32 v71, v234, v71
    v_exp_f32 v71, v71
    v_sub_f32 v124, v76, v232
    v_exp_f32 v124, v124
    v_sub_f32 v76, v234, v76
    v_exp_f32 v76, v76
    v_sub_f32 v125, v77, v232
    v_exp_f32 v125, v125
    v_sub_f32 v77, v234, v77
    v_exp_f32 v77, v77
    v_sub_f32 v126, v78, v232
    v_exp_f32 v126, v126
    v_sub_f32 v78, v234, v78
    v_exp_f32 v78, v78
    v_sub_f32 v127, v79, v232
    v_exp_f32 v127, v127
    v_sub_f32 v79, v234, v79
    v_exp_f32_e64 v79, v79
    v_cvt_pk_bf16_f32 v96, v116, v117
    v_cvt_pk_bf16_f32 v97, v118, v119
    v_cvt_pk_bf16_f32 v98, v124, v125
    v_cvt_pk_bf16_f32 v99, v126, v127
    s_nop 1
    v_mfma_f32_16x16x32_bf16 v[180:183], a[232:235], v[96:99], 0
    v_cvt_pk_bf16_f32 v148, v68, v69
    v_cvt_pk_bf16_f32 v149, v70, v71
    v_cvt_pk_bf16_f32 v150, v76, v77
    v_cvt_pk_bf16_f32 v151, v78, v79
    s_nop 1
    v_mfma_f32_16x16x32_bf16 v[188:191], a[232:235], v[148:151], 0
    s_nop 7
    v_rcp_f32 v232, v188
    v_max3_f32 v237, v180, v188, v237
    v_mul_f32_e64 v232, v232, v180
    v_pk_mul_f32 v[68:69], v[68:69], v[232:233] op_sel_hi:[1,0]
    v_pk_mul_f32 v[70:71], v[70:71], v[232:233] op_sel_hi:[1,0]
    v_pk_mul_f32 v[76:77], v[76:77], v[232:233] op_sel_hi:[1,0]
    v_pk_mul_f32 v[78:79], v[78:79], v[232:233] op_sel_hi:[1,0]
    v_cvt_pk_bf16_f32 v160, v68, v69
    v_cvt_pk_bf16_f32 v161, v70, v71
    v_cvt_pk_bf16_f32 v162, v76, v77
    v_cvt_pk_bf16_f32 v163, v78, v79
    v_mfma_f32_16x16x32_bf16 v[84:87], a[224:227], v[40:43], 0
    v_mfma_f32_16x16x32_bf16 v[92:95], a[228:231], v[40:43], 0
    s_nop 6
    v_pk_mul_f32 v[84:85], v[84:85], v[224:225] op_sel_hi:[1,0]
    v_pk_mul_f32 v[86:87], v[86:87], v[224:225] op_sel_hi:[1,0]
    v_pk_mul_f32 v[92:93], v[92:93], v[224:225] op_sel_hi:[1,0]
    v_pk_mul_f32 v[94:95], v[94:95], v[224:225] op_sel_hi:[1,0]
    v_max3_f32 v232, v84, v85, v86
    v_max3_f32 v232, v232, v87, v92
    v_max3_f32 v232, v232, v93, v94
    v_max_f32 v232, v232, v95
    v_mov_b32 v236, v232
    s_nop 1
    v_permlane16_swap_b32 v232, v236
    v_max_f32 v232, v232, v236
    v_mov_b32 v236, v232
    s_nop 1
    v_permlane32_swap_b32 v232, v236
    v_max_f32 v232, v232, v236
    v_min3_f32 v234, v84, v85, v86
    v_min3_f32 v234, v234, v87, v92
    v_min3_f32 v234, v234, v93, v94
    v_min_f32 v234, v234, v95
    v_mov_b32 v236, v234
    s_nop 1
    v_permlane16_swap_b32 v234, v236
    v_min_f32 v234, v234, v236
    v_mov_b32 v236, v234
    s_nop 1
    v_permlane32_swap_b32 v234, v236
    v_min_f32 v234, v234, v236
    v_sub_f32 v132, v84, v232
    v_exp_f32 v132, v132
    v_sub_f32 v84, v234, v84
    v_exp_f32 v84, v84
    v_sub_f32 v133, v85, v232
    v_exp_f32 v133, v133
    v_sub_f32 v85, v234, v85
    v_exp_f32 v85, v85
    v_sub_f32 v134, v86, v232
    v_exp_f32 v134, v134
    v_sub_f32 v86, v234, v86
    v_exp_f32 v86, v86
    v_sub_f32 v135, v87, v232
    v_exp_f32 v135, v135
    v_sub_f32 v87, v234, v87
    v_exp_f32 v87, v87
    v_sub_f32 v140, v92, v232
    v_exp_f32 v140, v140
    v_sub_f32 v92, v234, v92
    v_exp_f32 v92, v92
    v_sub_f32 v141, v93, v232
    v_exp_f32 v141, v141
    v_sub_f32 v93, v234, v93
    v_exp_f32 v93, v93
    v_sub_f32 v142, v94, v232
    v_exp_f32 v142, v142
    v_sub_f32 v94, v234, v94
    v_exp_f32 v94, v94
    v_sub_f32 v143, v95, v232
    v_exp_f32 v143, v143
    v_sub_f32 v95, v234, v95
    v_exp_f32_e64 v95, v95
    v_cvt_pk_bf16_f32 v104, v132, v133
    v_cvt_pk_bf16_f32 v105, v134, v135
    v_cvt_pk_bf16_f32 v106, v140, v141
    v_cvt_pk_bf16_f32 v107, v142, v143
    s_nop 1
    v_mfma_f32_16x16x32_bf16 v[4:7], a[232:235], v[104:107], 0
    v_cvt_pk_bf16_f32 v164, v84, v85
    v_cvt_pk_bf16_f32 v165, v86, v87
    v_cvt_pk_bf16_f32 v166, v92, v93
    v_cvt_pk_bf16_f32 v167, v94, v95
    s_nop 1
    v_mfma_f32_16x16x32_bf16 v[12:15], a[232:235], v[164:167], 0
    s_nop 7
    v_rcp_f32 v234, v12
    v_max3_f32 v237, v4, v12, v237
    v_mul_f32_e64 v234, v234, v4
    v_pk_mul_f32 v[84:85], v[84:85], v[234:235] op_sel_hi:[1,0]
    v_pk_mul_f32 v[86:87], v[86:87], v[234:235] op_sel_hi:[1,0]
    v_pk_mul_f32 v[92:93], v[92:93], v[234:235] op_sel_hi:[1,0]
    v_pk_mul_f32 v[94:95], v[94:95], v[234:235] op_sel_hi:[1,0]
    v_cvt_pk_bf16_f32 v168, v84, v85
    v_cvt_pk_bf16_f32 v169, v86, v87
    v_cvt_pk_bf16_f32 v170, v92, v93
    v_cvt_pk_bf16_f32 v171, v94, v95
    v_mfma_f32_16x16x32_bf16 v[100:103], a[224:227], v[48:51], 0
    v_mfma_f32_16x16x32_bf16 v[108:111], a[228:231], v[48:51], 0
    s_nop 6
    v_pk_mul_f32 v[100:101], v[100:101], v[224:225] op_sel_hi:[1,0]
    v_pk_mul_f32 v[102:103], v[102:103], v[224:225] op_sel_hi:[1,0]
    v_pk_mul_f32 v[108:109], v[108:109], v[224:225] op_sel_hi:[1,0]
    v_pk_mul_f32 v[110:111], v[110:111], v[224:225] op_sel_hi:[1,0]
    v_max3_f32 v232, v100, v101, v102
    v_max3_f32 v232, v232, v103, v108
    v_max3_f32 v232, v232, v109, v110
    v_max_f32 v232, v232, v111
    v_mov_b32 v236, v232
    s_nop 1
    v_permlane16_swap_b32 v232, v236
    v_max_f32 v232, v232, v236
    v_mov_b32 v236, v232
    s_nop 1
    v_permlane32_swap_b32 v232, v236
    v_max_f32 v232, v232, v236
    v_min3_f32 v234, v100, v101, v102
    v_min3_f32 v234, v234, v103, v108
    v_min3_f32 v234, v234, v109, v110
    v_min_f32 v234, v234, v111
    v_mov_b32 v236, v234
    s_nop 1
    v_permlane16_swap_b32 v234, v236
    v_min_f32 v234, v234, v236
    v_mov_b32 v236, v234
    s_nop 1
    v_permlane32_swap_b32 v234, v236
    v_min_f32 v234, v234, v236
    v_sub_f32 v116, v100, v232
    v_exp_f32 v116, v116
    v_sub_f32 v100, v234, v100
    v_exp_f32 v100, v100
    v_sub_f32 v117, v101, v232
    v_exp_f32 v117, v117
    v_sub_f32 v101, v234, v101
    v_exp_f32 v101, v101
    v_sub_f32 v118, v102, v232
    v_exp_f32 v118, v118
    v_sub_f32 v102, v234, v102
    v_exp_f32 v102, v102
    v_sub_f32 v119, v103, v232
    v_exp_f32 v119, v119
    v_sub_f32 v103, v234, v103
    v_exp_f32 v103, v103
    v_sub_f32 v124, v108, v232
    v_exp_f32 v124, v124
    v_sub_f32 v108, v234, v108
    v_exp_f32 v108, v108
    v_sub_f32 v125, v109, v232
    v_exp_f32 v125, v125
    v_sub_f32 v109, v234, v109
    v_exp_f32 v109, v109
    v_sub_f32 v126, v110, v232
    v_exp_f32 v126, v126
    v_sub_f32 v110, v234, v110
    v_exp_f32 v110, v110
    v_sub_f32 v127, v111, v232
    v_exp_f32 v127, v127
    v_sub_f32 v111, v234, v111
    v_exp_f32_e64 v111, v111
    v_cvt_pk_bf16_f32 v112, v116, v117
    v_cvt_pk_bf16_f32 v113, v118, v119
    v_cvt_pk_bf16_f32 v114, v124, v125
    v_cvt_pk_bf16_f32 v115, v126, v127
    s_nop 1
    v_mfma_f32_16x16x32_bf16 v[180:183], a[232:235], v[112:115], 0
    v_cvt_pk_bf16_f32 v148, v100, v101
    v_cvt_pk_bf16_f32 v149, v102, v103
    v_cvt_pk_bf16_f32 v150, v108, v109
    v_cvt_pk_bf16_f32 v151, v110, v111
    s_nop 1
    v_mfma_f32_16x16x32_bf16 v[188:191], a[232:235], v[148:151], 0
    s_nop 7
    v_rcp_f32 v236, v188
    v_max3_f32 v237, v180, v188, v237
    v_mul_f32_e64 v236, v236, v180
    v_pk_mul_f32 v[100:101], v[100:101], v[236:237] op_sel_hi:[1,0]
    v_pk_mul_f32 v[102:103], v[102:103], v[236:237] op_sel_hi:[1,0]
    v_pk_mul_f32 v[108:109], v[108:109], v[236:237] op_sel_hi:[1,0]
    v_pk_mul_f32 v[110:111], v[110:111], v[236:237] op_sel_hi:[1,0]
    v_cvt_pk_bf16_f32 v176, v100, v101
    v_cvt_pk_bf16_f32 v177, v102, v103
    v_cvt_pk_bf16_f32 v178, v108, v109
    v_cvt_pk_bf16_f32 v179, v110, v111
    v_mfma_f32_16x16x32_bf16 v[68:71], a[224:227], v[56:59], 0
    v_mfma_f32_16x16x32_bf16 v[76:79], a[228:231], v[56:59], 0
    s_nop 6
    v_pk_mul_f32 v[68:69], v[68:69], v[224:225] op_sel_hi:[1,0]
    v_pk_mul_f32 v[70:71], v[70:71], v[224:225] op_sel_hi:[1,0]
    v_pk_mul_f32 v[76:77], v[76:77], v[224:225] op_sel_hi:[1,0]
    v_pk_mul_f32 v[78:79], v[78:79], v[224:225] op_sel_hi:[1,0]
    v_max3_f32 v232, v68, v69, v70
    v_max3_f32 v232, v232, v71, v76
    v_max3_f32 v232, v232, v77, v78
    v_max_f32 v232, v232, v79
    v_mov_b32 v236, v232
    s_nop 1
    v_permlane16_swap_b32 v232, v236
    v_max_f32 v232, v232, v236
    v_mov_b32 v236, v232
    s_nop 1
    v_permlane32_swap_b32 v232, v236
    v_max_f32 v232, v232, v236
    v_min3_f32 v234, v68, v69, v70
    v_min3_f32 v234, v234, v71, v76
    v_min3_f32 v234, v234, v77, v78
    v_min_f32 v234, v234, v79
    v_mov_b32 v236, v234
    s_nop 1
    v_permlane16_swap_b32 v234, v236
    v_min_f32 v234, v234, v236
    v_mov_b32 v236, v234
    s_nop 1
    v_permlane32_swap_b32 v234, v236
    v_min_f32 v234, v234, v236
    v_sub_f32 v132, v68, v232
    v_exp_f32 v132, v132
    v_sub_f32 v68, v234, v68
    v_exp_f32 v68, v68
    v_sub_f32 v133, v69, v232
    v_exp_f32 v133, v133
    v_sub_f32 v69, v234, v69
    v_exp_f32 v69, v69
    v_sub_f32 v134, v70, v232
    v_exp_f32 v134, v134
    v_sub_f32 v70, v234, v70
    v_exp_f32 v70, v70
    v_sub_f32 v135, v71, v232
    v_exp_f32 v135, v135
    v_sub_f32 v71, v234, v71
    v_exp_f32 v71, v71
    v_sub_f32 v140, v76, v232
    v_exp_f32 v140, v140
    v_sub_f32 v76, v234, v76
    v_exp_f32 v76, v76
    v_sub_f32 v141, v77, v232
    v_exp_f32 v141, v141
    v_sub_f32 v77, v234, v77
    v_exp_f32 v77, v77
    v_sub_f32 v142, v78, v232
    v_exp_f32 v142, v142
    v_sub_f32 v78, v234, v78
    v_exp_f32 v78, v78
    v_sub_f32 v143, v79, v232
    v_exp_f32 v143, v143
    v_sub_f32 v79, v234, v79
    v_exp_f32_e64 v79, v79
    v_cvt_pk_bf16_f32 v120, v132, v133
    v_cvt_pk_bf16_f32 v121, v134, v135
    v_cvt_pk_bf16_f32 v122, v140, v141
    v_cvt_pk_bf16_f32 v123, v142, v143
    s_nop 1
    v_mfma_f32_16x16x32_bf16 v[4:7], a[232:235], v[120:123], 0
    v_cvt_pk_bf16_f32 v164, v68, v69
    v_cvt_pk_bf16_f32 v165, v70, v71
    v_cvt_pk_bf16_f32 v166, v76, v77
    v_cvt_pk_bf16_f32 v167, v78, v79
    s_nop 1
    v_mfma_f32_16x16x32_bf16 v[12:15], a[232:235], v[164:167], 0
    s_nop 7
    v_rcp_f32 v238, v12
    v_max3_f32 v237, v4, v12, v237
    v_mul_f32_e64 v238, v238, v4
    v_pk_mul_f32 v[68:69], v[68:69], v[238:239] op_sel_hi:[1,0]
    v_pk_mul_f32 v[70:71], v[70:71], v[238:239] op_sel_hi:[1,0]
    v_pk_mul_f32 v[76:77], v[76:77], v[238:239] op_sel_hi:[1,0]
    v_pk_mul_f32 v[78:79], v[78:79], v[238:239] op_sel_hi:[1,0]
    v_cvt_pk_bf16_f32 v184, v68, v69
    v_cvt_pk_bf16_f32 v185, v70, v71
    v_cvt_pk_bf16_f32 v186, v76, v77
    v_cvt_pk_bf16_f32 v187, v78, v79
    s_nop 7
    s_branch L_backQ
.section .rodata,"a"
.p2align 6
.amdhsa_kernel concat_heads__linear_kernel_hedgehog__linear_kernel_hedgehog__prompt_kernel
  .amdhsa_next_free_vgpr 512
  .amdhsa_next_free_sgpr 102
  .amdhsa_accum_offset 256
  .amdhsa_group_segment_fixed_size 0
  .amdhsa_kernarg_size 88
  .amdhsa_user_sgpr_count 2
  .amdhsa_user_sgpr_kernarg_segment_ptr 1
  .amdhsa_system_sgpr_workgroup_id_x 1
.end_amdhsa_kernel
```
